```python
import torch

def _softmax(x, axis=-1):
    return torch.softmax(x, dim=axis)

def _gelu(x):
    return torch.nn.functional.gelu(x, approximate='tanh')

def _silu(x):
    return torch.nn.functional.silu(x)

def _sigmoid(x):
    return torch.sigmoid(x)

def _layernorm(x, axis=-1, eps=1e-05):
    m = x.mean(dim=axis, keepdim=True)
    v = x.var(dim=axis, keepdim=True, unbiased=False)
    return (x - m) / torch.sqrt(v + eps)

def _scatter_add(tgt, idx, src, axis=0):
    return tgt.clone().index_add_(axis, idx, src)

def _segment_sum(src, seg, n):
    out = torch.zeros((n,) + src.shape[1:], dtype=src.dtype)
    return out.index_add_(0, seg, src)

def _pad(x, pw):
    flat = tuple((v for pair in reversed(pw) for v in pair))
    return torch.nn.functional.pad(x, flat)
kernel_name = 'adaLN_cond__memory_aug_recurrent_mem_tr__dense_activation_silu__prompt'

def setup_inputs():

    _w = lambda a: (lambda t: t.to(torch.bfloat16) if t.is_floating_point() else t)(torch.as_tensor(a))

    def _A_setup():
        B, S, Dm = (1, 2048, 512)
        H, Dh = (32, 128)
        M, seg = (8, 32)
        seg = min(seg, S)
        S = S // seg * seg
        return {'x': _w((lambda *s: torch.randn(*s, dtype=torch.bfloat16) * 0.05)(B, S, Dm)), 'mem0': _w((lambda *s: torch.randn(*s, dtype=torch.bfloat16) * 0.8)(B, M, Dm)), 'Wq': _w((lambda *s: torch.randn(*s, dtype=torch.bfloat16) * 0.8)(Dm, H, Dh) * Dm ** (-0.5)), 'Wk': _w((lambda *s: torch.randn(*s, dtype=torch.bfloat16) * 0.8)(Dm, H, Dh) * Dm ** (-0.5)), 'Wv': _w((lambda *s: torch.randn(*s, dtype=torch.bfloat16) * 0.8)(Dm, H, Dh) * Dm ** (-0.5)), 'Wo': _w((lambda *s: torch.randn(*s, dtype=torch.bfloat16) * 0.8)(H, Dh, Dm) * (H * Dh) ** (-0.5)), 'seg_len': seg}
    _A_in = _A_setup()

    def _B_setup():
        B, S, D, F = (1, 2048, 512, 1376)
        return {'x': _w((lambda *s: torch.randn(*s, dtype=torch.bfloat16) * 0.05)(B, S, D)), 'w1': _w((lambda *s: torch.randn(*s, dtype=torch.bfloat16) * 3.2)(D, F) * D ** (-0.5)), 'w2': _w((lambda *s: torch.randn(*s, dtype=torch.bfloat16) * 0.2)(F, D) * F ** (-0.5))}
    _B_in = _B_setup()
    return {'A_x': _A_in['x'], 'A_mem0': _A_in['mem0'], 'A_Wq': _A_in['Wq'], 'A_Wk': _A_in['Wk'], 'A_Wv': _A_in['Wv'], 'A_Wo': _A_in['Wo'], 'A_seg_len': _A_in['seg_len'], 'B_x': _B_in['x'], 'B_w1': _B_in['w1'], 'B_w2': _B_in['w2'], 'c': _w((lambda *s: torch.randn(*s, dtype=torch.bfloat16) * 0.2)(1, 512) * 8.0), 'w_mod': _w((lambda *s: torch.randn(*s, dtype=torch.bfloat16) * 0.2)(512, 6 * 512) * 512 ** (-0.5) * 8.0)}

def reference(A_x, A_mem0, A_Wq, A_Wk, A_Wv, A_Wo, A_seg_len, B_x, B_w1, B_w2, c, w_mod):

    def _A_ref(x, mem0, Wq, Wk, Wv, Wo, seg_len):
        B, S, Dm = x.shape
        H, Dh = (Wq.shape[1], Wq.shape[2])
        M = mem0.shape[1]
        scale = Dh ** (-0.5)
        n_seg = S // seg_len
        L = M + seg_len
        idx = torch.arange(L)
        mask = (idx[:, None] < M) | (idx[:, None] >= idx[None, :])
        mem = mem0
        outs = []
        for s in range(n_seg):
            xs = x[:, s * seg_len:(s + 1) * seg_len, :].clone()
            h = torch.concatenate([mem, xs], axis=1)
            q = torch.einsum('btd,dhe->bhte', h, Wq)
            k = torch.einsum('btd,dhe->bhte', h, Wk)
            v = torch.einsum('btd,dhe->bhte', h, Wv)
            scores = torch.einsum('bhqe,bhke->bhqk', q, k) * scale
            scores = torch.where(mask[None, None], scores, -1000000000.0)
            p = _softmax(scores, axis=-1)
            o = torch.einsum('bhqk,bhke->bhqe', p, v)
            o = torch.einsum('bhte,hed->btd', o, Wo)
            mem = o[:, :M, :].clone()
            outs.append(o[:, M:, :])
        return torch.concatenate(outs, axis=1)

    def _B_ref(x, w1, w2):
        h = torch.einsum('bsd,df->bsf', x, w1)
        h = _silu(h)
        out = torch.einsum('bsf,fd->bsd', h, w2)
        return out
    x = A_x
    mod = (_silu(c) @ w_mod).reshape(c.shape[0], 6, 1, -1)
    sa, ca, ga, sb, cb, gb = (mod[:, 0].clone(), mod[:, 1].clone(), mod[:, 2].clone(), mod[:, 3].clone(), mod[:, 4].clone(), mod[:, 5].clone())
    h = _layernorm(x, axis=-1) * (1 + ca) + sa
    x = x + ga * _A_ref(h, A_mem0, A_Wq, A_Wk, A_Wv, A_Wo, A_seg_len)
    h = _layernorm(x, axis=-1) * (1 + cb) + sb
    x = x + gb * _B_ref(h, B_w1, B_w2)
    return x
```

```asm
; @launch grid=(256,1,1) block=(256,1,1) lds=163840
.amdgcn_target "amdgcn-amd-amdhsa--gfx950"
.text
.globl adaLN_cond__memory_aug_recurrent_mem_tr__dense_activation_silu__prompt_kernel
.p2align 8
.type adaLN_cond__memory_aug_recurrent_mem_tr__dense_activation_silu__prompt_kernel,@function
adaLN_cond__memory_aug_recurrent_mem_tr__dense_activation_silu__prompt_kernel:

    s_load_dwordx2 s[4:5], s[0:1], 112
    s_load_dwordx2 s[12:13], s[0:1], 104
    s_cmp_ge_u32 s2, 256
    s_cbranch_scc1 L_end
    s_and_b32 s17, s2, 7
    s_lshr_b32 s14, s2, 3
    s_mov_b32 s6, 0x10000000
    s_mov_b32 s7, 0x00020000

    s_sub_u32 s17, s17, 1
    s_cbranch_scc0 L_worker

    v_lshrrev_b32 v1, 6, v0
    v_and_b32 v0, 63, v0
    v_readfirstlane_b32 s15, v1
    s_load_dwordx2 s[40:41], s[0:1], 8
    s_load_dwordx2 s[42:43], s[0:1], 16
    s_load_dwordx2 s[44:45], s[0:1], 24
    s_load_dwordx2 s[46:47], s[0:1], 32
    s_load_dwordx2 s[48:49], s[0:1], 40
    v_lshrrev_b32 v2, 4, v0
    v_and_b32 v3, 15, v0
    v_and_b32 v4, 1, v2
    v_lshrrev_b32 v5, 1, v2
    v_lshlrev_b32 v112, 4, v0
    v_and_b32 v115, 0x70, v112
    v_lshl_add_u32 v115, v2, 7, v115
    v_and_b32 v7, 0x80, v112
    v_lshl_add_u32 v116, v7, 2, v115
    v_mad_u32_u24 v114, v7, 7, v112
    v_and_b32 v113, 0x170, v112
    v_lshl_add_u32 v113, v7, 2, v113
    v_lshl_add_u32 v113, v5, 7, v113
    s_mul_i32 s36, s15, 34816
    s_add_u32 s36, s36, 24576
    v_add_u32 v121, s36, v112
    v_lshl_add_u32 v6, v5, 4, v3
    v_lshrrev_b32 v8, 2, v3
    v_and_b32 v9, 1, v3
    v_lshlrev_b32 v7, 2, v4
    v_and_b32 v10, 7, v3
    v_sub_u32 v11, v10, v7
    v_lshrrev_b32 v12, 3, v3
    v_lshlrev_b32 v12, 1, v12
    v_xor_b32 v12, v12, v10
    v_sub_u32 v12, v12, v7
    v_mov_b32 v13, 0x3f80
    v_mov_b32 v14, 0x3f800000
    v_cmp_eq_u32 vcc, 0, v11
s_nop 1
    v_cndmask_b32 v24, 0, v13, vcc
    v_cmp_eq_u32 vcc, 1, v11
s_nop 1
    v_cndmask_b32 v24, v24, v14, vcc
    v_cmp_eq_u32 vcc, 2, v11
s_nop 1
    v_cndmask_b32 v25, 0, v13, vcc
    v_cmp_eq_u32 vcc, 3, v11
s_nop 1
    v_cndmask_b32 v25, v25, v14, vcc
    v_cmp_eq_u32 vcc, 0, v12
s_nop 1
    v_cndmask_b32 v26, 0, v13, vcc
    v_cmp_eq_u32 vcc, 1, v12
s_nop 1
    v_cndmask_b32 v26, v26, v14, vcc
    v_cmp_eq_u32 vcc, 2, v12
s_nop 1
    v_cndmask_b32 v27, 0, v13, vcc
    v_cmp_eq_u32 vcc, 3, v12
s_nop 1
    v_cndmask_b32 v27, v27, v14, vcc
    v_and_b32 v15, 3, v3
    v_lshl_add_u32 v15, v15, 2, v8
    v_cmp_eq_u32 vcc, 0, v15
s_nop 1
    v_cndmask_b32 v28, 0, v13, vcc
    v_cmp_eq_u32 vcc, 1, v15
s_nop 1
    v_cndmask_b32 v28, v28, v14, vcc
    v_cmp_eq_u32 vcc, 2, v15
s_nop 1
    v_cndmask_b32 v29, 0, v13, vcc
    v_cmp_eq_u32 vcc, 3, v15
s_nop 1
    v_cndmask_b32 v29, v29, v14, vcc
    v_cmp_eq_u32 vcc, 4, v15
s_nop 1
    v_cndmask_b32 v30, 0, v13, vcc
    v_cmp_eq_u32 vcc, 5, v15
s_nop 1
    v_cndmask_b32 v30, v30, v14, vcc
    v_cmp_eq_u32 vcc, 6, v15
s_nop 1
    v_cndmask_b32 v31, 0, v13, vcc
    v_cmp_eq_u32 vcc, 7, v15
s_nop 1
    v_cndmask_b32 v31, v31, v14, vcc
    ds_write_b128 v112, v[24:27] offset:10240
    ds_write_b128 v112, v[28:31] offset:9216
    v_lshrrev_b32 v7, 3, v6
    v_lshlrev_b32 v7, 12, v7
    v_lshl_add_u32 v7, v4, 11, v7
    v_lshl_add_u32 v7, v10, 3, v7
    v_bfe_u32 v10, v3, 1, 1
    s_lshl_b32 s3, s15, 14
    s_lshl_b32 s37, s14, 6
    s_add_u32 s3, s3, s37
    v_add_u32 v117, s3, v7
    s_lshl_b32 s22, s15, 16
    s_lshl_b32 s37, s14, 11
    s_add_u32 s22, s22, s37
    v_add_u32 v118, s22, v112
    v_lshlrev_b32 v12, 2, v3
    v_lshl_add_u32 v7, v2, 4, v12
    s_lshl_b32 s3, s15, 11
    s_lshl_b32 s37, s14, 6
    s_add_u32 s3, s3, s37
    v_add_u32 v7, s3, v7
    v_mov_b32 v11, 0x80000000
    v_cmp_gt_u32 vcc, 4, v3
s_nop 1
    v_cndmask_b32 v119, v11, v7, vcc
    v_lshl_add_u32 v7, v2, 10, v12
    s_lshl_b32 s3, s15, 8
    s_lshr_b32 s37, s14, 1
    s_lshl_b32 s37, s37, 4
    s_add_u32 s3, s3, s37
    s_and_b32 s37, s14, 1
    s_lshl_b32 s37, s37, 12
    s_add_u32 s3, s3, s37
    v_add_u32 v7, s3, v7
    v_cndmask_b32 v12, v11, v7, vcc
    v_mov_b32 v7, 0x4444
    v_mov_b32 v13, 0xeeee
    v_cmp_gt_u32 vcc, 8, v3
s_nop 1
    v_cndmask_b32 v120, v13, v7, vcc
    v_lshlrev_b32 v7, 4, v5
    v_lshl_add_u32 v7, v4, 2, v7
    v_lshrrev_b32 v13, 3, v3
    v_lshl_add_u32 v7, v13, 3, v7
    v_and_b32 v14, 1, v8
    v_add_u32 v7, v7, v14
    v_lshlrev_b32 v7, 13, v7
    v_xor_b32 v15, v10, v4
    v_lshl_add_u32 v7, v15, 4, v7
    v_lshl_add_u32 v16, v9, 5, v7
    v_lshlrev_b32 v7, 3, v4
    v_lshl_add_u32 v7, v5, 2, v7
    v_lshlrev_b32 v15, 1, v4
    v_xor_b32 v15, v15, v8
    v_add_u32 v7, v7, v15
    v_lshlrev_b32 v7, 10, v7
    v_and_b32 v15, 3, v3
    v_lshl_add_u32 v17, v15, 4, v7
    v_lshlrev_b32 v7, 8, v2
    v_lshl_add_u32 v7, v15, 3, v7
    v_add_u32 v7, s36, v7
    v_lshl_add_u32 v18, v8, 6, v7
    v_lshl_add_u32 v18, v4, 5, v18
    v_xor_b32 v19, 32, v18
    v_lshl_add_u32 v20, v4, 7, v7
    v_lshl_add_u32 v20, v14, 6, v20
    v_lshl_add_u32 v20, v13, 5, v20
    v_xor_b32 v21, 0x80, v20
    v_mov_b32 v24, -1
    v_mov_b32 v25, -1
    v_mov_b32 v26, -1
    v_mov_b32 v27, -1
    s_mov_b32 s10, 0x400000
    s_mov_b32 s11, 0x00020000
    s_lshl_b32 s38, s14, 8
    s_lshl_b32 s3, s15, 6
    s_add_u32 s38, s38, s3
    s_lshl_b32 s39, s15, 20
    s_or_b32 s38, s38, s39
    s_lshl_b32 s39, s14, 17
    s_add_u32 s39, s39, s3
    s_waitcnt lgkmcnt(0)
    s_mov_b32 s8, s40
    s_mov_b32 s9, s41
    s_mov_b32 s10, 8192
    buffer_load_dword v22, v12, s[8:11], 0 offen
    s_mov_b32 s10, 0x400000

    s_cmp_lg_u32 s15, 0
    s_cbranch_scc1 TA_1
    s_getreg_b32 s3, hwreg(HW_REG_XCC_ID)
    s_and_b32 s3, s3, 7
    s_mul_i32 s3, s3, 6
    s_lshl_b64 vcc, 1, s3
    v_mov_b32 v4, vcc_lo
    v_mov_b32 v5, vcc_hi
    s_add_u32 s3, 0, 0
    s_lshl_b32 s3, s3, 3
    v_mov_b32 v2, s3
    s_mov_b64 exec, 1
    global_atomic_add_x2 v2, v[4:5], s[12:13] sc1
    s_mov_b64 exec, -1
TA_1:
    s_mov_b32 s8, s42
    s_mov_b32 s9, s43
    s_xor_b32 s3, s38, 2097152
    s_add_u32 m0, s36, 0
s_nop 0
    buffer_load_dwordx4 v16, s[8:11], s3 offen lds
    s_xor_b32 s3, s38, 2113536
    s_add_u32 m0, s36, 1024
s_nop 0
    buffer_load_dwordx4 v16, s[8:11], s3 offen lds
    s_xor_b32 s3, s38, 2359296
    s_add_u32 m0, s36, 2048
s_nop 0
    buffer_load_dwordx4 v16, s[8:11], s3 offen lds
    s_xor_b32 s3, s38, 2375680
    s_add_u32 m0, s36, 3072
s_nop 0
    buffer_load_dwordx4 v16, s[8:11], s3 offen lds
    s_xor_b32 s3, s38, 2621440
    s_add_u32 m0, s36, 4096
s_nop 0
    buffer_load_dwordx4 v16, s[8:11], s3 offen lds
    s_xor_b32 s3, s38, 2637824
    s_add_u32 m0, s36, 5120
s_nop 0
    buffer_load_dwordx4 v16, s[8:11], s3 offen lds
    s_xor_b32 s3, s38, 2883584
    s_add_u32 m0, s36, 6144
s_nop 0
    buffer_load_dwordx4 v16, s[8:11], s3 offen lds
    s_xor_b32 s3, s38, 2899968
    s_add_u32 m0, s36, 7168
s_nop 0
    buffer_load_dwordx4 v16, s[8:11], s3 offen lds
    s_xor_b32 s3, s38, 3145728
    s_add_u32 m0, s36, 8192
s_nop 0
    buffer_load_dwordx4 v16, s[8:11], s3 offen lds
    s_xor_b32 s3, s38, 3162112
    s_add_u32 m0, s36, 9216
s_nop 0
    buffer_load_dwordx4 v16, s[8:11], s3 offen lds
    s_xor_b32 s3, s38, 3407872
    s_add_u32 m0, s36, 10240
s_nop 0
    buffer_load_dwordx4 v16, s[8:11], s3 offen lds
    s_xor_b32 s3, s38, 3424256
    s_add_u32 m0, s36, 11264
s_nop 0
    buffer_load_dwordx4 v16, s[8:11], s3 offen lds
    s_xor_b32 s3, s38, 3670016
    s_add_u32 m0, s36, 12288
s_nop 0
    buffer_load_dwordx4 v16, s[8:11], s3 offen lds
    s_xor_b32 s3, s38, 3686400
    s_add_u32 m0, s36, 13312
s_nop 0
    buffer_load_dwordx4 v16, s[8:11], s3 offen lds
    s_xor_b32 s3, s38, 3932160
    s_add_u32 m0, s36, 14336
s_nop 0
    buffer_load_dwordx4 v16, s[8:11], s3 offen lds
    s_xor_b32 s3, s38, 3948544
    s_add_u32 m0, s36, 15360
s_nop 0
    buffer_load_dwordx4 v16, s[8:11], s3 offen lds
    s_mov_b32 s8, s44
    s_mov_b32 s9, s45
    s_xor_b32 s3, s38, 0
    s_add_u32 m0, s36, 16384
s_nop 0
    buffer_load_dwordx4 v16, s[8:11], s3 offen lds
    s_xor_b32 s3, s38, 16384
    s_add_u32 m0, s36, 17408
s_nop 0
    buffer_load_dwordx4 v16, s[8:11], s3 offen lds
    s_xor_b32 s3, s38, 262144
    s_add_u32 m0, s36, 18432
s_nop 0
    buffer_load_dwordx4 v16, s[8:11], s3 offen lds
    s_xor_b32 s3, s38, 278528
    s_add_u32 m0, s36, 19456
s_nop 0
    buffer_load_dwordx4 v16, s[8:11], s3 offen lds
    s_xor_b32 s3, s38, 524288
    s_add_u32 m0, s36, 20480
s_nop 0
    buffer_load_dwordx4 v16, s[8:11], s3 offen lds
    s_xor_b32 s3, s38, 540672
    s_add_u32 m0, s36, 21504
s_nop 0
    buffer_load_dwordx4 v16, s[8:11], s3 offen lds
    s_xor_b32 s3, s38, 786432
    s_add_u32 m0, s36, 22528
s_nop 0
    buffer_load_dwordx4 v16, s[8:11], s3 offen lds
    s_xor_b32 s3, s38, 802816
    s_add_u32 m0, s36, 23552
s_nop 0
    buffer_load_dwordx4 v16, s[8:11], s3 offen lds
    s_xor_b32 s3, s38, 1048576
    s_add_u32 m0, s36, 24576
s_nop 0
    buffer_load_dwordx4 v16, s[8:11], s3 offen lds
    s_xor_b32 s3, s38, 1064960
    s_add_u32 m0, s36, 25600
s_nop 0
    buffer_load_dwordx4 v16, s[8:11], s3 offen lds
    s_xor_b32 s3, s38, 1310720
    s_add_u32 m0, s36, 26624
s_nop 0
    buffer_load_dwordx4 v16, s[8:11], s3 offen lds
    s_xor_b32 s3, s38, 1327104
    s_add_u32 m0, s36, 27648
s_nop 0
    buffer_load_dwordx4 v16, s[8:11], s3 offen lds
    s_xor_b32 s3, s38, 1572864
    s_add_u32 m0, s36, 28672
s_nop 0
    buffer_load_dwordx4 v16, s[8:11], s3 offen lds
    s_xor_b32 s3, s38, 1589248
    s_add_u32 m0, s36, 29696
s_nop 0
    buffer_load_dwordx4 v16, s[8:11], s3 offen lds
    s_xor_b32 s3, s38, 1835008
    s_add_u32 m0, s36, 30720
s_nop 0
    buffer_load_dwordx4 v16, s[8:11], s3 offen lds
    s_xor_b32 s3, s38, 1851392
    s_add_u32 m0, s36, 31744
s_nop 0
    buffer_load_dwordx4 v16, s[8:11], s3 offen lds

    s_waitcnt vmcnt(32)
    s_mov_b32 s23, 524288
    s_mov_b32 s24, 532480
    buffer_store_dword v22, v119, s[4:7], s23 offen sc1
    buffer_store_dword v24, v119, s[4:7], s24 offen sc1
    buffer_store_dwordx4 v[24:27], v112, s[4:7], s22 offen sc1
    buffer_store_dwordx4 v[24:27], v112, s[4:7], s22 offen offset:1024 sc1
    s_xor_b32 s22, s22, 0x40000
    buffer_store_dwordx4 v[24:27], v112, s[4:7], s22 offen sc1
    buffer_store_dwordx4 v[24:27], v112, s[4:7], s22 offen offset:1024 sc1
    s_lshl_b32 s40, s14, 2
    s_add_u32 s40, s40, s15
    s_lshl_b32 s40, s40, 8
    s_add_u32 s40, s40, 80871424
    v_lshlrev_b32 v28, 2, v0
    v_mov_b32 v29, 0
    buffer_store_dword v29, v28, s[4:7], s40 offen sc1

    s_waitcnt vmcnt(35)
    ds_read_b64_tr_b16 a[0:1], v18 offset:0
    ds_read_b64_tr_b16 a[2:3], v18 offset:1024
    ds_read_b64_tr_b16 a[4:5], v18 offset:2048
    ds_read_b64_tr_b16 a[6:7], v18 offset:3072
    ds_read_b64_tr_b16 a[8:9], v19 offset:0
    ds_read_b64_tr_b16 a[10:11], v19 offset:1024
    ds_read_b64_tr_b16 a[12:13], v19 offset:2048
    ds_read_b64_tr_b16 a[14:15], v19 offset:3072
    s_waitcnt lgkmcnt(0)
    s_xor_b32 s3, s38, 2097152
    s_add_u32 m0, s36, 0
s_nop 0
    buffer_load_dwordx4 v16, s[8:11], s3 offen lds
    s_xor_b32 s3, s38, 2113536
    s_add_u32 m0, s36, 1024
s_nop 0
    buffer_load_dwordx4 v16, s[8:11], s3 offen lds
    s_xor_b32 s3, s38, 2359296
    s_add_u32 m0, s36, 2048
s_nop 0
    buffer_load_dwordx4 v16, s[8:11], s3 offen lds
    s_xor_b32 s3, s38, 2375680
    s_add_u32 m0, s36, 3072
s_nop 0
    buffer_load_dwordx4 v16, s[8:11], s3 offen lds
    s_waitcnt vmcnt(35)
    ds_read_b64_tr_b16 a[16:17], v18 offset:4096
    ds_read_b64_tr_b16 a[18:19], v18 offset:5120
    ds_read_b64_tr_b16 a[20:21], v18 offset:6144
    ds_read_b64_tr_b16 a[22:23], v18 offset:7168
    ds_read_b64_tr_b16 a[24:25], v19 offset:4096
    ds_read_b64_tr_b16 a[26:27], v19 offset:5120
    ds_read_b64_tr_b16 a[28:29], v19 offset:6144
    ds_read_b64_tr_b16 a[30:31], v19 offset:7168
    s_waitcnt lgkmcnt(0)
    s_xor_b32 s3, s38, 2621440
    s_add_u32 m0, s36, 4096
s_nop 0
    buffer_load_dwordx4 v16, s[8:11], s3 offen lds
    s_xor_b32 s3, s38, 2637824
    s_add_u32 m0, s36, 5120
s_nop 0
    buffer_load_dwordx4 v16, s[8:11], s3 offen lds
    s_xor_b32 s3, s38, 2883584
    s_add_u32 m0, s36, 6144
s_nop 0
    buffer_load_dwordx4 v16, s[8:11], s3 offen lds
    s_xor_b32 s3, s38, 2899968
    s_add_u32 m0, s36, 7168
s_nop 0
    buffer_load_dwordx4 v16, s[8:11], s3 offen lds
    s_waitcnt vmcnt(35)
    ds_read_b64_tr_b16 a[32:33], v18 offset:8192
    ds_read_b64_tr_b16 a[34:35], v18 offset:9216
    ds_read_b64_tr_b16 a[36:37], v18 offset:10240
    ds_read_b64_tr_b16 a[38:39], v18 offset:11264
    ds_read_b64_tr_b16 a[40:41], v19 offset:8192
    ds_read_b64_tr_b16 a[42:43], v19 offset:9216
    ds_read_b64_tr_b16 a[44:45], v19 offset:10240
    ds_read_b64_tr_b16 a[46:47], v19 offset:11264
    s_waitcnt lgkmcnt(0)
    s_xor_b32 s3, s38, 3145728
    s_add_u32 m0, s36, 8192
s_nop 0
    buffer_load_dwordx4 v16, s[8:11], s3 offen lds
    s_xor_b32 s3, s38, 3162112
    s_add_u32 m0, s36, 9216
s_nop 0
    buffer_load_dwordx4 v16, s[8:11], s3 offen lds
    s_xor_b32 s3, s38, 3407872
    s_add_u32 m0, s36, 10240
s_nop 0
    buffer_load_dwordx4 v16, s[8:11], s3 offen lds
    s_xor_b32 s3, s38, 3424256
    s_add_u32 m0, s36, 11264
s_nop 0
    buffer_load_dwordx4 v16, s[8:11], s3 offen lds
    s_waitcnt vmcnt(35)
    ds_read_b64_tr_b16 a[48:49], v18 offset:12288
    ds_read_b64_tr_b16 a[50:51], v18 offset:13312
    ds_read_b64_tr_b16 a[52:53], v18 offset:14336
    ds_read_b64_tr_b16 a[54:55], v18 offset:15360
    ds_read_b64_tr_b16 a[56:57], v19 offset:12288
    ds_read_b64_tr_b16 a[58:59], v19 offset:13312
    ds_read_b64_tr_b16 a[60:61], v19 offset:14336
    ds_read_b64_tr_b16 a[62:63], v19 offset:15360
    s_waitcnt lgkmcnt(0)
    s_xor_b32 s3, s38, 3670016
    s_add_u32 m0, s36, 12288
s_nop 0
    buffer_load_dwordx4 v16, s[8:11], s3 offen lds
    s_xor_b32 s3, s38, 3686400
    s_add_u32 m0, s36, 13312
s_nop 0
    buffer_load_dwordx4 v16, s[8:11], s3 offen lds
    s_xor_b32 s3, s38, 3932160
    s_add_u32 m0, s36, 14336
s_nop 0
    buffer_load_dwordx4 v16, s[8:11], s3 offen lds
    s_xor_b32 s3, s38, 3948544
    s_add_u32 m0, s36, 15360
s_nop 0
    buffer_load_dwordx4 v16, s[8:11], s3 offen lds
    s_waitcnt vmcnt(35)
    ds_read_b64_tr_b16 a[64:65], v18 offset:16384
    ds_read_b64_tr_b16 a[66:67], v18 offset:17408
    ds_read_b64_tr_b16 a[68:69], v18 offset:18432
    ds_read_b64_tr_b16 a[70:71], v18 offset:19456
    ds_read_b64_tr_b16 a[72:73], v19 offset:16384
    ds_read_b64_tr_b16 a[74:75], v19 offset:17408
    ds_read_b64_tr_b16 a[76:77], v19 offset:18432
    ds_read_b64_tr_b16 a[78:79], v19 offset:19456
    s_waitcnt lgkmcnt(0)
    s_mov_b32 s8, s46
    s_mov_b32 s9, s47
    s_xor_b32 s3, s38, 0
    s_add_u32 m0, s36, 16384
s_nop 0
    buffer_load_dwordx4 v16, s[8:11], s3 offen lds
    s_xor_b32 s3, s38, 16384
    s_add_u32 m0, s36, 17408
s_nop 0
    buffer_load_dwordx4 v16, s[8:11], s3 offen lds
    s_xor_b32 s3, s38, 262144
    s_add_u32 m0, s36, 18432
s_nop 0
    buffer_load_dwordx4 v16, s[8:11], s3 offen lds
    s_xor_b32 s3, s38, 278528
    s_add_u32 m0, s36, 19456
s_nop 0
    buffer_load_dwordx4 v16, s[8:11], s3 offen lds
    s_waitcnt vmcnt(35)
    ds_read_b64_tr_b16 a[80:81], v18 offset:20480
    ds_read_b64_tr_b16 a[82:83], v18 offset:21504
    ds_read_b64_tr_b16 a[84:85], v18 offset:22528
    ds_read_b64_tr_b16 a[86:87], v18 offset:23552
    ds_read_b64_tr_b16 a[88:89], v19 offset:20480
    ds_read_b64_tr_b16 a[90:91], v19 offset:21504
    ds_read_b64_tr_b16 a[92:93], v19 offset:22528
    ds_read_b64_tr_b16 a[94:95], v19 offset:23552
    s_waitcnt lgkmcnt(0)
    s_xor_b32 s3, s38, 524288
    s_add_u32 m0, s36, 20480
s_nop 0
    buffer_load_dwordx4 v16, s[8:11], s3 offen lds
    s_xor_b32 s3, s38, 540672
    s_add_u32 m0, s36, 21504
s_nop 0
    buffer_load_dwordx4 v16, s[8:11], s3 offen lds
    s_xor_b32 s3, s38, 786432
    s_add_u32 m0, s36, 22528
s_nop 0
    buffer_load_dwordx4 v16, s[8:11], s3 offen lds
    s_xor_b32 s3, s38, 802816
    s_add_u32 m0, s36, 23552
s_nop 0
    buffer_load_dwordx4 v16, s[8:11], s3 offen lds
    s_waitcnt vmcnt(35)
    ds_read_b64_tr_b16 a[96:97], v18 offset:24576
    ds_read_b64_tr_b16 a[98:99], v18 offset:25600
    ds_read_b64_tr_b16 a[100:101], v18 offset:26624
    ds_read_b64_tr_b16 a[102:103], v18 offset:27648
    ds_read_b64_tr_b16 a[104:105], v19 offset:24576
    ds_read_b64_tr_b16 a[106:107], v19 offset:25600
    ds_read_b64_tr_b16 a[108:109], v19 offset:26624
    ds_read_b64_tr_b16 a[110:111], v19 offset:27648
    s_waitcnt lgkmcnt(0)
    s_xor_b32 s3, s38, 1048576
    s_add_u32 m0, s36, 24576
s_nop 0
    buffer_load_dwordx4 v16, s[8:11], s3 offen lds
    s_xor_b32 s3, s38, 1064960
    s_add_u32 m0, s36, 25600
s_nop 0
    buffer_load_dwordx4 v16, s[8:11], s3 offen lds
    s_xor_b32 s3, s38, 1310720
    s_add_u32 m0, s36, 26624
s_nop 0
    buffer_load_dwordx4 v16, s[8:11], s3 offen lds
    s_xor_b32 s3, s38, 1327104
    s_add_u32 m0, s36, 27648
s_nop 0
    buffer_load_dwordx4 v16, s[8:11], s3 offen lds
    s_waitcnt vmcnt(35)
    ds_read_b64_tr_b16 a[112:113], v18 offset:28672
    ds_read_b64_tr_b16 a[114:115], v18 offset:29696
    ds_read_b64_tr_b16 a[116:117], v18 offset:30720
    ds_read_b64_tr_b16 a[118:119], v18 offset:31744
    ds_read_b64_tr_b16 a[120:121], v19 offset:28672
    ds_read_b64_tr_b16 a[122:123], v19 offset:29696
    ds_read_b64_tr_b16 a[124:125], v19 offset:30720
    ds_read_b64_tr_b16 a[126:127], v19 offset:31744
    s_waitcnt lgkmcnt(0)
    s_xor_b32 s3, s38, 1572864
    s_add_u32 m0, s36, 28672
s_nop 0
    buffer_load_dwordx4 v16, s[8:11], s3 offen lds
    s_xor_b32 s3, s38, 1589248
    s_add_u32 m0, s36, 29696
s_nop 0
    buffer_load_dwordx4 v16, s[8:11], s3 offen lds
    s_xor_b32 s3, s38, 1835008
    s_add_u32 m0, s36, 30720
s_nop 0
    buffer_load_dwordx4 v16, s[8:11], s3 offen lds
    s_xor_b32 s3, s38, 1851392
    s_add_u32 m0, s36, 31744
s_nop 0
    buffer_load_dwordx4 v16, s[8:11], s3 offen lds
    s_waitcnt vmcnt(28)
    ds_read_b64_tr_b16 a[128:129], v18 offset:0
    ds_read_b64_tr_b16 a[130:131], v18 offset:1024
    ds_read_b64_tr_b16 a[132:133], v18 offset:2048
    ds_read_b64_tr_b16 a[134:135], v18 offset:3072
    ds_read_b64_tr_b16 a[136:137], v19 offset:0
    ds_read_b64_tr_b16 a[138:139], v19 offset:1024
    ds_read_b64_tr_b16 a[140:141], v19 offset:2048
    ds_read_b64_tr_b16 a[142:143], v19 offset:3072
    s_waitcnt lgkmcnt(0)
    s_xor_b32 s3, s38, 2097152
    s_add_u32 m0, s36, 0
s_nop 0
    buffer_load_dwordx4 v16, s[8:11], s3 offen lds
    s_xor_b32 s3, s38, 2113536
    s_add_u32 m0, s36, 1024
s_nop 0
    buffer_load_dwordx4 v16, s[8:11], s3 offen lds
    s_xor_b32 s3, s38, 2359296
    s_add_u32 m0, s36, 2048
s_nop 0
    buffer_load_dwordx4 v16, s[8:11], s3 offen lds
    s_xor_b32 s3, s38, 2375680
    s_add_u32 m0, s36, 3072
s_nop 0
    buffer_load_dwordx4 v16, s[8:11], s3 offen lds

    v_mov_b32 v22, 1
    v_mov_b32 v23, 128
    s_mov_b64 exec, 1
    global_atomic_add v23, v22, s[12:13] sc1
    s_mov_b64 exec, -1

    s_waitcnt vmcnt(29)
    ds_read_b64_tr_b16 a[144:145], v18 offset:4096
    ds_read_b64_tr_b16 a[146:147], v18 offset:5120
    ds_read_b64_tr_b16 a[148:149], v18 offset:6144
    ds_read_b64_tr_b16 a[150:151], v18 offset:7168
    ds_read_b64_tr_b16 a[152:153], v19 offset:4096
    ds_read_b64_tr_b16 a[154:155], v19 offset:5120
    ds_read_b64_tr_b16 a[156:157], v19 offset:6144
    ds_read_b64_tr_b16 a[158:159], v19 offset:7168
    s_waitcnt lgkmcnt(0)
    s_xor_b32 s3, s38, 2621440
    s_add_u32 m0, s36, 4096
s_nop 0
    buffer_load_dwordx4 v16, s[8:11], s3 offen lds
    s_xor_b32 s3, s38, 2637824
    s_add_u32 m0, s36, 5120
s_nop 0
    buffer_load_dwordx4 v16, s[8:11], s3 offen lds
    s_xor_b32 s3, s38, 2883584
    s_add_u32 m0, s36, 6144
s_nop 0
    buffer_load_dwordx4 v16, s[8:11], s3 offen lds
    s_xor_b32 s3, s38, 2899968
    s_add_u32 m0, s36, 7168
s_nop 0
    buffer_load_dwordx4 v16, s[8:11], s3 offen lds
    s_waitcnt vmcnt(29)
    ds_read_b64_tr_b16 a[160:161], v18 offset:8192
    ds_read_b64_tr_b16 a[162:163], v18 offset:9216
    ds_read_b64_tr_b16 a[164:165], v18 offset:10240
    ds_read_b64_tr_b16 a[166:167], v18 offset:11264
    ds_read_b64_tr_b16 a[168:169], v19 offset:8192
    ds_read_b64_tr_b16 a[170:171], v19 offset:9216
    ds_read_b64_tr_b16 a[172:173], v19 offset:10240
    ds_read_b64_tr_b16 a[174:175], v19 offset:11264
    s_waitcnt lgkmcnt(0)
    s_xor_b32 s3, s38, 3145728
    s_add_u32 m0, s36, 8192
s_nop 0
    buffer_load_dwordx4 v16, s[8:11], s3 offen lds
    s_xor_b32 s3, s38, 3162112
    s_add_u32 m0, s36, 9216
s_nop 0
    buffer_load_dwordx4 v16, s[8:11], s3 offen lds
    s_xor_b32 s3, s38, 3407872
    s_add_u32 m0, s36, 10240
s_nop 0
    buffer_load_dwordx4 v16, s[8:11], s3 offen lds
    s_xor_b32 s3, s38, 3424256
    s_add_u32 m0, s36, 11264
s_nop 0
    buffer_load_dwordx4 v16, s[8:11], s3 offen lds
    s_waitcnt vmcnt(29)
    ds_read_b64_tr_b16 a[176:177], v18 offset:12288
    ds_read_b64_tr_b16 a[178:179], v18 offset:13312
    ds_read_b64_tr_b16 a[180:181], v18 offset:14336
    ds_read_b64_tr_b16 a[182:183], v18 offset:15360
    ds_read_b64_tr_b16 a[184:185], v19 offset:12288
    ds_read_b64_tr_b16 a[186:187], v19 offset:13312
    ds_read_b64_tr_b16 a[188:189], v19 offset:14336
    ds_read_b64_tr_b16 a[190:191], v19 offset:15360
    s_waitcnt lgkmcnt(0)
    s_xor_b32 s3, s38, 3670016
    s_add_u32 m0, s36, 12288
s_nop 0
    buffer_load_dwordx4 v16, s[8:11], s3 offen lds
    s_xor_b32 s3, s38, 3686400
    s_add_u32 m0, s36, 13312
s_nop 0
    buffer_load_dwordx4 v16, s[8:11], s3 offen lds
    s_xor_b32 s3, s38, 3932160
    s_add_u32 m0, s36, 14336
s_nop 0
    buffer_load_dwordx4 v16, s[8:11], s3 offen lds
    s_xor_b32 s3, s38, 3948544
    s_add_u32 m0, s36, 15360
s_nop 0
    buffer_load_dwordx4 v16, s[8:11], s3 offen lds
    s_waitcnt vmcnt(29)
    ds_read_b64_tr_b16 a[192:193], v18 offset:16384
    ds_read_b64_tr_b16 a[194:195], v18 offset:17408
    ds_read_b64_tr_b16 a[196:197], v18 offset:18432
    ds_read_b64_tr_b16 a[198:199], v18 offset:19456
    ds_read_b64_tr_b16 a[200:201], v19 offset:16384
    ds_read_b64_tr_b16 a[202:203], v19 offset:17408
    ds_read_b64_tr_b16 a[204:205], v19 offset:18432
    ds_read_b64_tr_b16 a[206:207], v19 offset:19456
    s_waitcnt lgkmcnt(0)
    s_mov_b32 s8, s48
    s_mov_b32 s9, s49
    s_xor_b32 s3, s39, 0
    s_add_u32 m0, s36, 16384
s_nop 0
    buffer_load_dwordx4 v17, s[8:11], s3 offen lds
    s_xor_b32 s3, s39, 16384
    s_add_u32 m0, s36, 17408
s_nop 0
    buffer_load_dwordx4 v17, s[8:11], s3 offen lds
    s_xor_b32 s3, s39, 32768
    s_add_u32 m0, s36, 18432
s_nop 0
    buffer_load_dwordx4 v17, s[8:11], s3 offen lds
    s_xor_b32 s3, s39, 49152
    s_add_u32 m0, s36, 19456
s_nop 0
    buffer_load_dwordx4 v17, s[8:11], s3 offen lds
    s_waitcnt vmcnt(29)
    ds_read_b64_tr_b16 a[208:209], v18 offset:20480
    ds_read_b64_tr_b16 a[210:211], v18 offset:21504
    ds_read_b64_tr_b16 a[212:213], v18 offset:22528
    ds_read_b64_tr_b16 a[214:215], v18 offset:23552
    ds_read_b64_tr_b16 a[216:217], v19 offset:20480
    ds_read_b64_tr_b16 a[218:219], v19 offset:21504
    ds_read_b64_tr_b16 a[220:221], v19 offset:22528
    ds_read_b64_tr_b16 a[222:223], v19 offset:23552
    s_waitcnt lgkmcnt(0)
    s_xor_b32 s3, s39, 65536
    s_add_u32 m0, s36, 20480
s_nop 0
    buffer_load_dwordx4 v17, s[8:11], s3 offen lds
    s_xor_b32 s3, s39, 81920
    s_add_u32 m0, s36, 21504
s_nop 0
    buffer_load_dwordx4 v17, s[8:11], s3 offen lds
    s_xor_b32 s3, s39, 98304
    s_add_u32 m0, s36, 22528
s_nop 0
    buffer_load_dwordx4 v17, s[8:11], s3 offen lds
    s_xor_b32 s3, s39, 114688
    s_add_u32 m0, s36, 23552
s_nop 0
    buffer_load_dwordx4 v17, s[8:11], s3 offen lds
    s_waitcnt vmcnt(29)
    ds_read_b64_tr_b16 a[224:225], v18 offset:24576
    ds_read_b64_tr_b16 a[226:227], v18 offset:25600
    ds_read_b64_tr_b16 a[228:229], v18 offset:26624
    ds_read_b64_tr_b16 a[230:231], v18 offset:27648
    ds_read_b64_tr_b16 a[232:233], v19 offset:24576
    ds_read_b64_tr_b16 a[234:235], v19 offset:25600
    ds_read_b64_tr_b16 a[236:237], v19 offset:26624
    ds_read_b64_tr_b16 a[238:239], v19 offset:27648
    s_waitcnt lgkmcnt(0)
    s_xor_b32 s3, s39, 256
    s_add_u32 m0, s36, 24576
s_nop 0
    buffer_load_dwordx4 v17, s[8:11], s3 offen lds
    s_xor_b32 s3, s39, 16640
    s_add_u32 m0, s36, 25600
s_nop 0
    buffer_load_dwordx4 v17, s[8:11], s3 offen lds
    s_xor_b32 s3, s39, 33024
    s_add_u32 m0, s36, 26624
s_nop 0
    buffer_load_dwordx4 v17, s[8:11], s3 offen lds
    s_xor_b32 s3, s39, 49408
    s_add_u32 m0, s36, 27648
s_nop 0
    buffer_load_dwordx4 v17, s[8:11], s3 offen lds
    s_waitcnt vmcnt(29)
    ds_read_b64_tr_b16 a[240:241], v18 offset:28672
    ds_read_b64_tr_b16 a[242:243], v18 offset:29696
    ds_read_b64_tr_b16 a[244:245], v18 offset:30720
    ds_read_b64_tr_b16 a[246:247], v18 offset:31744
    ds_read_b64_tr_b16 a[248:249], v19 offset:28672
    ds_read_b64_tr_b16 a[250:251], v19 offset:29696
    ds_read_b64_tr_b16 a[252:253], v19 offset:30720
    ds_read_b64_tr_b16 a[254:255], v19 offset:31744
    s_waitcnt lgkmcnt(0)
    s_xor_b32 s3, s39, 65792
    s_add_u32 m0, s36, 28672
s_nop 0
    buffer_load_dwordx4 v17, s[8:11], s3 offen lds
    s_xor_b32 s3, s39, 82176
    s_add_u32 m0, s36, 29696
s_nop 0
    buffer_load_dwordx4 v17, s[8:11], s3 offen lds
    s_xor_b32 s3, s39, 98560
    s_add_u32 m0, s36, 30720
s_nop 0
    buffer_load_dwordx4 v17, s[8:11], s3 offen lds
    s_xor_b32 s3, s39, 114944
    s_add_u32 m0, s36, 31744
s_nop 0
    buffer_load_dwordx4 v17, s[8:11], s3 offen lds
    s_waitcnt vmcnt(29)
    ds_read_b64_tr_b16 v[128:129], v18 offset:0
    ds_read_b64_tr_b16 v[130:131], v18 offset:1024
    ds_read_b64_tr_b16 v[132:133], v18 offset:2048
    ds_read_b64_tr_b16 v[134:135], v18 offset:3072
    ds_read_b64_tr_b16 v[136:137], v19 offset:0
    ds_read_b64_tr_b16 v[138:139], v19 offset:1024
    ds_read_b64_tr_b16 v[140:141], v19 offset:2048
    ds_read_b64_tr_b16 v[142:143], v19 offset:3072
    s_waitcnt lgkmcnt(0)
    s_mov_b32 s8, s42
    s_mov_b32 s9, s43
    s_xor_b32 s3, s38, 0
    s_add_u32 m0, s36, 0
s_nop 0
    buffer_load_dwordx4 v16, s[8:11], s3 offen lds
    s_xor_b32 s3, s38, 16384
    s_add_u32 m0, s36, 1024
s_nop 0
    buffer_load_dwordx4 v16, s[8:11], s3 offen lds
    s_xor_b32 s3, s38, 262144
    s_add_u32 m0, s36, 2048
s_nop 0
    buffer_load_dwordx4 v16, s[8:11], s3 offen lds
    s_xor_b32 s3, s38, 278528
    s_add_u32 m0, s36, 3072
s_nop 0
    buffer_load_dwordx4 v16, s[8:11], s3 offen lds
    s_waitcnt vmcnt(28)
    ds_read_b64_tr_b16 v[144:145], v18 offset:4096
    ds_read_b64_tr_b16 v[146:147], v18 offset:5120
    ds_read_b64_tr_b16 v[148:149], v18 offset:6144
    ds_read_b64_tr_b16 v[150:151], v18 offset:7168
    ds_read_b64_tr_b16 v[152:153], v19 offset:4096
    ds_read_b64_tr_b16 v[154:155], v19 offset:5120
    ds_read_b64_tr_b16 v[156:157], v19 offset:6144
    ds_read_b64_tr_b16 v[158:159], v19 offset:7168
    s_waitcnt lgkmcnt(0)
    s_xor_b32 s3, s38, 524288
    s_add_u32 m0, s36, 4096
s_nop 0
    buffer_load_dwordx4 v16, s[8:11], s3 offen lds
    s_xor_b32 s3, s38, 540672
    s_add_u32 m0, s36, 5120
s_nop 0
    buffer_load_dwordx4 v16, s[8:11], s3 offen lds
    s_xor_b32 s3, s38, 786432
    s_add_u32 m0, s36, 6144
s_nop 0
    buffer_load_dwordx4 v16, s[8:11], s3 offen lds
    s_xor_b32 s3, s38, 802816
    s_add_u32 m0, s36, 7168
s_nop 0
    buffer_load_dwordx4 v16, s[8:11], s3 offen lds
    s_waitcnt vmcnt(28)
    ds_read_b64_tr_b16 v[160:161], v18 offset:8192
    ds_read_b64_tr_b16 v[162:163], v18 offset:9216
    ds_read_b64_tr_b16 v[164:165], v18 offset:10240
    ds_read_b64_tr_b16 v[166:167], v18 offset:11264
    ds_read_b64_tr_b16 v[168:169], v19 offset:8192
    ds_read_b64_tr_b16 v[170:171], v19 offset:9216
    ds_read_b64_tr_b16 v[172:173], v19 offset:10240
    ds_read_b64_tr_b16 v[174:175], v19 offset:11264
    s_waitcnt lgkmcnt(0)
    s_xor_b32 s3, s38, 1048576
    s_add_u32 m0, s36, 8192
s_nop 0
    buffer_load_dwordx4 v16, s[8:11], s3 offen lds
    s_xor_b32 s3, s38, 1064960
    s_add_u32 m0, s36, 9216
s_nop 0
    buffer_load_dwordx4 v16, s[8:11], s3 offen lds
    s_xor_b32 s3, s38, 1310720
    s_add_u32 m0, s36, 10240
s_nop 0
    buffer_load_dwordx4 v16, s[8:11], s3 offen lds
    s_xor_b32 s3, s38, 1327104
    s_add_u32 m0, s36, 11264
s_nop 0
    buffer_load_dwordx4 v16, s[8:11], s3 offen lds
    s_waitcnt vmcnt(28)
    ds_read_b64_tr_b16 v[176:177], v18 offset:12288
    ds_read_b64_tr_b16 v[178:179], v18 offset:13312
    ds_read_b64_tr_b16 v[180:181], v18 offset:14336
    ds_read_b64_tr_b16 v[182:183], v18 offset:15360
    ds_read_b64_tr_b16 v[184:185], v19 offset:12288
    ds_read_b64_tr_b16 v[186:187], v19 offset:13312
    ds_read_b64_tr_b16 v[188:189], v19 offset:14336
    ds_read_b64_tr_b16 v[190:191], v19 offset:15360
    s_waitcnt lgkmcnt(0)
    s_xor_b32 s3, s38, 1572864
    s_add_u32 m0, s36, 12288
s_nop 0
    buffer_load_dwordx4 v16, s[8:11], s3 offen lds
    s_xor_b32 s3, s38, 1589248
    s_add_u32 m0, s36, 13312
s_nop 0
    buffer_load_dwordx4 v16, s[8:11], s3 offen lds
    s_xor_b32 s3, s38, 1835008
    s_add_u32 m0, s36, 14336
s_nop 0
    buffer_load_dwordx4 v16, s[8:11], s3 offen lds
    s_xor_b32 s3, s38, 1851392
    s_add_u32 m0, s36, 15360
s_nop 0
    buffer_load_dwordx4 v16, s[8:11], s3 offen lds
    s_waitcnt vmcnt(28)
    ds_read_b64_tr_b16 v[192:193], v20 offset:16384
    ds_read_b64_tr_b16 v[194:195], v21 offset:16384
    ds_read_b64_tr_b16 v[196:197], v20 offset:17408
    ds_read_b64_tr_b16 v[198:199], v21 offset:17408
    ds_read_b64_tr_b16 v[200:201], v20 offset:18432
    ds_read_b64_tr_b16 v[202:203], v21 offset:18432
    ds_read_b64_tr_b16 v[204:205], v20 offset:19456
    ds_read_b64_tr_b16 v[206:207], v21 offset:19456
    s_waitcnt lgkmcnt(0)
    s_mov_b32 s8, s48
    s_mov_b32 s9, s49
    s_xor_b32 s3, s39, 512
    s_add_u32 m0, s36, 16384
s_nop 0
    buffer_load_dwordx4 v17, s[8:11], s3 offen lds
    s_xor_b32 s3, s39, 16896
    s_add_u32 m0, s36, 17408
s_nop 0
    buffer_load_dwordx4 v17, s[8:11], s3 offen lds
    s_xor_b32 s3, s39, 33280
    s_add_u32 m0, s36, 18432
s_nop 0
    buffer_load_dwordx4 v17, s[8:11], s3 offen lds
    s_xor_b32 s3, s39, 49664
    s_add_u32 m0, s36, 19456
s_nop 0
    buffer_load_dwordx4 v17, s[8:11], s3 offen lds
    s_waitcnt vmcnt(28)
    ds_read_b64_tr_b16 v[208:209], v20 offset:20480
    ds_read_b64_tr_b16 v[210:211], v21 offset:20480
    ds_read_b64_tr_b16 v[212:213], v20 offset:21504
    ds_read_b64_tr_b16 v[214:215], v21 offset:21504
    ds_read_b64_tr_b16 v[216:217], v20 offset:22528
    ds_read_b64_tr_b16 v[218:219], v21 offset:22528
    ds_read_b64_tr_b16 v[220:221], v20 offset:23552
    ds_read_b64_tr_b16 v[222:223], v21 offset:23552
    s_waitcnt lgkmcnt(0)
    s_xor_b32 s3, s39, 66048
    s_add_u32 m0, s36, 20480
s_nop 0
    buffer_load_dwordx4 v17, s[8:11], s3 offen lds
    s_xor_b32 s3, s39, 82432
    s_add_u32 m0, s36, 21504
s_nop 0
    buffer_load_dwordx4 v17, s[8:11], s3 offen lds
    s_xor_b32 s3, s39, 98816
    s_add_u32 m0, s36, 22528
s_nop 0
    buffer_load_dwordx4 v17, s[8:11], s3 offen lds
    s_xor_b32 s3, s39, 115200
    s_add_u32 m0, s36, 23552
s_nop 0
    buffer_load_dwordx4 v17, s[8:11], s3 offen lds
    s_waitcnt vmcnt(28)
    ds_read_b64_tr_b16 v[224:225], v20 offset:24576
    ds_read_b64_tr_b16 v[226:227], v21 offset:24576
    ds_read_b64_tr_b16 v[228:229], v20 offset:25600
    ds_read_b64_tr_b16 v[230:231], v21 offset:25600
    ds_read_b64_tr_b16 v[232:233], v20 offset:26624
    ds_read_b64_tr_b16 v[234:235], v21 offset:26624
    ds_read_b64_tr_b16 v[236:237], v20 offset:27648
    ds_read_b64_tr_b16 v[238:239], v21 offset:27648
    s_waitcnt lgkmcnt(0)
    s_xor_b32 s3, s39, 768
    s_add_u32 m0, s36, 24576
s_nop 0
    buffer_load_dwordx4 v17, s[8:11], s3 offen lds
    s_xor_b32 s3, s39, 17152
    s_add_u32 m0, s36, 25600
s_nop 0
    buffer_load_dwordx4 v17, s[8:11], s3 offen lds
    s_xor_b32 s3, s39, 33536
    s_add_u32 m0, s36, 26624
s_nop 0
    buffer_load_dwordx4 v17, s[8:11], s3 offen lds
    s_xor_b32 s3, s39, 49920
    s_add_u32 m0, s36, 27648
s_nop 0
    buffer_load_dwordx4 v17, s[8:11], s3 offen lds
    s_waitcnt vmcnt(28)
    ds_read_b64_tr_b16 v[240:241], v20 offset:28672
    ds_read_b64_tr_b16 v[242:243], v21 offset:28672
    ds_read_b64_tr_b16 v[244:245], v20 offset:29696
    ds_read_b64_tr_b16 v[246:247], v21 offset:29696
    ds_read_b64_tr_b16 v[248:249], v20 offset:30720
    ds_read_b64_tr_b16 v[250:251], v21 offset:30720
    ds_read_b64_tr_b16 v[252:253], v20 offset:31744
    ds_read_b64_tr_b16 v[254:255], v21 offset:31744
    s_waitcnt lgkmcnt(0)
    s_xor_b32 s3, s39, 66304
    s_add_u32 m0, s36, 28672
s_nop 0
    buffer_load_dwordx4 v17, s[8:11], s3 offen lds
    s_xor_b32 s3, s39, 82688
    s_add_u32 m0, s36, 29696
s_nop 0
    buffer_load_dwordx4 v17, s[8:11], s3 offen lds
    s_xor_b32 s3, s39, 99072
    s_add_u32 m0, s36, 30720
s_nop 0
    buffer_load_dwordx4 v17, s[8:11], s3 offen lds
    s_xor_b32 s3, s39, 115456
    s_add_u32 m0, s36, 31744
s_nop 0
    buffer_load_dwordx4 v17, s[8:11], s3 offen lds
    s_waitcnt vmcnt(28)
    ds_read_b64_tr_b16 v[32:33], v18 offset:0
    ds_read_b64_tr_b16 v[34:35], v18 offset:1024
    ds_read_b64_tr_b16 v[36:37], v18 offset:2048
    ds_read_b64_tr_b16 v[38:39], v18 offset:3072
    ds_read_b64_tr_b16 v[40:41], v19 offset:0
    ds_read_b64_tr_b16 v[42:43], v19 offset:1024
    ds_read_b64_tr_b16 v[44:45], v19 offset:2048
    ds_read_b64_tr_b16 v[46:47], v19 offset:3072
    s_waitcnt lgkmcnt(0)
    ds_write_b128 v121, v[32:35] offset:0
    ds_write_b128 v121, v[36:39] offset:1024
    ds_write_b128 v121, v[40:43] offset:2048
    ds_write_b128 v121, v[44:47] offset:3072
    s_waitcnt lgkmcnt(0)
    s_waitcnt vmcnt(24)
    ds_read_b64_tr_b16 v[32:33], v18 offset:4096
    ds_read_b64_tr_b16 v[34:35], v18 offset:5120
    ds_read_b64_tr_b16 v[36:37], v18 offset:6144
    ds_read_b64_tr_b16 v[38:39], v18 offset:7168
    ds_read_b64_tr_b16 v[40:41], v19 offset:4096
    ds_read_b64_tr_b16 v[42:43], v19 offset:5120
    ds_read_b64_tr_b16 v[44:45], v19 offset:6144
    ds_read_b64_tr_b16 v[46:47], v19 offset:7168
    s_waitcnt lgkmcnt(0)
    ds_write_b128 v121, v[32:35] offset:4096
    ds_write_b128 v121, v[36:39] offset:5120
    ds_write_b128 v121, v[40:43] offset:6144
    ds_write_b128 v121, v[44:47] offset:7168
    s_waitcnt lgkmcnt(0)
    s_waitcnt vmcnt(20)
    ds_read_b64_tr_b16 v[32:33], v18 offset:8192
    ds_read_b64_tr_b16 v[34:35], v18 offset:9216
    ds_read_b64_tr_b16 v[36:37], v18 offset:10240
    ds_read_b64_tr_b16 v[38:39], v18 offset:11264
    ds_read_b64_tr_b16 v[40:41], v19 offset:8192
    ds_read_b64_tr_b16 v[42:43], v19 offset:9216
    ds_read_b64_tr_b16 v[44:45], v19 offset:10240
    ds_read_b64_tr_b16 v[46:47], v19 offset:11264
    s_waitcnt lgkmcnt(0)
    ds_write_b128 v121, v[32:35] offset:8192
    ds_write_b128 v121, v[36:39] offset:9216
    ds_write_b128 v121, v[40:43] offset:10240
    ds_write_b128 v121, v[44:47] offset:11264
    s_waitcnt lgkmcnt(0)
    s_waitcnt vmcnt(16)
    ds_read_b64_tr_b16 v[32:33], v18 offset:12288
    ds_read_b64_tr_b16 v[34:35], v18 offset:13312
    ds_read_b64_tr_b16 v[36:37], v18 offset:14336
    ds_read_b64_tr_b16 v[38:39], v18 offset:15360
    ds_read_b64_tr_b16 v[40:41], v19 offset:12288
    ds_read_b64_tr_b16 v[42:43], v19 offset:13312
    ds_read_b64_tr_b16 v[44:45], v19 offset:14336
    ds_read_b64_tr_b16 v[46:47], v19 offset:15360
    s_waitcnt lgkmcnt(0)
    ds_write_b128 v121, v[32:35] offset:12288
    ds_write_b128 v121, v[36:39] offset:13312
    ds_write_b128 v121, v[40:43] offset:14336
    ds_write_b128 v121, v[44:47] offset:15360
    s_waitcnt lgkmcnt(0)
    s_waitcnt vmcnt(12)
    ds_read_b64_tr_b16 v[32:33], v20 offset:16384
    ds_read_b64_tr_b16 v[34:35], v21 offset:16384
    ds_read_b64_tr_b16 v[36:37], v20 offset:17408
    ds_read_b64_tr_b16 v[38:39], v21 offset:17408
    ds_read_b64_tr_b16 v[40:41], v20 offset:18432
    ds_read_b64_tr_b16 v[42:43], v21 offset:18432
    ds_read_b64_tr_b16 v[44:45], v20 offset:19456
    ds_read_b64_tr_b16 v[46:47], v21 offset:19456
    s_waitcnt lgkmcnt(0)
    ds_write_b128 v121, v[32:35] offset:16384
    ds_write_b128 v121, v[36:39] offset:17408
    ds_write_b128 v121, v[40:43] offset:18432
    ds_write_b128 v121, v[44:47] offset:19456
    s_waitcnt lgkmcnt(0)
    s_waitcnt vmcnt(8)
    ds_read_b64_tr_b16 v[32:33], v20 offset:20480
    ds_read_b64_tr_b16 v[34:35], v21 offset:20480
    ds_read_b64_tr_b16 v[36:37], v20 offset:21504
    ds_read_b64_tr_b16 v[38:39], v21 offset:21504
    ds_read_b64_tr_b16 v[40:41], v20 offset:22528
    ds_read_b64_tr_b16 v[42:43], v21 offset:22528
    ds_read_b64_tr_b16 v[44:45], v20 offset:23552
    ds_read_b64_tr_b16 v[46:47], v21 offset:23552
    s_waitcnt lgkmcnt(0)
    ds_write_b128 v121, v[32:35] offset:20480
    ds_write_b128 v121, v[36:39] offset:21504
    ds_write_b128 v121, v[40:43] offset:22528
    ds_write_b128 v121, v[44:47] offset:23552
    s_waitcnt lgkmcnt(0)
    s_waitcnt vmcnt(4)
    ds_read_b64_tr_b16 v[32:33], v20 offset:24576
    ds_read_b64_tr_b16 v[34:35], v21 offset:24576
    ds_read_b64_tr_b16 v[36:37], v20 offset:25600
    ds_read_b64_tr_b16 v[38:39], v21 offset:25600
    ds_read_b64_tr_b16 v[40:41], v20 offset:26624
    ds_read_b64_tr_b16 v[42:43], v21 offset:26624
    ds_read_b64_tr_b16 v[44:45], v20 offset:27648
    ds_read_b64_tr_b16 v[46:47], v21 offset:27648
    s_waitcnt lgkmcnt(0)
    ds_write_b128 v121, v[32:35] offset:24576
    ds_write_b128 v121, v[36:39] offset:25600
    ds_write_b128 v121, v[40:43] offset:26624
    ds_write_b128 v121, v[44:47] offset:27648
    s_waitcnt lgkmcnt(0)
    s_waitcnt vmcnt(0)
    ds_read_b64_tr_b16 v[32:33], v20 offset:28672
    ds_read_b64_tr_b16 v[34:35], v21 offset:28672
    ds_read_b64_tr_b16 v[36:37], v20 offset:29696
    ds_read_b64_tr_b16 v[38:39], v21 offset:29696
    ds_read_b64_tr_b16 v[40:41], v20 offset:30720
    ds_read_b64_tr_b16 v[42:43], v21 offset:30720
    ds_read_b64_tr_b16 v[44:45], v20 offset:31744
    ds_read_b64_tr_b16 v[46:47], v21 offset:31744
    s_waitcnt lgkmcnt(0)
    ds_write_b128 v121, v[32:35] offset:28672
    ds_write_b128 v121, v[36:39] offset:29696
    ds_write_b128 v121, v[40:43] offset:30720
    ds_write_b128 v121, v[44:47] offset:31744
    s_waitcnt lgkmcnt(0)

    s_mov_b32 s30, 200000
RB_2:
    global_load_dword v24, v23, s[12:13] sc1
    s_sub_u32 s30, s30, 1
    s_cbranch_scc1 L_abort
    s_waitcnt vmcnt(0)
    v_readfirstlane_b32 s3, v24
    s_cmp_lt_u32 s3, 128
    s_cbranch_scc1 RB_2
    v_mov_b32 v24, 0
    global_load_dwordx2 v[24:25], v24, s[12:13] sc1
    s_mov_b32 s16, 0
    s_mov_b32 s29, 0
    s_mov_b32 s17, 0
    s_mov_b32 s41, 0
    s_mov_b32 s18, 0
    s_mov_b32 s19, 0x10000
    s_mov_b32 s20, 0x20000
    s_mov_b32 s21, 0x30000
    s_mul_i32 s25, s14, 16384
    s_lshl_b32 s3, s15, 11
    s_add_u32 s25, s25, s3
    s_add_u32 s25, s25, 1048576
    s_add_u32 s26, s25, 8192
    s_add_u32 s23, s23, s3
    s_mov_b32 s28, 540672
    s_lshl_b32 s27, s14, 12
    s_lshl_b32 s3, s15, 10
    s_add_u32 s27, s27, s3
    s_add_u32 s27, s27, 52297728
    s_mov_b32 s30, 400000
    s_mov_b32 s32, 0x3e0293ee
    s_mov_b32 s33, 0x3e0293ee
    s_mov_b32 s34, 0x3f003f00
    s_mov_b32 s35, 0x3f003f00
    s_mov_b32 s38, 0x3f803f80
    s_mov_b32 s39, 0x3f803f80
    s_waitcnt vmcnt(0)

    s_getreg_b32 s3, hwreg(HW_REG_XCC_ID)
    s_and_b32 s3, s3, 7
    s_mul_i32 s3, s3, 6
    s_lshl_b64 vcc, 32, s3
    v_cmp_ne_u64 vcc, vcc, v[24:25]
    s_cbranch_vccnz L_safe
    s_cmp_eq_u32 s15, 1
    s_cbranch_scc1 RW_4
    s_cmp_eq_u32 s15, 2
    s_cbranch_scc1 RW_5
    s_cmp_eq_u32 s15, 3
    s_cbranch_scc1 RW_6
RW_3:
    s_cmp_gt_u32 s17, s41
    s_cbranch_scc0 KC_13
KC_14:
    s_add_u32 s41, s41, 1
    s_mov_b32 m0, 12288
s_nop 0
    buffer_load_dwordx4 v112, s[4:7], s25 offen sc1 lds
    buffer_load_dwordx4 v112, s[4:7], s25 offen offset:1024 sc1 lds
    s_mov_b32 m0, 57344
s_nop 0
    buffer_load_dwordx4 v114, s[4:7], s26 offen sc1 lds
    s_mov_b32 m0, 58240
s_nop 0
    buffer_load_dwordx4 v114, s[4:7], s26 offen offset:128 sc1 lds
    ds_read_b128 v[32:35], v121 offset:0
    ds_read_b128 v[36:39], v121 offset:1024
    ds_read_b128 v[40:43], v121 offset:2048
    ds_read_b128 v[44:47], v121 offset:3072
    ds_read_b128 v[48:51], v121 offset:4096
    ds_read_b128 v[52:55], v121 offset:5120
    ds_read_b128 v[56:59], v121 offset:6144
    ds_read_b128 v[60:63], v121 offset:7168
    v_mov_b64 v[96:97], 0
    v_mov_b64 v[98:99], 0
    v_mov_b64 v[100:101], 0
    v_mov_b64 v[102:103], 0
    v_mov_b64 v[104:105], 0
    v_mov_b64 v[106:107], 0
    v_mov_b64 v[108:109], 0
    v_mov_b64 v[110:111], 0
    v_mov_b64 v[0:1], 0
    v_mov_b64 v[2:3], 0
    v_mov_b64 v[4:5], 0
    v_mov_b64 v[6:7], 0
    s_waitcnt vmcnt(0)
RL_7:
    ds_read_b128 v[48:51], v121 offset:4096
    ds_read_b128 v[52:55], v121 offset:5120
    ds_read_b128 v[56:59], v121 offset:6144
    ds_read_b128 v[60:63], v121 offset:7168
    ds_read_b128 v[80:83], v112 offset:12288
    ds_read_b128 v[84:87], v112 offset:13312
    ds_read_b128 v[88:91], v121 offset:32768
    ds_read_b128 v[92:95], v121 offset:33792
    s_add_u32 s25, s25, 524288
    s_add_u32 s26, s26, 524288
    buffer_load_dwordx4 v[64:67], v112, s[4:7], s23 offen sc1
    buffer_load_dwordx4 v[68:71], v112, s[4:7], s23 offen offset:1024 sc1
    s_cmp_gt_u32 s17, s41
    s_cbranch_scc0 KC_15
KC_16:
    s_add_u32 s41, s41, 1
RC_8:
    s_waitcnt vmcnt(1) lgkmcnt(0)
    v_max3_u32 v122, v64, v65, v66
    v_max_u32 v122, v122, v67
    v_smfmac_f32_16x16x64_bf16 v[96:99], v[64:67], v[32:39], v120
    ds_write_b128 v112, v[64:67] offset:0
    s_waitcnt vmcnt(0)
    v_max3_u32 v122, v122, v68, v69
    v_smfmac_f32_16x16x64_bf16 v[100:103], v[64:67], v[40:47], v120
    v_max3_u32 v122, v122, v70, v71
    v_cmp_eq_u32 vcc, -1, v122
    s_cbranch_vccnz RF_10
    v_smfmac_f32_16x16x64_bf16 v[96:99], v[68:71], v[48:55], v120
    ds_write_b128 v112, v[68:71] offset:1024
    v_smfmac_f32_16x16x64_bf16 v[100:103], v[68:71], v[56:63], v120
    v_smfmac_f32_16x16x64_bf16 v[104:107], v[64:67], a[64:71], v120
    ds_read_b128 v[32:35], v121 offset:8192
    ds_read_b128 v[36:39], v121 offset:9216
    v_smfmac_f32_16x16x64_bf16 v[108:111], v[64:67], a[72:79], v120
    ds_read_b128 v[40:43], v121 offset:10240
    ds_read_b128 v[44:47], v121 offset:11264
    s_waitcnt lgkmcnt(4)
    s_barrier
    ds_read_b128 v[16:19], v112 offset:4096
    ds_read_b128 v[20:23], v112 offset:5120
    v_smfmac_f32_16x16x64_bf16 v[104:107], v[68:71], a[80:87], v120
    ds_read_b128 v[24:27], v112 offset:6144
    ds_read_b128 v[28:31], v112 offset:7168
    v_smfmac_f32_16x16x64_bf16 v[108:111], v[68:71], a[88:95], v120
    ds_read_b128 v[8:11], v112 offset:2048
    ds_read_b128 v[12:15], v112 offset:3072
    v_smfmac_f32_16x16x64_bf16 v[0:3], v[64:67], a[192:199], v120
    ds_read_b128 v[48:51], v121 offset:12288
    ds_read_b128 v[52:55], v121 offset:13312
    v_smfmac_f32_16x16x64_bf16 v[4:7], v[64:67], a[200:207], v120
    ds_read_b128 v[56:59], v121 offset:14336
    ds_read_b128 v[60:63], v121 offset:15360
    v_smfmac_f32_16x16x64_bf16 v[0:3], v[68:71], a[208:215], v120
    v_smfmac_f32_16x16x64_bf16 v[4:7], v[68:71], a[216:223], v120
RB_12:
    s_waitcnt lgkmcnt(9)
    v_smfmac_f32_16x16x64_bf16 v[96:99], v[16:19], a[0:7], v120
    buffer_store_dwordx4 v[124:127], v113, s[4:7], s27 offen sc1
    v_smfmac_f32_16x16x64_bf16 v[100:103], v[16:19], a[8:15], v120
    s_waitcnt lgkmcnt(8)
    v_smfmac_f32_16x16x64_bf16 v[96:99], v[20:23], a[16:23], v120
    v_smfmac_f32_16x16x64_bf16 v[100:103], v[20:23], a[24:31], v120
    s_waitcnt lgkmcnt(7)
    v_smfmac_f32_16x16x64_bf16 v[96:99], v[24:27], a[32:39], v120
    s_mov_b32 m0, 12288
s_nop 0
    buffer_load_dwordx4 v112, s[4:7], s25 offen sc1 lds
    v_smfmac_f32_16x16x64_bf16 v[100:103], v[24:27], a[40:47], v120
    v_mov_b64 v[124:125], -1
    s_waitcnt lgkmcnt(6)
    v_smfmac_f32_16x16x64_bf16 v[96:99], v[28:31], a[48:55], v120
    v_smfmac_f32_16x16x64_bf16 v[100:103], v[28:31], a[56:63], v120
    s_waitcnt vmcnt(2)
    s_waitcnt lgkmcnt(5)
    v_smfmac_f32_16x16x64_bf16 v[96:99], v[8:11], v[32:39], v120
    buffer_load_dwordx4 v112, s[4:7], s25 offen offset:1024 sc1 lds
    ds_read_b128 v[76:79], v112 offset:10240
    s_waitcnt lgkmcnt(3)
    v_smfmac_f32_16x16x64_bf16 v[96:99], v[12:15], v[48:55], v120
    v_smfmac_f32_16x16x64_bf16 v[100:103], v[8:11], v[40:47], v120
    s_waitcnt lgkmcnt(1)
    v_smfmac_f32_16x16x64_bf16 v[100:103], v[12:15], v[56:63], v120
    v_cvt_pk_bf16_f32 v122, v96, v97
    v_smfmac_f32_16x16x64_bf16 v[104:107], v[8:11], a[96:103], v120
    s_mov_b32 m0, 57344
s_nop 0
    buffer_load_dwordx4 v114, s[4:7], s26 offen sc1 lds
    ds_read_b128 v[32:35], v121 offset:16384
    v_cvt_pk_bf16_f32 v123, v98, v99
    v_smfmac_f32_16x16x64_bf16 v[104:107], v[12:15], a[112:119], v120
    ds_read_b128 v[36:39], v121 offset:17408
    v_cvt_pk_bf16_f32 v60, v100, v101
    s_waitcnt lgkmcnt(2)
    v_mfma_f32_16x16x16_bf16 v[96:99], v[122:123], v[76:77], 0
    v_cvt_pk_bf16_f32 v61, v102, v103
    v_smfmac_f32_16x16x64_bf16 v[104:107], v[16:19], a[128:135], v120
    ds_read_b128 v[40:43], v121 offset:24576
    v_mfma_f32_16x16x16_bf16 v[100:103], v[60:61], v[76:77], 0
    v_smfmac_f32_16x16x64_bf16 v[104:107], v[20:23], a[144:151], v120
    ds_read_b128 v[44:47], v121 offset:25600
    v_cvt_pk_bf16_f32 v72, v96, v97
    v_smfmac_f32_16x16x64_bf16 v[104:107], v[24:27], a[160:167], v120
    s_mov_b32 m0, 58240
s_nop 0
    buffer_load_dwordx4 v114, s[4:7], s26 offen offset:128 sc1 lds
    ds_read_b128 v[48:51], v121 offset:18432
    v_cvt_pk_bf16_f32 v73, v98, v99
    v_smfmac_f32_16x16x64_bf16 v[104:107], v[28:31], a[176:183], v120
    ds_read_b128 v[52:55], v121 offset:19456
    v_cvt_pk_bf16_f32 v74, v100, v101
    v_smfmac_f32_16x16x64_bf16 v[108:111], v[8:11], a[104:111], v120
    ds_read_b128 v[64:67], v121 offset:20480
    v_cvt_pk_bf16_f32 v75, v102, v103
    v_smfmac_f32_16x16x64_bf16 v[108:111], v[12:15], a[120:127], v120
    ds_read_b128 v[68:71], v121 offset:21504
    v_cvt_pk_bf16_f32 v56, v104, v105
    v_smfmac_f32_16x16x64_bf16 v[108:111], v[16:19], a[136:143], v120
    buffer_store_dword v124, v119, s[4:7], s28 offen
    v_cvt_pk_bf16_f32 v57, v106, v107
    v_smfmac_f32_16x16x64_bf16 v[108:111], v[20:23], a[152:159], v120
    v_smfmac_f32_16x16x64_bf16 v[108:111], v[24:27], a[168:175], v120
    v_smfmac_f32_16x16x64_bf16 v[108:111], v[28:31], a[184:191], v120
    v_mfma_f32_16x16x16_bf16 v[104:107], v[56:57], v[78:79], 0
    v_mfma_f32_16x16x32_bf16 v[96:99], v[80:83], v[72:75], 0
    v_cvt_pk_bf16_f32 v58, v108, v109
    v_cvt_pk_bf16_f32 v59, v110, v111
s_nop 1
    v_cvt_pk_bf16_f32 v60, v104, v105
    v_cvt_pk_bf16_f32 v61, v106, v107
    v_mfma_f32_16x16x16_bf16 v[108:111], v[58:59], v[78:79], 0
    v_mov_b64 v[76:77], s[38:39]
    v_mov_b64 v[78:79], s[38:39]
    v_mfma_f32_16x16x32_bf16 v[100:103], v[84:87], v[72:75], 0
    v_smfmac_f32_16x16x64_bf16 v[0:3], v[8:11], a[224:231], v120
    v_cvt_pk_bf16_f32 v62, v108, v109
    v_cvt_pk_bf16_f32 v63, v110, v111
s_nop 1
    v_mov_b32_dpp v96, v100 quad_perm:[0,1,2,3] row_mask:0xf bank_mask:0xc
    v_mov_b32_dpp v97, v101 quad_perm:[0,1,2,3] row_mask:0xf bank_mask:0xc
    v_mfma_f32_16x16x32_bf16 v[104:107], v[60:63], v[72:75], 0
    v_mov_b32_dpp v98, v102 quad_perm:[0,1,2,3] row_mask:0xf bank_mask:0xc
    v_mov_b32_dpp v99, v103 quad_perm:[0,1,2,3] row_mask:0xf bank_mask:0xc
    v_smfmac_f32_16x16x64_bf16 v[0:3], v[12:15], a[240:247], v120
    ds_write_b128 v112, v[96:99] offset:20480
    v_smfmac_f32_16x16x64_bf16 v[0:3], v[16:19], v[128:135], v120
    ds_write_b64 v113, v[104:105] offset:8192
    v_smfmac_f32_16x16x64_bf16 v[0:3], v[20:23], v[144:151], v120
    v_smfmac_f32_16x16x64_bf16 v[0:3], v[24:27], v[160:167], v120
    v_smfmac_f32_16x16x64_bf16 v[0:3], v[28:31], v[176:183], v120
    v_smfmac_f32_16x16x64_bf16 v[4:7], v[8:11], a[232:239], v120
    s_waitcnt lgkmcnt(0)
    s_barrier
    ds_read_b128 v[104:107], v112 offset:8192
    ds_read_b128 v[108:111], v112 offset:11264
    v_smfmac_f32_16x16x64_bf16 v[4:7], v[12:15], a[248:255], v120
    ds_read_b128 v[80:83], v112 offset:21504
    ds_read_b128 v[84:87], v112 offset:22528
    v_smfmac_f32_16x16x64_bf16 v[4:7], v[16:19], v[136:143], v120
    ds_read_b128 v[100:103], v112 offset:23552
    v_cvt_pk_bf16_f32 v72, v0, v1
    v_smfmac_f32_16x16x64_bf16 v[4:7], v[20:23], v[152:159], v120
    v_cvt_pk_bf16_f32 v73, v2, v3
    v_smfmac_f32_16x16x64_bf16 v[4:7], v[24:27], v[168:175], v120
    s_cmp_eq_u32 s16, 63
    v_smfmac_f32_16x16x64_bf16 v[4:7], v[28:31], v[184:191], v120
    s_cbranch_scc1 RZ_17
    ds_read_b128 v[16:19], v121 offset:26624
    ds_read_b128 v[20:23], v121 offset:27648
    ds_read_b128 v[24:27], v121 offset:28672
    ds_read_b128 v[28:31], v121 offset:29696
    s_waitcnt lgkmcnt(7)
    v_pk_add_f32 v[104:105], v[104:105], v[106:107]
    v_pk_add_f32 v[108:109], v[108:109], v[110:111]
    s_waitcnt lgkmcnt(6)
    v_pk_add_f32 v[96:97], v[96:97], v[80:81]
    v_pk_add_f32 v[98:99], v[98:99], v[82:83]
    s_waitcnt lgkmcnt(4)
    v_pk_add_f32 v[84:85], v[84:85], v[100:101]
    v_pk_add_f32 v[86:87], v[86:87], v[102:103]
    v_pk_add_f32 v[100:101], v[104:105], v[108:109]
    v_pk_add_f32 v[96:97], v[96:97], v[84:85]
    v_pk_add_f32 v[98:99], v[98:99], v[86:87]
    v_max3_f32 v122, v100, v101, v96
    v_max3_f32 v123, v97, v98, v99
    v_max_f32 v102, v122, v123
    v_cvt_pk_bf16_f32 v74, v4, v5
    v_cvt_pk_bf16_f32 v75, v6, v7
    v_max_f32_dpp v122, v102, v102 row_ror:8 row_mask:0xf bank_mask:0xf
    v_max_f32_dpp v123, v102, v102 row_ror:8 row_mask:0xf bank_mask:0xf
    v_mov_b64 v[110:111], s[34:35]
s_nop 0
    v_permlane16_swap_b32 v122, v123
    v_max_f32 v102, v122, v123
    v_max_f32 v103, v122, v123
s_nop 1
    v_permlane32_swap_b32 v102, v103
    v_max_f32 v122, v102, v103
    v_mul_f32 v122, s32, v122
    v_pk_fma_f32 v[100:101], v[100:101], s[32:33], v[122:123] op_sel_hi:[1,1,0] neg_lo:[0,0,1] neg_hi:[0,0,1]
    v_pk_fma_f32 v[96:97], v[96:97], s[32:33], v[122:123] op_sel_hi:[1,1,0] neg_lo:[0,0,1] neg_hi:[0,0,1]
    v_pk_fma_f32 v[98:99], v[98:99], s[32:33], v[122:123] op_sel_hi:[1,1,0] neg_lo:[0,0,1] neg_hi:[0,0,1]
    v_exp_f32 v100, v100
    v_exp_f32 v101, v101
    v_exp_f32 v96, v96
    v_cvt_pk_bf16_f32 v108, v100, v101
    v_exp_f32 v97, v97
    v_exp_f32 v98, v98
    v_mov_b32_dpp v109, v108 row_ror:8 row_mask:0xf bank_mask:0xf
    v_cvt_pk_bf16_f32 v104, v96, v97
    v_exp_f32 v99, v99
    v_mfma_f32_16x16x16_bf16 v[60:63], v[110:111], v[108:109], 0
    v_cvt_pk_bf16_f32 v105, v98, v99
    v_mov_b32_dpp v106, v104 row_ror:8 row_mask:0xf bank_mask:0xf
    v_mfma_f32_16x16x16_bf16 v[100:103], v[74:75], v[108:109], 0
    v_mov_b32_dpp v107, v105 row_ror:8 row_mask:0xf bank_mask:0xf
    v_mfma_f32_16x16x16_bf16 v[96:99], v[72:73], v[108:109], 0
    ds_read_b128 v[80:83], v121 offset:22528
    ds_read_b128 v[84:87], v121 offset:23552
    v_mfma_f32_16x16x32_bf16 v[60:63], v[76:79], v[104:107], v[60:63]
    v_mfma_f32_16x16x32_bf16 v[100:103], v[92:95], v[104:107], v[100:103]
    v_mfma_f32_16x16x32_bf16 v[96:99], v[88:91], v[104:107], v[96:99]
    v_mov_b64 v[104:105], 0
    v_rcp_f32 v122, v60
    v_mov_b64 v[106:107], 0
    v_mov_b64 v[108:109], 0
    v_pk_mul_f32 v[100:101], v[100:101], v[122:123] op_sel_hi:[1,0]
    v_pk_mul_f32 v[102:103], v[102:103], v[122:123] op_sel_hi:[1,0]
    v_cvt_pk_bf16_f32 v74, v100, v101
    v_cvt_pk_bf16_f32 v75, v102, v103
    v_pk_mul_f32 v[96:97], v[96:97], v[122:123] op_sel_hi:[1,0]
    v_pk_mul_f32 v[98:99], v[98:99], v[122:123] op_sel_hi:[1,0]
    v_cvt_pk_bf16_f32 v72, v96, v97
    v_cvt_pk_bf16_f32 v73, v98, v99
    ds_write_b128 v116, v[72:75] offset:0
    v_mov_b32_dpp v74, v74 row_ror:8 row_mask:0xf bank_mask:0xc
    v_mov_b32_dpp v75, v75 row_ror:8 row_mask:0xf bank_mask:0xc
    v_mov_b32_dpp v72, v72 row_ror:8 row_mask:0xf bank_mask:0xc
    v_mov_b32_dpp v73, v73 row_ror:8 row_mask:0xf bank_mask:0xc
    v_mov_b64 v[110:111], 0
    v_mov_b64 v[96:97], 0
    v_smfmac_f32_16x16x64_bf16 v[104:107], v[72:75], v[32:39], v120
    ds_read_b128 v[88:91], v121 offset:30720
    ds_read_b128 v[92:95], v121 offset:31744
    v_mov_b64 v[98:99], 0
    v_smfmac_f32_16x16x64_bf16 v[108:111], v[72:75], v[40:47], v120
    v_mov_b64 v[100:101], 0
    v_mov_b64 v[102:103], 0
    s_waitcnt lgkmcnt(2)
    s_barrier
    ds_read_b128 v[8:11], v115 offset:1024
    ds_read_b128 v[12:15], v115 offset:2048
    ds_read_b128 v[76:79], v115 offset:3072
    v_smfmac_f32_16x16x64_bf16 v[96:99], v[72:75], v[192:199], v120
    v_smfmac_f32_16x16x64_bf16 v[100:103], v[72:75], v[224:231], v120
    s_waitcnt lgkmcnt(2)
    v_smfmac_f32_16x16x64_bf16 v[96:99], v[8:11], v[200:207], v120
    s_waitcnt lgkmcnt(1)
    v_smfmac_f32_16x16x64_bf16 v[96:99], v[12:15], v[208:215], v120
    s_waitcnt lgkmcnt(0)
    v_smfmac_f32_16x16x64_bf16 v[96:99], v[76:79], v[216:223], v120
    v_smfmac_f32_16x16x64_bf16 v[100:103], v[8:11], v[232:239], v120
    v_smfmac_f32_16x16x64_bf16 v[100:103], v[12:15], v[240:247], v120
    v_cvt_pk_bf16_f32 v96, v96, v97
    v_smfmac_f32_16x16x64_bf16 v[100:103], v[76:79], v[248:255], v120
    v_cvt_pk_bf16_f32 v97, v98, v99
    v_smfmac_f32_16x16x64_bf16 v[104:107], v[8:11], v[48:55], v120
    v_and_or_b32 v96, v96, -2, s29
    v_smfmac_f32_16x16x64_bf16 v[104:107], v[12:15], v[64:71], v120
    buffer_store_dwordx2 v[96:97], v117, s[4:7], s18 offen
    v_cvt_pk_bf16_f32 v100, v100, v101
    v_smfmac_f32_16x16x64_bf16 v[104:107], v[76:79], v[80:87], v120
    v_cvt_pk_bf16_f32 v101, v102, v103
    v_smfmac_f32_16x16x64_bf16 v[108:111], v[8:11], v[16:23], v120
    v_and_or_b32 v100, v100, -2, s29
    v_smfmac_f32_16x16x64_bf16 v[108:111], v[12:15], v[24:31], v120
    buffer_store_dwordx2 v[100:101], v117, s[4:7], s19 offen
    v_cvt_pk_bf16_f32 v104, v104, v105
    v_smfmac_f32_16x16x64_bf16 v[108:111], v[76:79], v[88:95], v120
    ds_read_b128 v[24:27], v112 offset:9216
    v_cvt_pk_bf16_f32 v105, v106, v107
    v_and_or_b32 v104, v104, -2, s29
    buffer_store_dwordx2 v[104:105], v117, s[4:7], s20 offen
    v_permlane32_swap_b32 v0, v4
    v_permlane32_swap_b32 v1, v5
s_nop 1
    v_cvt_pk_bf16_f32 v108, v108, v109
    v_cvt_pk_bf16_f32 v109, v110, v111
    v_and_or_b32 v108, v108, -2, s29
    buffer_store_dwordx2 v[108:109], v117, s[4:7], s21 offen
    s_xor_b32 s19, s19, 0x40000
    s_xor_b32 s20, s20, 0x40000
    s_xor_b32 s21, s21, 0x40000
    s_add_u32 s23, s23, 0x2000
    s_bitset0_b32 s23, 15
    s_add_u32 s28, s28, 0x2000
    s_bitset0_b32 s28, 15
    s_add_u32 s27, s27, 131072
    s_add_u32 s16, s16, 1
    v_permlane32_swap_b32 v2, v6
    v_permlane32_swap_b32 v3, v7
    v_permlane32_swap_b32 v56, v58
    v_permlane32_swap_b32 v57, v59
    v_pk_add_f32 v[0:1], v[0:1], v[4:5]
    v_pk_add_f32 v[2:3], v[2:3], v[6:7]
    v_lshlrev_b32 v64, 16, v56
    v_and_b32 v65, 0xffff0000, v56
    v_lshlrev_b32 v66, 16, v58
    v_and_b32 v67, 0xffff0000, v58
    v_lshlrev_b32 v68, 16, v57
    v_and_b32 v69, 0xffff0000, v57
    v_lshlrev_b32 v70, 16, v59
    v_and_b32 v71, 0xffff0000, v59
    v_pk_add_f32 v[64:65], v[64:65], v[66:67]
    v_pk_add_f32 v[68:69], v[68:69], v[70:71]
    v_cvt_pk_bf16_f32 v126, v0, v1
    v_cvt_pk_bf16_f32 v127, v2, v3
    v_cvt_pk_bf16_f32 v124, v64, v65
    v_cvt_pk_bf16_f32 v125, v68, v69
    v_mov_b64 v[0:1], 0
    v_mov_b64 v[2:3], 0
    v_mov_b64 v[4:5], 0
    v_mov_b64 v[6:7], 0
    v_mov_b64 v[96:97], 0
    v_mov_b64 v[98:99], 0
    v_mov_b64 v[100:101], 0
    v_mov_b64 v[102:103], 0
    v_mov_b64 v[104:105], 0
    v_mov_b64 v[106:107], 0
    v_mov_b64 v[108:109], 0
    v_mov_b64 v[110:111], 0
    ds_read_b128 v[32:35], v121 offset:0
    ds_read_b128 v[36:39], v121 offset:1024
    ds_read_b128 v[40:43], v121 offset:2048
    ds_read_b128 v[44:47], v121 offset:3072
    buffer_load_dwordx4 v[8:11], v118, s[4:7], s18 offen offset:0 sc1
    buffer_load_dwordx4 v[12:15], v118, s[4:7], s18 offen offset:1024 sc1
    s_waitcnt lgkmcnt(4)
    s_barrier
RD_18:
    s_waitcnt vmcnt(1)
    v_mfma_f32_16x16x32_bf16 v[28:31], v[24:27], v[8:11], 0
    v_bitop3_b32 v122, v8, v10, s29 bitop3:0x7e
    s_waitcnt vmcnt(0)
    v_mfma_f32_16x16x32_bf16 v[28:31], v[24:27], v[12:15], v[28:31]
    v_bitop3_b32 v123, v12, v14, s29 bitop3:0x7e
    v_bitop3_b32 v122, v122, v123, 1 bitop3:0xa8
    v_cmp_ne_u32 vcc, 0, v122
    s_cbranch_vccnz RO_19
s_nop 3
    v_add_f32_dpp v28, v28, v28 row_ror:8 row_mask:0xf bank_mask:0xf
    v_add_f32_dpp v29, v29, v29 row_ror:8 row_mask:0xf bank_mask:0xf
s_nop 0
    v_add_f32_dpp v28, v28, v28 row_ror:4 row_mask:0xf bank_mask:0xf
    v_add_f32_dpp v29, v29, v29 row_ror:4 row_mask:0xf bank_mask:0xf
    v_cvt_pk_bf16_f32 v122, v28, v29
    buffer_store_dword v122, v119, s[4:7], s24 offen
    s_xor_b32 s18, s18, 0x40000
    s_bfe_u32 s29, s16, 0x10001
    s_add_u32 s24, s24, 0x2000
    s_bitset0_b32 s24, 15
    s_branch RL_7
RO_19:
    s_sub_u32 s30, s30, 1
    s_cbranch_scc1 L_abort
    s_mov_b64 exec, vcc
    buffer_load_dwordx4 v[8:11], v118, s[4:7], s18 offen offset:0 sc1
    buffer_load_dwordx4 v[12:15], v118, s[4:7], s18 offen offset:1024 sc1
    s_mov_b64 exec, -1
    s_branch RD_18
RF_10:
    s_sub_u32 s30, s30, 1
    s_cbranch_scc1 L_abort
    s_mov_b64 exec, vcc
    buffer_load_dwordx4 v[64:67], v112, s[4:7], s23 offen sc1
    buffer_load_dwordx4 v[68:71], v112, s[4:7], s23 offen offset:1024 sc1
    s_mov_b64 exec, -1
    v_mov_b64 v[96:97], 0
    v_mov_b64 v[98:99], 0
    v_mov_b64 v[100:101], 0
    v_mov_b64 v[102:103], 0
    s_branch RC_8
KC_13:
    v_lshrrev_b32 v122, 2, v112
    buffer_load_dword v123, v122, s[4:7], s40 offen sc1
    s_sub_u32 s30, s30, 1
    s_cbranch_scc1 L_abort
    s_waitcnt vmcnt(0)
    v_cmp_ne_u32 vcc, 0, v123
    s_nop 4
    s_ff0_i32_b64 s17, vcc
    s_cmp_gt_u32 s17, s41
    s_cbranch_scc0 KC_13
    s_branch KC_14
KC_15:
    v_lshrrev_b32 v122, 2, v112
    buffer_load_dword v123, v122, s[4:7], s40 offen sc1
    s_sub_u32 s30, s30, 1
    s_cbranch_scc1 L_abort
    s_waitcnt vmcnt(0)
    v_cmp_ne_u32 vcc, 0, v123
    s_nop 4
    s_ff0_i32_b64 s17, vcc
    s_cmp_gt_u32 s17, s41
    s_cbranch_scc0 KC_15
    s_branch KC_16
RZ_17:
    s_waitcnt lgkmcnt(0)
    s_nop 7
    s_nop 7
    s_add_u32 s27, s27, 131072
    v_permlane32_swap_b32 v0, v4
    v_permlane32_swap_b32 v1, v5
    v_permlane32_swap_b32 v2, v6
    v_permlane32_swap_b32 v3, v7
    v_permlane32_swap_b32 v56, v58
    v_permlane32_swap_b32 v57, v59
    v_pk_add_f32 v[0:1], v[0:1], v[4:5]
    v_pk_add_f32 v[2:3], v[2:3], v[6:7]
    v_lshlrev_b32 v64, 16, v56
    v_and_b32 v65, 0xffff0000, v56
    v_lshlrev_b32 v66, 16, v58
    v_and_b32 v67, 0xffff0000, v58
    v_lshlrev_b32 v68, 16, v57
    v_and_b32 v69, 0xffff0000, v57
    v_lshlrev_b32 v70, 16, v59
    v_and_b32 v71, 0xffff0000, v59
    v_pk_add_f32 v[64:65], v[64:65], v[66:67]
    v_pk_add_f32 v[68:69], v[68:69], v[70:71]
    v_cvt_pk_bf16_f32 v126, v0, v1
    v_cvt_pk_bf16_f32 v127, v2, v3
    v_cvt_pk_bf16_f32 v124, v64, v65
    v_cvt_pk_bf16_f32 v125, v68, v69
    buffer_store_dwordx4 v[124:127], v113, s[4:7], s27 offen sc1
    s_branch L_rdone
RW_4:
    s_cmp_gt_u32 s17, s41
    s_cbranch_scc0 KC_26
KC_27:
    s_add_u32 s41, s41, 1
    s_mov_b32 m0, 14336
s_nop 0
    buffer_load_dwordx4 v112, s[4:7], s25 offen sc1 lds
    buffer_load_dwordx4 v112, s[4:7], s25 offen offset:1024 sc1 lds
    s_mov_b32 m0, 92160
s_nop 0
    buffer_load_dwordx4 v114, s[4:7], s26 offen sc1 lds
    s_mov_b32 m0, 93056
s_nop 0
    buffer_load_dwordx4 v114, s[4:7], s26 offen offset:128 sc1 lds
    ds_read_b128 v[32:35], v121 offset:0
    ds_read_b128 v[36:39], v121 offset:1024
    ds_read_b128 v[40:43], v121 offset:2048
    ds_read_b128 v[44:47], v121 offset:3072
    ds_read_b128 v[48:51], v121 offset:4096
    ds_read_b128 v[52:55], v121 offset:5120
    ds_read_b128 v[56:59], v121 offset:6144
    ds_read_b128 v[60:63], v121 offset:7168
    v_mov_b64 v[96:97], 0
    v_mov_b64 v[98:99], 0
    v_mov_b64 v[100:101], 0
    v_mov_b64 v[102:103], 0
    v_mov_b64 v[104:105], 0
    v_mov_b64 v[106:107], 0
    v_mov_b64 v[108:109], 0
    v_mov_b64 v[110:111], 0
    v_mov_b64 v[0:1], 0
    v_mov_b64 v[2:3], 0
    v_mov_b64 v[4:5], 0
    v_mov_b64 v[6:7], 0
    s_waitcnt vmcnt(0)
RL_20:
    ds_read_b128 v[48:51], v121 offset:4096
    ds_read_b128 v[52:55], v121 offset:5120
    ds_read_b128 v[56:59], v121 offset:6144
    ds_read_b128 v[60:63], v121 offset:7168
    ds_read_b128 v[80:83], v112 offset:14336
    ds_read_b128 v[84:87], v112 offset:15360
    ds_read_b128 v[88:91], v121 offset:32768
    ds_read_b128 v[92:95], v121 offset:33792
    s_add_u32 s25, s25, 524288
    s_add_u32 s26, s26, 524288
    buffer_load_dwordx4 v[64:67], v112, s[4:7], s23 offen sc1
    buffer_load_dwordx4 v[68:71], v112, s[4:7], s23 offen offset:1024 sc1
    s_cmp_gt_u32 s17, s41
    s_cbranch_scc0 KC_28
KC_29:
    s_add_u32 s41, s41, 1
RC_21:
    s_waitcnt vmcnt(1) lgkmcnt(0)
    v_max3_u32 v122, v64, v65, v66
    v_max_u32 v122, v122, v67
    v_smfmac_f32_16x16x64_bf16 v[96:99], v[64:67], v[32:39], v120
    ds_write_b128 v112, v[64:67] offset:2048
    s_waitcnt vmcnt(0)
    v_max3_u32 v122, v122, v68, v69
    v_smfmac_f32_16x16x64_bf16 v[100:103], v[64:67], v[40:47], v120
    v_max3_u32 v122, v122, v70, v71
    v_cmp_eq_u32 vcc, -1, v122
    s_cbranch_vccnz RF_23
    v_smfmac_f32_16x16x64_bf16 v[96:99], v[68:71], v[48:55], v120
    ds_write_b128 v112, v[68:71] offset:3072
    v_smfmac_f32_16x16x64_bf16 v[100:103], v[68:71], v[56:63], v120
    v_smfmac_f32_16x16x64_bf16 v[104:107], v[64:67], a[64:71], v120
    ds_read_b128 v[32:35], v121 offset:8192
    ds_read_b128 v[36:39], v121 offset:9216
    v_smfmac_f32_16x16x64_bf16 v[108:111], v[64:67], a[72:79], v120
    ds_read_b128 v[40:43], v121 offset:10240
    ds_read_b128 v[44:47], v121 offset:11264
    s_waitcnt lgkmcnt(4)
    s_barrier
    ds_read_b128 v[16:19], v112 offset:6144
    ds_read_b128 v[20:23], v112 offset:7168
    v_smfmac_f32_16x16x64_bf16 v[104:107], v[68:71], a[80:87], v120
    ds_read_b128 v[24:27], v112 offset:4096
    ds_read_b128 v[28:31], v112 offset:5120
    v_smfmac_f32_16x16x64_bf16 v[108:111], v[68:71], a[88:95], v120
    ds_read_b128 v[8:11], v112 offset:0
    ds_read_b128 v[12:15], v112 offset:1024
    v_smfmac_f32_16x16x64_bf16 v[0:3], v[64:67], a[192:199], v120
    ds_read_b128 v[48:51], v121 offset:12288
    ds_read_b128 v[52:55], v121 offset:13312
    v_smfmac_f32_16x16x64_bf16 v[4:7], v[64:67], a[200:207], v120
    ds_read_b128 v[56:59], v121 offset:14336
    ds_read_b128 v[60:63], v121 offset:15360
    v_smfmac_f32_16x16x64_bf16 v[0:3], v[68:71], a[208:215], v120
    v_smfmac_f32_16x16x64_bf16 v[4:7], v[68:71], a[216:223], v120
RB_25:
    s_waitcnt lgkmcnt(9)
    v_smfmac_f32_16x16x64_bf16 v[96:99], v[16:19], a[0:7], v120
    v_smfmac_f32_16x16x64_bf16 v[100:103], v[16:19], a[8:15], v120
    buffer_store_dwordx4 v[124:127], v113, s[4:7], s27 offen sc1
    s_waitcnt lgkmcnt(8)
    v_smfmac_f32_16x16x64_bf16 v[96:99], v[20:23], a[16:23], v120
    v_smfmac_f32_16x16x64_bf16 v[100:103], v[20:23], a[24:31], v120
    s_waitcnt lgkmcnt(7)
    v_smfmac_f32_16x16x64_bf16 v[96:99], v[24:27], a[32:39], v120
    v_smfmac_f32_16x16x64_bf16 v[100:103], v[24:27], a[40:47], v120
    s_mov_b32 m0, 14336
s_nop 0
    buffer_load_dwordx4 v112, s[4:7], s25 offen sc1 lds
    v_mov_b64 v[124:125], -1
    s_waitcnt lgkmcnt(6)
    v_smfmac_f32_16x16x64_bf16 v[96:99], v[28:31], a[48:55], v120
    v_smfmac_f32_16x16x64_bf16 v[100:103], v[28:31], a[56:63], v120
    s_waitcnt vmcnt(2)
    s_waitcnt lgkmcnt(5)
    v_smfmac_f32_16x16x64_bf16 v[96:99], v[8:11], v[32:39], v120
    ds_read_b128 v[76:79], v112 offset:10240
    s_waitcnt lgkmcnt(3)
    v_smfmac_f32_16x16x64_bf16 v[96:99], v[12:15], v[48:55], v120
    buffer_load_dwordx4 v112, s[4:7], s25 offen offset:1024 sc1 lds
    v_smfmac_f32_16x16x64_bf16 v[100:103], v[8:11], v[40:47], v120
    s_waitcnt lgkmcnt(1)
    v_smfmac_f32_16x16x64_bf16 v[100:103], v[12:15], v[56:63], v120
    v_cvt_pk_bf16_f32 v122, v96, v97
    v_smfmac_f32_16x16x64_bf16 v[104:107], v[8:11], a[96:103], v120
    ds_read_b128 v[32:35], v121 offset:18432
    v_cvt_pk_bf16_f32 v123, v98, v99
    v_smfmac_f32_16x16x64_bf16 v[104:107], v[12:15], a[112:119], v120
    s_mov_b32 m0, 92160
s_nop 0
    buffer_load_dwordx4 v114, s[4:7], s26 offen sc1 lds
    ds_read_b128 v[36:39], v121 offset:19456
    v_cvt_pk_bf16_f32 v60, v100, v101
    s_waitcnt lgkmcnt(2)
    v_mfma_f32_16x16x16_bf16 v[96:99], v[122:123], v[76:77], 0
    v_cvt_pk_bf16_f32 v61, v102, v103
    v_smfmac_f32_16x16x64_bf16 v[104:107], v[16:19], a[128:135], v120
    ds_read_b128 v[40:43], v121 offset:26624
    v_mfma_f32_16x16x16_bf16 v[100:103], v[60:61], v[76:77], 0
    v_smfmac_f32_16x16x64_bf16 v[104:107], v[20:23], a[144:151], v120
    ds_read_b128 v[44:47], v121 offset:27648
    v_cvt_pk_bf16_f32 v72, v96, v97
    v_smfmac_f32_16x16x64_bf16 v[104:107], v[24:27], a[160:167], v120
    ds_read_b128 v[48:51], v121 offset:16384
    v_cvt_pk_bf16_f32 v73, v98, v99
    v_smfmac_f32_16x16x64_bf16 v[104:107], v[28:31], a[176:183], v120
    s_mov_b32 m0, 93056
s_nop 0
    buffer_load_dwordx4 v114, s[4:7], s26 offen offset:128 sc1 lds
    ds_read_b128 v[52:55], v121 offset:17408
    v_cvt_pk_bf16_f32 v74, v100, v101
    v_smfmac_f32_16x16x64_bf16 v[108:111], v[8:11], a[104:111], v120
    ds_read_b128 v[64:67], v121 offset:22528
    v_cvt_pk_bf16_f32 v75, v102, v103
    v_smfmac_f32_16x16x64_bf16 v[108:111], v[12:15], a[120:127], v120
    ds_read_b128 v[68:71], v121 offset:23552
    v_cvt_pk_bf16_f32 v56, v104, v105
    v_smfmac_f32_16x16x64_bf16 v[108:111], v[16:19], a[136:143], v120
    v_cvt_pk_bf16_f32 v57, v106, v107
    v_smfmac_f32_16x16x64_bf16 v[108:111], v[20:23], a[152:159], v120
    buffer_store_dword v124, v119, s[4:7], s28 offen
    v_smfmac_f32_16x16x64_bf16 v[108:111], v[24:27], a[168:175], v120
    v_smfmac_f32_16x16x64_bf16 v[108:111], v[28:31], a[184:191], v120
    v_mfma_f32_16x16x16_bf16 v[104:107], v[56:57], v[78:79], 0
    v_mfma_f32_16x16x32_bf16 v[96:99], v[80:83], v[72:75], 0
    v_cvt_pk_bf16_f32 v58, v108, v109
    v_cvt_pk_bf16_f32 v59, v110, v111
s_nop 1
    v_cvt_pk_bf16_f32 v60, v104, v105
    v_cvt_pk_bf16_f32 v61, v106, v107
    v_mfma_f32_16x16x16_bf16 v[108:111], v[58:59], v[78:79], 0
    v_mov_b64 v[76:77], s[38:39]
    v_mov_b64 v[78:79], s[38:39]
    v_mfma_f32_16x16x32_bf16 v[100:103], v[84:87], v[72:75], 0
    v_smfmac_f32_16x16x64_bf16 v[0:3], v[8:11], a[224:231], v120
    v_cvt_pk_bf16_f32 v62, v108, v109
    v_cvt_pk_bf16_f32 v63, v110, v111
s_nop 1
    v_mov_b32_dpp v96, v100 quad_perm:[0,1,2,3] row_mask:0xf bank_mask:0xc
    v_mov_b32_dpp v97, v101 quad_perm:[0,1,2,3] row_mask:0xf bank_mask:0xc
    v_mfma_f32_16x16x32_bf16 v[104:107], v[60:63], v[72:75], 0
    v_mov_b32_dpp v98, v102 quad_perm:[0,1,2,3] row_mask:0xf bank_mask:0xc
    v_mov_b32_dpp v99, v103 quad_perm:[0,1,2,3] row_mask:0xf bank_mask:0xc
    v_smfmac_f32_16x16x64_bf16 v[0:3], v[12:15], a[240:247], v120
    ds_write_b128 v112, v[96:99] offset:21504
    v_smfmac_f32_16x16x64_bf16 v[0:3], v[16:19], v[128:135], v120
    ds_write_b64 v113, v[104:105] offset:8200
    v_smfmac_f32_16x16x64_bf16 v[0:3], v[20:23], v[144:151], v120
    v_smfmac_f32_16x16x64_bf16 v[0:3], v[24:27], v[160:167], v120
    v_smfmac_f32_16x16x64_bf16 v[0:3], v[28:31], v[176:183], v120
    v_smfmac_f32_16x16x64_bf16 v[4:7], v[8:11], a[232:239], v120
    s_waitcnt lgkmcnt(0)
    s_barrier
    ds_read_b128 v[104:107], v112 offset:8192
    ds_read_b128 v[108:111], v112 offset:11264
    v_smfmac_f32_16x16x64_bf16 v[4:7], v[12:15], a[248:255], v120
    ds_read_b128 v[80:83], v112 offset:20480
    ds_read_b128 v[84:87], v112 offset:23552
    v_smfmac_f32_16x16x64_bf16 v[4:7], v[16:19], v[136:143], v120
    ds_read_b128 v[100:103], v112 offset:22528
    v_cvt_pk_bf16_f32 v72, v0, v1
    v_smfmac_f32_16x16x64_bf16 v[4:7], v[20:23], v[152:159], v120
    v_cvt_pk_bf16_f32 v73, v2, v3
    v_smfmac_f32_16x16x64_bf16 v[4:7], v[24:27], v[168:175], v120
    s_cmp_eq_u32 s16, 63
    v_smfmac_f32_16x16x64_bf16 v[4:7], v[28:31], v[184:191], v120
    s_cbranch_scc1 RZ_30
    ds_read_b128 v[16:19], v121 offset:24576
    ds_read_b128 v[20:23], v121 offset:25600
    ds_read_b128 v[24:27], v121 offset:30720
    ds_read_b128 v[28:31], v121 offset:31744
    s_waitcnt lgkmcnt(7)
    v_pk_add_f32 v[104:105], v[104:105], v[106:107]
    v_pk_add_f32 v[108:109], v[108:109], v[110:111]
    s_waitcnt lgkmcnt(6)
    v_pk_add_f32 v[96:97], v[96:97], v[80:81]
    v_pk_add_f32 v[98:99], v[98:99], v[82:83]
    s_waitcnt lgkmcnt(4)
    v_pk_add_f32 v[84:85], v[84:85], v[100:101]
    v_pk_add_f32 v[86:87], v[86:87], v[102:103]
    v_pk_add_f32 v[100:101], v[104:105], v[108:109]
    v_pk_add_f32 v[96:97], v[96:97], v[84:85]
    v_pk_add_f32 v[98:99], v[98:99], v[86:87]
    v_max3_f32 v122, v100, v101, v96
    v_max3_f32 v123, v97, v98, v99
    v_max_f32 v102, v122, v123
    v_cvt_pk_bf16_f32 v74, v4, v5
    v_cvt_pk_bf16_f32 v75, v6, v7
    v_max_f32_dpp v122, v102, v102 row_ror:8 row_mask:0xf bank_mask:0xf
    v_max_f32_dpp v123, v102, v102 row_ror:8 row_mask:0xf bank_mask:0xf
    v_mov_b64 v[110:111], s[34:35]
s_nop 0
    v_permlane16_swap_b32 v122, v123
    v_max_f32 v102, v122, v123
    v_max_f32 v103, v122, v123
s_nop 1
    v_permlane32_swap_b32 v102, v103
    v_max_f32 v122, v102, v103
    v_mul_f32 v122, s32, v122
    v_pk_fma_f32 v[100:101], v[100:101], s[32:33], v[122:123] op_sel_hi:[1,1,0] neg_lo:[0,0,1] neg_hi:[0,0,1]
    v_pk_fma_f32 v[96:97], v[96:97], s[32:33], v[122:123] op_sel_hi:[1,1,0] neg_lo:[0,0,1] neg_hi:[0,0,1]
    v_pk_fma_f32 v[98:99], v[98:99], s[32:33], v[122:123] op_sel_hi:[1,1,0] neg_lo:[0,0,1] neg_hi:[0,0,1]
    v_exp_f32 v100, v100
    v_exp_f32 v101, v101
    v_exp_f32 v96, v96
    v_cvt_pk_bf16_f32 v108, v100, v101
    v_exp_f32 v97, v97
    v_exp_f32 v98, v98
    v_mov_b32_dpp v109, v108 row_ror:8 row_mask:0xf bank_mask:0xf
    v_cvt_pk_bf16_f32 v104, v96, v97
    v_exp_f32 v99, v99
    v_mfma_f32_16x16x16_bf16 v[60:63], v[110:111], v[108:109], 0
    v_cvt_pk_bf16_f32 v105, v98, v99
    v_mov_b32_dpp v106, v104 row_ror:8 row_mask:0xf bank_mask:0xf
    v_mfma_f32_16x16x16_bf16 v[100:103], v[74:75], v[108:109], 0
    v_mov_b32_dpp v107, v105 row_ror:8 row_mask:0xf bank_mask:0xf
    v_mfma_f32_16x16x16_bf16 v[96:99], v[72:73], v[108:109], 0
    ds_read_b128 v[80:83], v121 offset:20480
    ds_read_b128 v[84:87], v121 offset:21504
    v_mfma_f32_16x16x32_bf16 v[60:63], v[76:79], v[104:107], v[60:63]
    v_mfma_f32_16x16x32_bf16 v[100:103], v[92:95], v[104:107], v[100:103]
    v_mfma_f32_16x16x32_bf16 v[96:99], v[88:91], v[104:107], v[96:99]
    v_mov_b64 v[104:105], 0
    v_rcp_f32 v122, v60
    v_mov_b64 v[106:107], 0
    v_mov_b64 v[108:109], 0
    v_pk_mul_f32 v[100:101], v[100:101], v[122:123] op_sel_hi:[1,0]
    v_pk_mul_f32 v[102:103], v[102:103], v[122:123] op_sel_hi:[1,0]
    v_cvt_pk_bf16_f32 v74, v100, v101
    v_cvt_pk_bf16_f32 v75, v102, v103
    v_pk_mul_f32 v[96:97], v[96:97], v[122:123] op_sel_hi:[1,0]
    v_pk_mul_f32 v[98:99], v[98:99], v[122:123] op_sel_hi:[1,0]
    v_cvt_pk_bf16_f32 v72, v96, v97
    v_cvt_pk_bf16_f32 v73, v98, v99
    ds_write_b128 v116, v[72:75] offset:1024
    v_mov_b32_dpp v74, v74 row_ror:8 row_mask:0xf bank_mask:0xc
    v_mov_b32_dpp v75, v75 row_ror:8 row_mask:0xf bank_mask:0xc
    v_mov_b32_dpp v72, v72 row_ror:8 row_mask:0xf bank_mask:0xc
    v_mov_b32_dpp v73, v73 row_ror:8 row_mask:0xf bank_mask:0xc
    v_mov_b64 v[110:111], 0
    v_mov_b64 v[96:97], 0
    v_smfmac_f32_16x16x64_bf16 v[104:107], v[72:75], v[32:39], v120
    ds_read_b128 v[88:91], v121 offset:28672
    ds_read_b128 v[92:95], v121 offset:29696
    v_mov_b64 v[98:99], 0
    v_smfmac_f32_16x16x64_bf16 v[108:111], v[72:75], v[40:47], v120
    v_mov_b64 v[100:101], 0
    v_mov_b64 v[102:103], 0
    s_waitcnt lgkmcnt(2)
    s_barrier
    ds_read_b128 v[8:11], v115 offset:0
    ds_read_b128 v[12:15], v115 offset:3072
    ds_read_b128 v[76:79], v115 offset:2048
    v_smfmac_f32_16x16x64_bf16 v[96:99], v[72:75], v[200:207], v120
    v_smfmac_f32_16x16x64_bf16 v[100:103], v[72:75], v[232:239], v120
    s_waitcnt lgkmcnt(2)
    v_smfmac_f32_16x16x64_bf16 v[96:99], v[8:11], v[192:199], v120
    s_waitcnt lgkmcnt(1)
    v_smfmac_f32_16x16x64_bf16 v[96:99], v[12:15], v[216:223], v120
    s_waitcnt lgkmcnt(0)
    v_smfmac_f32_16x16x64_bf16 v[96:99], v[76:79], v[208:215], v120
    v_smfmac_f32_16x16x64_bf16 v[100:103], v[8:11], v[224:231], v120
    v_smfmac_f32_16x16x64_bf16 v[100:103], v[12:15], v[248:255], v120
    v_cvt_pk_bf16_f32 v96, v96, v97
    v_smfmac_f32_16x16x64_bf16 v[100:103], v[76:79], v[240:247], v120
    v_cvt_pk_bf16_f32 v97, v98, v99
    v_smfmac_f32_16x16x64_bf16 v[104:107], v[8:11], v[48:55], v120
    v_and_or_b32 v96, v96, -2, s29
    v_smfmac_f32_16x16x64_bf16 v[104:107], v[12:15], v[64:71], v120
    buffer_store_dwordx2 v[96:97], v117, s[4:7], s18 offen
    v_cvt_pk_bf16_f32 v100, v100, v101
    v_smfmac_f32_16x16x64_bf16 v[104:107], v[76:79], v[80:87], v120
    v_cvt_pk_bf16_f32 v101, v102, v103
    v_smfmac_f32_16x16x64_bf16 v[108:111], v[8:11], v[16:23], v120
    v_and_or_b32 v100, v100, -2, s29
    v_smfmac_f32_16x16x64_bf16 v[108:111], v[12:15], v[24:31], v120
    buffer_store_dwordx2 v[100:101], v117, s[4:7], s19 offen
    v_cvt_pk_bf16_f32 v104, v104, v105
    v_smfmac_f32_16x16x64_bf16 v[108:111], v[76:79], v[88:95], v120
    ds_read_b128 v[24:27], v112 offset:9216
    v_cvt_pk_bf16_f32 v105, v106, v107
    v_and_or_b32 v104, v104, -2, s29
    buffer_store_dwordx2 v[104:105], v117, s[4:7], s20 offen
    v_permlane32_swap_b32 v0, v4
    v_permlane32_swap_b32 v1, v5
s_nop 1
    v_cvt_pk_bf16_f32 v108, v108, v109
    v_cvt_pk_bf16_f32 v109, v110, v111
    v_and_or_b32 v108, v108, -2, s29
    buffer_store_dwordx2 v[108:109], v117, s[4:7], s21 offen
    s_xor_b32 s19, s19, 0x40000
    s_xor_b32 s20, s20, 0x40000
    s_xor_b32 s21, s21, 0x40000
    s_add_u32 s23, s23, 0x2000
    s_bitset0_b32 s23, 15
    s_add_u32 s28, s28, 0x2000
    s_bitset0_b32 s28, 15
    s_add_u32 s27, s27, 131072
    s_add_u32 s16, s16, 1
    v_permlane32_swap_b32 v2, v6
    v_permlane32_swap_b32 v3, v7
    v_permlane32_swap_b32 v56, v58
    v_permlane32_swap_b32 v57, v59
    v_pk_add_f32 v[0:1], v[0:1], v[4:5]
    v_pk_add_f32 v[2:3], v[2:3], v[6:7]
    v_lshlrev_b32 v64, 16, v56
    v_and_b32 v65, 0xffff0000, v56
    v_lshlrev_b32 v66, 16, v58
    v_and_b32 v67, 0xffff0000, v58
    v_lshlrev_b32 v68, 16, v57
    v_and_b32 v69, 0xffff0000, v57
    v_lshlrev_b32 v70, 16, v59
    v_and_b32 v71, 0xffff0000, v59
    v_pk_add_f32 v[64:65], v[64:65], v[66:67]
    v_pk_add_f32 v[68:69], v[68:69], v[70:71]
    v_cvt_pk_bf16_f32 v126, v0, v1
    v_cvt_pk_bf16_f32 v127, v2, v3
    v_cvt_pk_bf16_f32 v124, v64, v65
    v_cvt_pk_bf16_f32 v125, v68, v69
    v_mov_b64 v[0:1], 0
    v_mov_b64 v[2:3], 0
    v_mov_b64 v[4:5], 0
    v_mov_b64 v[6:7], 0
    v_mov_b64 v[96:97], 0
    v_mov_b64 v[98:99], 0
    v_mov_b64 v[100:101], 0
    v_mov_b64 v[102:103], 0
    v_mov_b64 v[104:105], 0
    v_mov_b64 v[106:107], 0
    v_mov_b64 v[108:109], 0
    v_mov_b64 v[110:111], 0
    ds_read_b128 v[32:35], v121 offset:0
    ds_read_b128 v[36:39], v121 offset:1024
    ds_read_b128 v[40:43], v121 offset:2048
    ds_read_b128 v[44:47], v121 offset:3072
    buffer_load_dwordx4 v[8:11], v118, s[4:7], s18 offen offset:0 sc1
    buffer_load_dwordx4 v[12:15], v118, s[4:7], s18 offen offset:1024 sc1
    s_waitcnt lgkmcnt(4)
    s_barrier
RD_31:
    s_waitcnt vmcnt(1)
    v_mfma_f32_16x16x32_bf16 v[28:31], v[24:27], v[8:11], 0
    v_bitop3_b32 v122, v8, v10, s29 bitop3:0x7e
    s_waitcnt vmcnt(0)
    v_mfma_f32_16x16x32_bf16 v[28:31], v[24:27], v[12:15], v[28:31]
    v_bitop3_b32 v123, v12, v14, s29 bitop3:0x7e
    v_bitop3_b32 v122, v122, v123, 1 bitop3:0xa8
    v_cmp_ne_u32 vcc, 0, v122
    s_cbranch_vccnz RO_32
s_nop 3
    v_add_f32_dpp v28, v28, v28 row_ror:8 row_mask:0xf bank_mask:0xf
    v_add_f32_dpp v29, v29, v29 row_ror:8 row_mask:0xf bank_mask:0xf
s_nop 0
    v_add_f32_dpp v28, v28, v28 row_ror:4 row_mask:0xf bank_mask:0xf
    v_add_f32_dpp v29, v29, v29 row_ror:4 row_mask:0xf bank_mask:0xf
    v_cvt_pk_bf16_f32 v122, v28, v29
    buffer_store_dword v122, v119, s[4:7], s24 offen
    s_xor_b32 s18, s18, 0x40000
    s_bfe_u32 s29, s16, 0x10001
    s_add_u32 s24, s24, 0x2000
    s_bitset0_b32 s24, 15
    s_branch RL_20
RO_32:
    s_sub_u32 s30, s30, 1
    s_cbranch_scc1 L_abort
    s_mov_b64 exec, vcc
    buffer_load_dwordx4 v[8:11], v118, s[4:7], s18 offen offset:0 sc1
    buffer_load_dwordx4 v[12:15], v118, s[4:7], s18 offen offset:1024 sc1
    s_mov_b64 exec, -1
    s_branch RD_31
RF_23:
    s_sub_u32 s30, s30, 1
    s_cbranch_scc1 L_abort
    s_mov_b64 exec, vcc
    buffer_load_dwordx4 v[64:67], v112, s[4:7], s23 offen sc1
    buffer_load_dwordx4 v[68:71], v112, s[4:7], s23 offen offset:1024 sc1
    s_mov_b64 exec, -1
    v_mov_b64 v[96:97], 0
    v_mov_b64 v[98:99], 0
    v_mov_b64 v[100:101], 0
    v_mov_b64 v[102:103], 0
    s_branch RC_21
KC_26:
    v_lshrrev_b32 v122, 2, v112
    buffer_load_dword v123, v122, s[4:7], s40 offen sc1
    s_sub_u32 s30, s30, 1
    s_cbranch_scc1 L_abort
    s_waitcnt vmcnt(0)
    v_cmp_ne_u32 vcc, 0, v123
    s_nop 4
    s_ff0_i32_b64 s17, vcc
    s_cmp_gt_u32 s17, s41
    s_cbranch_scc0 KC_26
    s_branch KC_27
KC_28:
    v_lshrrev_b32 v122, 2, v112
    buffer_load_dword v123, v122, s[4:7], s40 offen sc1
    s_sub_u32 s30, s30, 1
    s_cbranch_scc1 L_abort
    s_waitcnt vmcnt(0)
    v_cmp_ne_u32 vcc, 0, v123
    s_nop 4
    s_ff0_i32_b64 s17, vcc
    s_cmp_gt_u32 s17, s41
    s_cbranch_scc0 KC_28
    s_branch KC_29
RZ_30:
    s_waitcnt lgkmcnt(0)
    s_nop 7
    s_nop 7
    s_add_u32 s27, s27, 131072
    v_permlane32_swap_b32 v0, v4
    v_permlane32_swap_b32 v1, v5
    v_permlane32_swap_b32 v2, v6
    v_permlane32_swap_b32 v3, v7
    v_permlane32_swap_b32 v56, v58
    v_permlane32_swap_b32 v57, v59
    v_pk_add_f32 v[0:1], v[0:1], v[4:5]
    v_pk_add_f32 v[2:3], v[2:3], v[6:7]
    v_lshlrev_b32 v64, 16, v56
    v_and_b32 v65, 0xffff0000, v56
    v_lshlrev_b32 v66, 16, v58
    v_and_b32 v67, 0xffff0000, v58
    v_lshlrev_b32 v68, 16, v57
    v_and_b32 v69, 0xffff0000, v57
    v_lshlrev_b32 v70, 16, v59
    v_and_b32 v71, 0xffff0000, v59
    v_pk_add_f32 v[64:65], v[64:65], v[66:67]
    v_pk_add_f32 v[68:69], v[68:69], v[70:71]
    v_cvt_pk_bf16_f32 v126, v0, v1
    v_cvt_pk_bf16_f32 v127, v2, v3
    v_cvt_pk_bf16_f32 v124, v64, v65
    v_cvt_pk_bf16_f32 v125, v68, v69
    buffer_store_dwordx4 v[124:127], v113, s[4:7], s27 offen sc1
    s_branch L_rdone
RW_5:
    s_cmp_gt_u32 s17, s41
    s_cbranch_scc0 KC_39
KC_40:
    s_add_u32 s41, s41, 1
    s_mov_b32 m0, 16384
s_nop 0
    buffer_load_dwordx4 v112, s[4:7], s25 offen sc1 lds
    buffer_load_dwordx4 v112, s[4:7], s25 offen offset:1024 sc1 lds
    s_mov_b32 m0, 126976
s_nop 0
    buffer_load_dwordx4 v114, s[4:7], s26 offen sc1 lds
    s_mov_b32 m0, 127872
s_nop 0
    buffer_load_dwordx4 v114, s[4:7], s26 offen offset:128 sc1 lds
    ds_read_b128 v[32:35], v121 offset:0
    ds_read_b128 v[36:39], v121 offset:1024
    ds_read_b128 v[40:43], v121 offset:2048
    ds_read_b128 v[44:47], v121 offset:3072
    ds_read_b128 v[48:51], v121 offset:4096
    ds_read_b128 v[52:55], v121 offset:5120
    ds_read_b128 v[56:59], v121 offset:6144
    ds_read_b128 v[60:63], v121 offset:7168
    v_mov_b64 v[96:97], 0
    v_mov_b64 v[98:99], 0
    v_mov_b64 v[100:101], 0
    v_mov_b64 v[102:103], 0
    v_mov_b64 v[104:105], 0
    v_mov_b64 v[106:107], 0
    v_mov_b64 v[108:109], 0
    v_mov_b64 v[110:111], 0
    v_mov_b64 v[0:1], 0
    v_mov_b64 v[2:3], 0
    v_mov_b64 v[4:5], 0
    v_mov_b64 v[6:7], 0
    s_waitcnt vmcnt(0)
RL_33:
    ds_read_b128 v[48:51], v121 offset:4096
    ds_read_b128 v[52:55], v121 offset:5120
    ds_read_b128 v[56:59], v121 offset:6144
    ds_read_b128 v[60:63], v121 offset:7168
    ds_read_b128 v[80:83], v112 offset:16384
    ds_read_b128 v[84:87], v112 offset:17408
    ds_read_b128 v[88:91], v121 offset:32768
    ds_read_b128 v[92:95], v121 offset:33792
    s_add_u32 s25, s25, 524288
    s_add_u32 s26, s26, 524288
    buffer_load_dwordx4 v[64:67], v112, s[4:7], s23 offen sc1
    buffer_load_dwordx4 v[68:71], v112, s[4:7], s23 offen offset:1024 sc1
    s_cmp_gt_u32 s17, s41
    s_cbranch_scc0 KC_41
KC_42:
    s_add_u32 s41, s41, 1
RC_34:
    s_waitcnt vmcnt(1) lgkmcnt(0)
    v_max3_u32 v122, v64, v65, v66
    v_max_u32 v122, v122, v67
    v_smfmac_f32_16x16x64_bf16 v[96:99], v[64:67], v[32:39], v120
    ds_write_b128 v112, v[64:67] offset:4096
    s_waitcnt vmcnt(0)
    v_max3_u32 v122, v122, v68, v69
    v_smfmac_f32_16x16x64_bf16 v[100:103], v[64:67], v[40:47], v120
    v_max3_u32 v122, v122, v70, v71
    v_cmp_eq_u32 vcc, -1, v122
    s_cbranch_vccnz RF_36
    v_smfmac_f32_16x16x64_bf16 v[96:99], v[68:71], v[48:55], v120
    ds_write_b128 v112, v[68:71] offset:5120
    v_smfmac_f32_16x16x64_bf16 v[100:103], v[68:71], v[56:63], v120
    v_smfmac_f32_16x16x64_bf16 v[104:107], v[64:67], a[64:71], v120
    ds_read_b128 v[32:35], v121 offset:8192
    ds_read_b128 v[36:39], v121 offset:9216
    v_smfmac_f32_16x16x64_bf16 v[108:111], v[64:67], a[72:79], v120
    ds_read_b128 v[40:43], v121 offset:10240
    ds_read_b128 v[44:47], v121 offset:11264
    s_waitcnt lgkmcnt(4)
    s_barrier
    ds_read_b128 v[16:19], v112 offset:0
    ds_read_b128 v[20:23], v112 offset:1024
    v_smfmac_f32_16x16x64_bf16 v[104:107], v[68:71], a[80:87], v120
    ds_read_b128 v[24:27], v112 offset:2048
    ds_read_b128 v[28:31], v112 offset:3072
    v_smfmac_f32_16x16x64_bf16 v[108:111], v[68:71], a[88:95], v120
    ds_read_b128 v[8:11], v112 offset:6144
    ds_read_b128 v[12:15], v112 offset:7168
    v_smfmac_f32_16x16x64_bf16 v[0:3], v[64:67], a[192:199], v120
    ds_read_b128 v[48:51], v121 offset:12288
    ds_read_b128 v[52:55], v121 offset:13312
    v_smfmac_f32_16x16x64_bf16 v[4:7], v[64:67], a[200:207], v120
    ds_read_b128 v[56:59], v121 offset:14336
    ds_read_b128 v[60:63], v121 offset:15360
    v_smfmac_f32_16x16x64_bf16 v[0:3], v[68:71], a[208:215], v120
    v_smfmac_f32_16x16x64_bf16 v[4:7], v[68:71], a[216:223], v120
RB_38:
    s_waitcnt lgkmcnt(9)
    v_smfmac_f32_16x16x64_bf16 v[96:99], v[16:19], a[0:7], v120
    v_smfmac_f32_16x16x64_bf16 v[100:103], v[16:19], a[8:15], v120
    s_waitcnt lgkmcnt(8)
    v_smfmac_f32_16x16x64_bf16 v[96:99], v[20:23], a[16:23], v120
    buffer_store_dwordx4 v[124:127], v113, s[4:7], s27 offen sc1
    v_smfmac_f32_16x16x64_bf16 v[100:103], v[20:23], a[24:31], v120
    s_waitcnt lgkmcnt(7)
    v_smfmac_f32_16x16x64_bf16 v[96:99], v[24:27], a[32:39], v120
    v_smfmac_f32_16x16x64_bf16 v[100:103], v[24:27], a[40:47], v120
    v_mov_b64 v[124:125], -1
    s_waitcnt lgkmcnt(6)
    v_smfmac_f32_16x16x64_bf16 v[96:99], v[28:31], a[48:55], v120
    s_mov_b32 m0, 16384
s_nop 0
    buffer_load_dwordx4 v112, s[4:7], s25 offen sc1 lds
    v_smfmac_f32_16x16x64_bf16 v[100:103], v[28:31], a[56:63], v120
    s_waitcnt vmcnt(2)
    s_waitcnt lgkmcnt(5)
    v_smfmac_f32_16x16x64_bf16 v[96:99], v[8:11], v[32:39], v120
    ds_read_b128 v[76:79], v112 offset:10240
    s_waitcnt lgkmcnt(3)
    v_smfmac_f32_16x16x64_bf16 v[96:99], v[12:15], v[48:55], v120
    v_smfmac_f32_16x16x64_bf16 v[100:103], v[8:11], v[40:47], v120
    buffer_load_dwordx4 v112, s[4:7], s25 offen offset:1024 sc1 lds
    s_waitcnt lgkmcnt(1)
    v_smfmac_f32_16x16x64_bf16 v[100:103], v[12:15], v[56:63], v120
    v_cvt_pk_bf16_f32 v122, v96, v97
    v_smfmac_f32_16x16x64_bf16 v[104:107], v[8:11], a[96:103], v120
    ds_read_b128 v[32:35], v121 offset:20480
    v_cvt_pk_bf16_f32 v123, v98, v99
    v_smfmac_f32_16x16x64_bf16 v[104:107], v[12:15], a[112:119], v120
    ds_read_b128 v[36:39], v121 offset:21504
    v_cvt_pk_bf16_f32 v60, v100, v101
    s_waitcnt lgkmcnt(2)
    v_mfma_f32_16x16x16_bf16 v[96:99], v[122:123], v[76:77], 0
    v_cvt_pk_bf16_f32 v61, v102, v103
    v_smfmac_f32_16x16x64_bf16 v[104:107], v[16:19], a[128:135], v120
    s_mov_b32 m0, 126976
s_nop 0
    buffer_load_dwordx4 v114, s[4:7], s26 offen sc1 lds
    ds_read_b128 v[40:43], v121 offset:28672
    v_mfma_f32_16x16x16_bf16 v[100:103], v[60:61], v[76:77], 0
    v_smfmac_f32_16x16x64_bf16 v[104:107], v[20:23], a[144:151], v120
    ds_read_b128 v[44:47], v121 offset:29696
    v_cvt_pk_bf16_f32 v72, v96, v97
    v_smfmac_f32_16x16x64_bf16 v[104:107], v[24:27], a[160:167], v120
    ds_read_b128 v[48:51], v121 offset:22528
    v_cvt_pk_bf16_f32 v73, v98, v99
    v_smfmac_f32_16x16x64_bf16 v[104:107], v[28:31], a[176:183], v120
    ds_read_b128 v[52:55], v121 offset:23552
    v_cvt_pk_bf16_f32 v74, v100, v101
    v_smfmac_f32_16x16x64_bf16 v[108:111], v[8:11], a[104:111], v120
    s_mov_b32 m0, 127872
s_nop 0
    buffer_load_dwordx4 v114, s[4:7], s26 offen offset:128 sc1 lds
    ds_read_b128 v[64:67], v121 offset:16384
    v_cvt_pk_bf16_f32 v75, v102, v103
    v_smfmac_f32_16x16x64_bf16 v[108:111], v[12:15], a[120:127], v120
    ds_read_b128 v[68:71], v121 offset:17408
    v_cvt_pk_bf16_f32 v56, v104, v105
    v_smfmac_f32_16x16x64_bf16 v[108:111], v[16:19], a[136:143], v120
    v_cvt_pk_bf16_f32 v57, v106, v107
    v_smfmac_f32_16x16x64_bf16 v[108:111], v[20:23], a[152:159], v120
    v_smfmac_f32_16x16x64_bf16 v[108:111], v[24:27], a[168:175], v120
    buffer_store_dword v124, v119, s[4:7], s28 offen
    v_smfmac_f32_16x16x64_bf16 v[108:111], v[28:31], a[184:191], v120
    v_mfma_f32_16x16x16_bf16 v[104:107], v[56:57], v[78:79], 0
    v_mfma_f32_16x16x32_bf16 v[96:99], v[80:83], v[72:75], 0
    v_cvt_pk_bf16_f32 v58, v108, v109
    v_cvt_pk_bf16_f32 v59, v110, v111
s_nop 1
    v_cvt_pk_bf16_f32 v60, v104, v105
    v_cvt_pk_bf16_f32 v61, v106, v107
    v_mfma_f32_16x16x16_bf16 v[108:111], v[58:59], v[78:79], 0
    v_mov_b64 v[76:77], s[38:39]
    v_mov_b64 v[78:79], s[38:39]
    v_mfma_f32_16x16x32_bf16 v[100:103], v[84:87], v[72:75], 0
    v_smfmac_f32_16x16x64_bf16 v[0:3], v[8:11], a[224:231], v120
    v_cvt_pk_bf16_f32 v62, v108, v109
    v_cvt_pk_bf16_f32 v63, v110, v111
s_nop 1
    v_mov_b32_dpp v96, v100 quad_perm:[0,1,2,3] row_mask:0xf bank_mask:0xc
    v_mov_b32_dpp v97, v101 quad_perm:[0,1,2,3] row_mask:0xf bank_mask:0xc
    v_mfma_f32_16x16x32_bf16 v[104:107], v[60:63], v[72:75], 0
    v_mov_b32_dpp v98, v102 quad_perm:[0,1,2,3] row_mask:0xf bank_mask:0xc
    v_mov_b32_dpp v99, v103 quad_perm:[0,1,2,3] row_mask:0xf bank_mask:0xc
    v_smfmac_f32_16x16x64_bf16 v[0:3], v[12:15], a[240:247], v120
    ds_write_b128 v112, v[96:99] offset:22528
    v_smfmac_f32_16x16x64_bf16 v[0:3], v[16:19], v[128:135], v120
    ds_write_b64 v113, v[104:105] offset:11264
    v_smfmac_f32_16x16x64_bf16 v[0:3], v[20:23], v[144:151], v120
    v_smfmac_f32_16x16x64_bf16 v[0:3], v[24:27], v[160:167], v120
    v_smfmac_f32_16x16x64_bf16 v[0:3], v[28:31], v[176:183], v120
    v_smfmac_f32_16x16x64_bf16 v[4:7], v[8:11], a[232:239], v120
    s_waitcnt lgkmcnt(0)
    s_barrier
    ds_read_b128 v[104:107], v112 offset:8192
    ds_read_b128 v[108:111], v112 offset:11264
    v_smfmac_f32_16x16x64_bf16 v[4:7], v[12:15], a[248:255], v120
    ds_read_b128 v[80:83], v112 offset:23552
    ds_read_b128 v[84:87], v112 offset:20480
    v_smfmac_f32_16x16x64_bf16 v[4:7], v[16:19], v[136:143], v120
    ds_read_b128 v[100:103], v112 offset:21504
    v_cvt_pk_bf16_f32 v72, v0, v1
    v_smfmac_f32_16x16x64_bf16 v[4:7], v[20:23], v[152:159], v120
    v_cvt_pk_bf16_f32 v73, v2, v3
    v_smfmac_f32_16x16x64_bf16 v[4:7], v[24:27], v[168:175], v120
    s_cmp_eq_u32 s16, 63
    v_smfmac_f32_16x16x64_bf16 v[4:7], v[28:31], v[184:191], v120
    s_cbranch_scc1 RZ_43
    ds_read_b128 v[16:19], v121 offset:30720
    ds_read_b128 v[20:23], v121 offset:31744
    ds_read_b128 v[24:27], v121 offset:24576
    ds_read_b128 v[28:31], v121 offset:25600
    s_waitcnt lgkmcnt(7)
    v_pk_add_f32 v[104:105], v[104:105], v[106:107]
    v_pk_add_f32 v[108:109], v[108:109], v[110:111]
    s_waitcnt lgkmcnt(6)
    v_pk_add_f32 v[96:97], v[96:97], v[80:81]
    v_pk_add_f32 v[98:99], v[98:99], v[82:83]
    s_waitcnt lgkmcnt(4)
    v_pk_add_f32 v[84:85], v[84:85], v[100:101]
    v_pk_add_f32 v[86:87], v[86:87], v[102:103]
    v_pk_add_f32 v[100:101], v[104:105], v[108:109]
    v_pk_add_f32 v[96:97], v[96:97], v[84:85]
    v_pk_add_f32 v[98:99], v[98:99], v[86:87]
    v_max3_f32 v122, v100, v101, v96
    v_max3_f32 v123, v97, v98, v99
    v_max_f32 v102, v122, v123
    v_cvt_pk_bf16_f32 v74, v4, v5
    v_cvt_pk_bf16_f32 v75, v6, v7
    v_max_f32_dpp v122, v102, v102 row_ror:8 row_mask:0xf bank_mask:0xf
    v_max_f32_dpp v123, v102, v102 row_ror:8 row_mask:0xf bank_mask:0xf
    v_mov_b64 v[110:111], s[34:35]
s_nop 0
    v_permlane16_swap_b32 v122, v123
    v_max_f32 v102, v122, v123
    v_max_f32 v103, v122, v123
s_nop 1
    v_permlane32_swap_b32 v102, v103
    v_max_f32 v122, v102, v103
    v_mul_f32 v122, s32, v122
    v_pk_fma_f32 v[100:101], v[100:101], s[32:33], v[122:123] op_sel_hi:[1,1,0] neg_lo:[0,0,1] neg_hi:[0,0,1]
    v_pk_fma_f32 v[96:97], v[96:97], s[32:33], v[122:123] op_sel_hi:[1,1,0] neg_lo:[0,0,1] neg_hi:[0,0,1]
    v_pk_fma_f32 v[98:99], v[98:99], s[32:33], v[122:123] op_sel_hi:[1,1,0] neg_lo:[0,0,1] neg_hi:[0,0,1]
    v_exp_f32 v100, v100
    v_exp_f32 v101, v101
    v_exp_f32 v96, v96
    v_cvt_pk_bf16_f32 v108, v100, v101
    v_exp_f32 v97, v97
    v_exp_f32 v98, v98
    v_mov_b32_dpp v109, v108 row_ror:8 row_mask:0xf bank_mask:0xf
    v_cvt_pk_bf16_f32 v104, v96, v97
    v_exp_f32 v99, v99
    v_mfma_f32_16x16x16_bf16 v[60:63], v[110:111], v[108:109], 0
    v_cvt_pk_bf16_f32 v105, v98, v99
    v_mov_b32_dpp v106, v104 row_ror:8 row_mask:0xf bank_mask:0xf
    v_mfma_f32_16x16x16_bf16 v[100:103], v[74:75], v[108:109], 0
    v_mov_b32_dpp v107, v105 row_ror:8 row_mask:0xf bank_mask:0xf
    v_mfma_f32_16x16x16_bf16 v[96:99], v[72:73], v[108:109], 0
    ds_read_b128 v[80:83], v121 offset:18432
    ds_read_b128 v[84:87], v121 offset:19456
    v_mfma_f32_16x16x32_bf16 v[60:63], v[76:79], v[104:107], v[60:63]
    v_mfma_f32_16x16x32_bf16 v[100:103], v[92:95], v[104:107], v[100:103]
    v_mfma_f32_16x16x32_bf16 v[96:99], v[88:91], v[104:107], v[96:99]
    v_mov_b64 v[104:105], 0
    v_rcp_f32 v122, v60
    v_mov_b64 v[106:107], 0
    v_mov_b64 v[108:109], 0
    v_pk_mul_f32 v[100:101], v[100:101], v[122:123] op_sel_hi:[1,0]
    v_pk_mul_f32 v[102:103], v[102:103], v[122:123] op_sel_hi:[1,0]
    v_cvt_pk_bf16_f32 v74, v100, v101
    v_cvt_pk_bf16_f32 v75, v102, v103
    v_pk_mul_f32 v[96:97], v[96:97], v[122:123] op_sel_hi:[1,0]
    v_pk_mul_f32 v[98:99], v[98:99], v[122:123] op_sel_hi:[1,0]
    v_cvt_pk_bf16_f32 v72, v96, v97
    v_cvt_pk_bf16_f32 v73, v98, v99
    ds_write_b128 v116, v[72:75] offset:2048
    v_mov_b32_dpp v74, v74 row_ror:8 row_mask:0xf bank_mask:0xc
    v_mov_b32_dpp v75, v75 row_ror:8 row_mask:0xf bank_mask:0xc
    v_mov_b32_dpp v72, v72 row_ror:8 row_mask:0xf bank_mask:0xc
    v_mov_b32_dpp v73, v73 row_ror:8 row_mask:0xf bank_mask:0xc
    v_mov_b64 v[110:111], 0
    v_mov_b64 v[96:97], 0
    v_smfmac_f32_16x16x64_bf16 v[104:107], v[72:75], v[32:39], v120
    ds_read_b128 v[88:91], v121 offset:26624
    ds_read_b128 v[92:95], v121 offset:27648
    v_mov_b64 v[98:99], 0
    v_smfmac_f32_16x16x64_bf16 v[108:111], v[72:75], v[40:47], v120
    v_mov_b64 v[100:101], 0
    v_mov_b64 v[102:103], 0
    s_waitcnt lgkmcnt(2)
    s_barrier
    ds_read_b128 v[8:11], v115 offset:3072
    ds_read_b128 v[12:15], v115 offset:0
    ds_read_b128 v[76:79], v115 offset:1024
    v_smfmac_f32_16x16x64_bf16 v[96:99], v[72:75], v[208:215], v120
    v_smfmac_f32_16x16x64_bf16 v[100:103], v[72:75], v[240:247], v120
    s_waitcnt lgkmcnt(2)
    v_smfmac_f32_16x16x64_bf16 v[96:99], v[8:11], v[216:223], v120
    s_waitcnt lgkmcnt(1)
    v_smfmac_f32_16x16x64_bf16 v[96:99], v[12:15], v[192:199], v120
    s_waitcnt lgkmcnt(0)
    v_smfmac_f32_16x16x64_bf16 v[96:99], v[76:79], v[200:207], v120
    v_smfmac_f32_16x16x64_bf16 v[100:103], v[8:11], v[248:255], v120
    v_smfmac_f32_16x16x64_bf16 v[100:103], v[12:15], v[224:231], v120
    v_cvt_pk_bf16_f32 v96, v96, v97
    v_smfmac_f32_16x16x64_bf16 v[100:103], v[76:79], v[232:239], v120
    v_cvt_pk_bf16_f32 v97, v98, v99
    v_smfmac_f32_16x16x64_bf16 v[104:107], v[8:11], v[48:55], v120
    v_and_or_b32 v96, v96, -2, s29
    v_smfmac_f32_16x16x64_bf16 v[104:107], v[12:15], v[64:71], v120
    buffer_store_dwordx2 v[96:97], v117, s[4:7], s18 offen
    v_cvt_pk_bf16_f32 v100, v100, v101
    v_smfmac_f32_16x16x64_bf16 v[104:107], v[76:79], v[80:87], v120
    v_cvt_pk_bf16_f32 v101, v102, v103
    v_smfmac_f32_16x16x64_bf16 v[108:111], v[8:11], v[16:23], v120
    v_and_or_b32 v100, v100, -2, s29
    v_smfmac_f32_16x16x64_bf16 v[108:111], v[12:15], v[24:31], v120
    buffer_store_dwordx2 v[100:101], v117, s[4:7], s19 offen
    v_cvt_pk_bf16_f32 v104, v104, v105
    v_smfmac_f32_16x16x64_bf16 v[108:111], v[76:79], v[88:95], v120
    ds_read_b128 v[24:27], v112 offset:9216
    v_cvt_pk_bf16_f32 v105, v106, v107
    v_and_or_b32 v104, v104, -2, s29
    buffer_store_dwordx2 v[104:105], v117, s[4:7], s20 offen
    v_permlane32_swap_b32 v0, v4
    v_permlane32_swap_b32 v1, v5
s_nop 1
    v_cvt_pk_bf16_f32 v108, v108, v109
    v_cvt_pk_bf16_f32 v109, v110, v111
    v_and_or_b32 v108, v108, -2, s29
    buffer_store_dwordx2 v[108:109], v117, s[4:7], s21 offen
    s_xor_b32 s19, s19, 0x40000
    s_xor_b32 s20, s20, 0x40000
    s_xor_b32 s21, s21, 0x40000
    s_add_u32 s23, s23, 0x2000
    s_bitset0_b32 s23, 15
    s_add_u32 s28, s28, 0x2000
    s_bitset0_b32 s28, 15
    s_add_u32 s27, s27, 131072
    s_add_u32 s16, s16, 1
    v_permlane32_swap_b32 v2, v6
    v_permlane32_swap_b32 v3, v7
    v_permlane32_swap_b32 v56, v58
    v_permlane32_swap_b32 v57, v59
    v_pk_add_f32 v[0:1], v[0:1], v[4:5]
    v_pk_add_f32 v[2:3], v[2:3], v[6:7]
    v_lshlrev_b32 v64, 16, v56
    v_and_b32 v65, 0xffff0000, v56
    v_lshlrev_b32 v66, 16, v58
    v_and_b32 v67, 0xffff0000, v58
    v_lshlrev_b32 v68, 16, v57
    v_and_b32 v69, 0xffff0000, v57
    v_lshlrev_b32 v70, 16, v59
    v_and_b32 v71, 0xffff0000, v59
    v_pk_add_f32 v[64:65], v[64:65], v[66:67]
    v_pk_add_f32 v[68:69], v[68:69], v[70:71]
    v_cvt_pk_bf16_f32 v126, v0, v1
    v_cvt_pk_bf16_f32 v127, v2, v3
    v_cvt_pk_bf16_f32 v124, v64, v65
    v_cvt_pk_bf16_f32 v125, v68, v69
    v_mov_b64 v[0:1], 0
    v_mov_b64 v[2:3], 0
    v_mov_b64 v[4:5], 0
    v_mov_b64 v[6:7], 0
    v_mov_b64 v[96:97], 0
    v_mov_b64 v[98:99], 0
    v_mov_b64 v[100:101], 0
    v_mov_b64 v[102:103], 0
    v_mov_b64 v[104:105], 0
    v_mov_b64 v[106:107], 0
    v_mov_b64 v[108:109], 0
    v_mov_b64 v[110:111], 0
    ds_read_b128 v[32:35], v121 offset:0
    ds_read_b128 v[36:39], v121 offset:1024
    ds_read_b128 v[40:43], v121 offset:2048
    ds_read_b128 v[44:47], v121 offset:3072
    buffer_load_dwordx4 v[8:11], v118, s[4:7], s18 offen offset:0 sc1
    buffer_load_dwordx4 v[12:15], v118, s[4:7], s18 offen offset:1024 sc1
    s_waitcnt lgkmcnt(4)
    s_barrier
RD_44:
    s_waitcnt vmcnt(1)
    v_mfma_f32_16x16x32_bf16 v[28:31], v[24:27], v[8:11], 0
    v_bitop3_b32 v122, v8, v10, s29 bitop3:0x7e
    s_waitcnt vmcnt(0)
    v_mfma_f32_16x16x32_bf16 v[28:31], v[24:27], v[12:15], v[28:31]
    v_bitop3_b32 v123, v12, v14, s29 bitop3:0x7e
    v_bitop3_b32 v122, v122, v123, 1 bitop3:0xa8
    v_cmp_ne_u32 vcc, 0, v122
    s_cbranch_vccnz RO_45
s_nop 3
    v_add_f32_dpp v28, v28, v28 row_ror:8 row_mask:0xf bank_mask:0xf
    v_add_f32_dpp v29, v29, v29 row_ror:8 row_mask:0xf bank_mask:0xf
s_nop 0
    v_add_f32_dpp v28, v28, v28 row_ror:4 row_mask:0xf bank_mask:0xf
    v_add_f32_dpp v29, v29, v29 row_ror:4 row_mask:0xf bank_mask:0xf
    v_cvt_pk_bf16_f32 v122, v28, v29
    buffer_store_dword v122, v119, s[4:7], s24 offen
    s_xor_b32 s18, s18, 0x40000
    s_bfe_u32 s29, s16, 0x10001
    s_add_u32 s24, s24, 0x2000
    s_bitset0_b32 s24, 15
    s_branch RL_33
RO_45:
    s_sub_u32 s30, s30, 1
    s_cbranch_scc1 L_abort
    s_mov_b64 exec, vcc
    buffer_load_dwordx4 v[8:11], v118, s[4:7], s18 offen offset:0 sc1
    buffer_load_dwordx4 v[12:15], v118, s[4:7], s18 offen offset:1024 sc1
    s_mov_b64 exec, -1
    s_branch RD_44
RF_36:
    s_sub_u32 s30, s30, 1
    s_cbranch_scc1 L_abort
    s_mov_b64 exec, vcc
    buffer_load_dwordx4 v[64:67], v112, s[4:7], s23 offen sc1
    buffer_load_dwordx4 v[68:71], v112, s[4:7], s23 offen offset:1024 sc1
    s_mov_b64 exec, -1
    v_mov_b64 v[96:97], 0
    v_mov_b64 v[98:99], 0
    v_mov_b64 v[100:101], 0
    v_mov_b64 v[102:103], 0
    s_branch RC_34
KC_39:
    v_lshrrev_b32 v122, 2, v112
    buffer_load_dword v123, v122, s[4:7], s40 offen sc1
    s_sub_u32 s30, s30, 1
    s_cbranch_scc1 L_abort
    s_waitcnt vmcnt(0)
    v_cmp_ne_u32 vcc, 0, v123
    s_nop 4
    s_ff0_i32_b64 s17, vcc
    s_cmp_gt_u32 s17, s41
    s_cbranch_scc0 KC_39
    s_branch KC_40
KC_41:
    v_lshrrev_b32 v122, 2, v112
    buffer_load_dword v123, v122, s[4:7], s40 offen sc1
    s_sub_u32 s30, s30, 1
    s_cbranch_scc1 L_abort
    s_waitcnt vmcnt(0)
    v_cmp_ne_u32 vcc, 0, v123
    s_nop 4
    s_ff0_i32_b64 s17, vcc
    s_cmp_gt_u32 s17, s41
    s_cbranch_scc0 KC_41
    s_branch KC_42
RZ_43:
    s_waitcnt lgkmcnt(0)
    s_nop 7
    s_nop 7
    s_add_u32 s27, s27, 131072
    v_permlane32_swap_b32 v0, v4
    v_permlane32_swap_b32 v1, v5
    v_permlane32_swap_b32 v2, v6
    v_permlane32_swap_b32 v3, v7
    v_permlane32_swap_b32 v56, v58
    v_permlane32_swap_b32 v57, v59
    v_pk_add_f32 v[0:1], v[0:1], v[4:5]
    v_pk_add_f32 v[2:3], v[2:3], v[6:7]
    v_lshlrev_b32 v64, 16, v56
    v_and_b32 v65, 0xffff0000, v56
    v_lshlrev_b32 v66, 16, v58
    v_and_b32 v67, 0xffff0000, v58
    v_lshlrev_b32 v68, 16, v57
    v_and_b32 v69, 0xffff0000, v57
    v_lshlrev_b32 v70, 16, v59
    v_and_b32 v71, 0xffff0000, v59
    v_pk_add_f32 v[64:65], v[64:65], v[66:67]
    v_pk_add_f32 v[68:69], v[68:69], v[70:71]
    v_cvt_pk_bf16_f32 v126, v0, v1
    v_cvt_pk_bf16_f32 v127, v2, v3
    v_cvt_pk_bf16_f32 v124, v64, v65
    v_cvt_pk_bf16_f32 v125, v68, v69
    buffer_store_dwordx4 v[124:127], v113, s[4:7], s27 offen sc1
    s_branch L_rdone
RW_6:
    s_cmp_gt_u32 s17, s41
    s_cbranch_scc0 KC_52
KC_53:
    s_add_u32 s41, s41, 1
    s_mov_b32 m0, 18432
s_nop 0
    buffer_load_dwordx4 v112, s[4:7], s25 offen sc1 lds
    buffer_load_dwordx4 v112, s[4:7], s25 offen offset:1024 sc1 lds
    s_mov_b32 m0, 161792
s_nop 0
    buffer_load_dwordx4 v114, s[4:7], s26 offen sc1 lds
    s_mov_b32 m0, 162688
s_nop 0
    buffer_load_dwordx4 v114, s[4:7], s26 offen offset:128 sc1 lds
    ds_read_b128 v[32:35], v121 offset:0
    ds_read_b128 v[36:39], v121 offset:1024
    ds_read_b128 v[40:43], v121 offset:2048
    ds_read_b128 v[44:47], v121 offset:3072
    ds_read_b128 v[48:51], v121 offset:4096
    ds_read_b128 v[52:55], v121 offset:5120
    ds_read_b128 v[56:59], v121 offset:6144
    ds_read_b128 v[60:63], v121 offset:7168
    v_mov_b64 v[96:97], 0
    v_mov_b64 v[98:99], 0
    v_mov_b64 v[100:101], 0
    v_mov_b64 v[102:103], 0
    v_mov_b64 v[104:105], 0
    v_mov_b64 v[106:107], 0
    v_mov_b64 v[108:109], 0
    v_mov_b64 v[110:111], 0
    v_mov_b64 v[0:1], 0
    v_mov_b64 v[2:3], 0
    v_mov_b64 v[4:5], 0
    v_mov_b64 v[6:7], 0
    s_waitcnt vmcnt(0)
RL_46:
    ds_read_b128 v[48:51], v121 offset:4096
    ds_read_b128 v[52:55], v121 offset:5120
    ds_read_b128 v[56:59], v121 offset:6144
    ds_read_b128 v[60:63], v121 offset:7168
    ds_read_b128 v[80:83], v112 offset:18432
    ds_read_b128 v[84:87], v112 offset:19456
    ds_read_b128 v[88:91], v121 offset:32768
    ds_read_b128 v[92:95], v121 offset:33792
    s_add_u32 s25, s25, 524288
    s_add_u32 s26, s26, 524288
    buffer_load_dwordx4 v[64:67], v112, s[4:7], s23 offen sc1
    buffer_load_dwordx4 v[68:71], v112, s[4:7], s23 offen offset:1024 sc1
    s_cmp_gt_u32 s17, s41
    s_cbranch_scc0 KC_54
KC_55:
    s_add_u32 s41, s41, 1
RC_47:
    s_waitcnt vmcnt(1) lgkmcnt(0)
    v_max3_u32 v122, v64, v65, v66
    v_max_u32 v122, v122, v67
    v_smfmac_f32_16x16x64_bf16 v[96:99], v[64:67], v[32:39], v120
    ds_write_b128 v112, v[64:67] offset:6144
    s_waitcnt vmcnt(0)
    v_max3_u32 v122, v122, v68, v69
    v_smfmac_f32_16x16x64_bf16 v[100:103], v[64:67], v[40:47], v120
    v_max3_u32 v122, v122, v70, v71
    v_cmp_eq_u32 vcc, -1, v122
    s_cbranch_vccnz RF_49
    v_smfmac_f32_16x16x64_bf16 v[96:99], v[68:71], v[48:55], v120
    ds_write_b128 v112, v[68:71] offset:7168
    v_smfmac_f32_16x16x64_bf16 v[100:103], v[68:71], v[56:63], v120
    v_smfmac_f32_16x16x64_bf16 v[104:107], v[64:67], a[64:71], v120
    ds_read_b128 v[32:35], v121 offset:8192
    ds_read_b128 v[36:39], v121 offset:9216
    v_smfmac_f32_16x16x64_bf16 v[108:111], v[64:67], a[72:79], v120
    ds_read_b128 v[40:43], v121 offset:10240
    ds_read_b128 v[44:47], v121 offset:11264
    s_waitcnt lgkmcnt(4)
    s_barrier
    ds_read_b128 v[16:19], v112 offset:2048
    ds_read_b128 v[20:23], v112 offset:3072
    v_smfmac_f32_16x16x64_bf16 v[104:107], v[68:71], a[80:87], v120
    ds_read_b128 v[24:27], v112 offset:0
    ds_read_b128 v[28:31], v112 offset:1024
    v_smfmac_f32_16x16x64_bf16 v[108:111], v[68:71], a[88:95], v120
    ds_read_b128 v[8:11], v112 offset:4096
    ds_read_b128 v[12:15], v112 offset:5120
    v_smfmac_f32_16x16x64_bf16 v[0:3], v[64:67], a[192:199], v120
    ds_read_b128 v[48:51], v121 offset:12288
    ds_read_b128 v[52:55], v121 offset:13312
    v_smfmac_f32_16x16x64_bf16 v[4:7], v[64:67], a[200:207], v120
    ds_read_b128 v[56:59], v121 offset:14336
    ds_read_b128 v[60:63], v121 offset:15360
    v_smfmac_f32_16x16x64_bf16 v[0:3], v[68:71], a[208:215], v120
    v_smfmac_f32_16x16x64_bf16 v[4:7], v[68:71], a[216:223], v120
RB_51:
    s_waitcnt lgkmcnt(9)
    v_smfmac_f32_16x16x64_bf16 v[96:99], v[16:19], a[0:7], v120
    v_smfmac_f32_16x16x64_bf16 v[100:103], v[16:19], a[8:15], v120
    s_waitcnt lgkmcnt(8)
    v_smfmac_f32_16x16x64_bf16 v[96:99], v[20:23], a[16:23], v120
    v_smfmac_f32_16x16x64_bf16 v[100:103], v[20:23], a[24:31], v120
    buffer_store_dwordx4 v[124:127], v113, s[4:7], s27 offen sc1
    s_waitcnt lgkmcnt(7)
    v_smfmac_f32_16x16x64_bf16 v[96:99], v[24:27], a[32:39], v120
    v_smfmac_f32_16x16x64_bf16 v[100:103], v[24:27], a[40:47], v120
    v_mov_b64 v[124:125], -1
    s_waitcnt lgkmcnt(6)
    v_smfmac_f32_16x16x64_bf16 v[96:99], v[28:31], a[48:55], v120
    v_smfmac_f32_16x16x64_bf16 v[100:103], v[28:31], a[56:63], v120
    s_mov_b32 m0, 18432
s_nop 0
    buffer_load_dwordx4 v112, s[4:7], s25 offen sc1 lds
    s_waitcnt vmcnt(2)
    s_waitcnt lgkmcnt(5)
    v_smfmac_f32_16x16x64_bf16 v[96:99], v[8:11], v[32:39], v120
    ds_read_b128 v[76:79], v112 offset:10240
    s_waitcnt lgkmcnt(3)
    v_smfmac_f32_16x16x64_bf16 v[96:99], v[12:15], v[48:55], v120
    v_smfmac_f32_16x16x64_bf16 v[100:103], v[8:11], v[40:47], v120
    s_waitcnt lgkmcnt(1)
    v_smfmac_f32_16x16x64_bf16 v[100:103], v[12:15], v[56:63], v120
    buffer_load_dwordx4 v112, s[4:7], s25 offen offset:1024 sc1 lds
    v_cvt_pk_bf16_f32 v122, v96, v97
    v_smfmac_f32_16x16x64_bf16 v[104:107], v[8:11], a[96:103], v120
    ds_read_b128 v[32:35], v121 offset:22528
    v_cvt_pk_bf16_f32 v123, v98, v99
    v_smfmac_f32_16x16x64_bf16 v[104:107], v[12:15], a[112:119], v120
    ds_read_b128 v[36:39], v121 offset:23552
    v_cvt_pk_bf16_f32 v60, v100, v101
    s_waitcnt lgkmcnt(2)
    v_mfma_f32_16x16x16_bf16 v[96:99], v[122:123], v[76:77], 0
    v_cvt_pk_bf16_f32 v61, v102, v103
    v_smfmac_f32_16x16x64_bf16 v[104:107], v[16:19], a[128:135], v120
    ds_read_b128 v[40:43], v121 offset:30720
    v_mfma_f32_16x16x16_bf16 v[100:103], v[60:61], v[76:77], 0
    v_smfmac_f32_16x16x64_bf16 v[104:107], v[20:23], a[144:151], v120
    s_mov_b32 m0, 161792
s_nop 0
    buffer_load_dwordx4 v114, s[4:7], s26 offen sc1 lds
    ds_read_b128 v[44:47], v121 offset:31744
    v_cvt_pk_bf16_f32 v72, v96, v97
    v_smfmac_f32_16x16x64_bf16 v[104:107], v[24:27], a[160:167], v120
    ds_read_b128 v[48:51], v121 offset:20480
    v_cvt_pk_bf16_f32 v73, v98, v99
    v_smfmac_f32_16x16x64_bf16 v[104:107], v[28:31], a[176:183], v120
    ds_read_b128 v[52:55], v121 offset:21504
    v_cvt_pk_bf16_f32 v74, v100, v101
    v_smfmac_f32_16x16x64_bf16 v[108:111], v[8:11], a[104:111], v120
    ds_read_b128 v[64:67], v121 offset:18432
    v_cvt_pk_bf16_f32 v75, v102, v103
    v_smfmac_f32_16x16x64_bf16 v[108:111], v[12:15], a[120:127], v120
    s_mov_b32 m0, 162688
s_nop 0
    buffer_load_dwordx4 v114, s[4:7], s26 offen offset:128 sc1 lds
    ds_read_b128 v[68:71], v121 offset:19456
    v_cvt_pk_bf16_f32 v56, v104, v105
    v_smfmac_f32_16x16x64_bf16 v[108:111], v[16:19], a[136:143], v120
    v_cvt_pk_bf16_f32 v57, v106, v107
    v_smfmac_f32_16x16x64_bf16 v[108:111], v[20:23], a[152:159], v120
    v_smfmac_f32_16x16x64_bf16 v[108:111], v[24:27], a[168:175], v120
    v_smfmac_f32_16x16x64_bf16 v[108:111], v[28:31], a[184:191], v120
    buffer_store_dword v124, v119, s[4:7], s28 offen
    v_mfma_f32_16x16x16_bf16 v[104:107], v[56:57], v[78:79], 0
    v_mfma_f32_16x16x32_bf16 v[96:99], v[80:83], v[72:75], 0
    v_cvt_pk_bf16_f32 v58, v108, v109
    v_cvt_pk_bf16_f32 v59, v110, v111
s_nop 1
    v_cvt_pk_bf16_f32 v60, v104, v105
    v_cvt_pk_bf16_f32 v61, v106, v107
    v_mfma_f32_16x16x16_bf16 v[108:111], v[58:59], v[78:79], 0
    v_mov_b64 v[76:77], s[38:39]
    v_mov_b64 v[78:79], s[38:39]
    v_mfma_f32_16x16x32_bf16 v[100:103], v[84:87], v[72:75], 0
    v_smfmac_f32_16x16x64_bf16 v[0:3], v[8:11], a[224:231], v120
    v_cvt_pk_bf16_f32 v62, v108, v109
    v_cvt_pk_bf16_f32 v63, v110, v111
s_nop 1
    v_mov_b32_dpp v96, v100 quad_perm:[0,1,2,3] row_mask:0xf bank_mask:0xc
    v_mov_b32_dpp v97, v101 quad_perm:[0,1,2,3] row_mask:0xf bank_mask:0xc
    v_mfma_f32_16x16x32_bf16 v[104:107], v[60:63], v[72:75], 0
    v_mov_b32_dpp v98, v102 quad_perm:[0,1,2,3] row_mask:0xf bank_mask:0xc
    v_mov_b32_dpp v99, v103 quad_perm:[0,1,2,3] row_mask:0xf bank_mask:0xc
    v_smfmac_f32_16x16x64_bf16 v[0:3], v[12:15], a[240:247], v120
    ds_write_b128 v112, v[96:99] offset:23552
    v_smfmac_f32_16x16x64_bf16 v[0:3], v[16:19], v[128:135], v120
    ds_write_b64 v113, v[104:105] offset:11272
    v_smfmac_f32_16x16x64_bf16 v[0:3], v[20:23], v[144:151], v120
    v_smfmac_f32_16x16x64_bf16 v[0:3], v[24:27], v[160:167], v120
    v_smfmac_f32_16x16x64_bf16 v[0:3], v[28:31], v[176:183], v120
    v_smfmac_f32_16x16x64_bf16 v[4:7], v[8:11], a[232:239], v120
    s_waitcnt lgkmcnt(0)
    s_barrier
    ds_read_b128 v[104:107], v112 offset:8192
    ds_read_b128 v[108:111], v112 offset:11264
    v_smfmac_f32_16x16x64_bf16 v[4:7], v[12:15], a[248:255], v120
    ds_read_b128 v[80:83], v112 offset:22528
    ds_read_b128 v[84:87], v112 offset:21504
    v_smfmac_f32_16x16x64_bf16 v[4:7], v[16:19], v[136:143], v120
    ds_read_b128 v[100:103], v112 offset:20480
    v_cvt_pk_bf16_f32 v72, v0, v1
    v_smfmac_f32_16x16x64_bf16 v[4:7], v[20:23], v[152:159], v120
    v_cvt_pk_bf16_f32 v73, v2, v3
    v_smfmac_f32_16x16x64_bf16 v[4:7], v[24:27], v[168:175], v120
    s_cmp_eq_u32 s16, 63
    v_smfmac_f32_16x16x64_bf16 v[4:7], v[28:31], v[184:191], v120
    s_cbranch_scc1 RZ_56
    ds_read_b128 v[16:19], v121 offset:28672
    ds_read_b128 v[20:23], v121 offset:29696
    ds_read_b128 v[24:27], v121 offset:26624
    ds_read_b128 v[28:31], v121 offset:27648
    s_waitcnt lgkmcnt(7)
    v_pk_add_f32 v[104:105], v[104:105], v[106:107]
    v_pk_add_f32 v[108:109], v[108:109], v[110:111]
    s_waitcnt lgkmcnt(6)
    v_pk_add_f32 v[96:97], v[96:97], v[80:81]
    v_pk_add_f32 v[98:99], v[98:99], v[82:83]
    s_waitcnt lgkmcnt(4)
    v_pk_add_f32 v[84:85], v[84:85], v[100:101]
    v_pk_add_f32 v[86:87], v[86:87], v[102:103]
    v_pk_add_f32 v[100:101], v[104:105], v[108:109]
    v_pk_add_f32 v[96:97], v[96:97], v[84:85]
    v_pk_add_f32 v[98:99], v[98:99], v[86:87]
    v_max3_f32 v122, v100, v101, v96
    v_max3_f32 v123, v97, v98, v99
    v_max_f32 v102, v122, v123
    v_cvt_pk_bf16_f32 v74, v4, v5
    v_cvt_pk_bf16_f32 v75, v6, v7
    v_max_f32_dpp v122, v102, v102 row_ror:8 row_mask:0xf bank_mask:0xf
    v_max_f32_dpp v123, v102, v102 row_ror:8 row_mask:0xf bank_mask:0xf
    v_mov_b64 v[110:111], s[34:35]
s_nop 0
    v_permlane16_swap_b32 v122, v123
    v_max_f32 v102, v122, v123
    v_max_f32 v103, v122, v123
s_nop 1
    v_permlane32_swap_b32 v102, v103
    v_max_f32 v122, v102, v103
    v_mul_f32 v122, s32, v122
    v_pk_fma_f32 v[100:101], v[100:101], s[32:33], v[122:123] op_sel_hi:[1,1,0] neg_lo:[0,0,1] neg_hi:[0,0,1]
    v_pk_fma_f32 v[96:97], v[96:97], s[32:33], v[122:123] op_sel_hi:[1,1,0] neg_lo:[0,0,1] neg_hi:[0,0,1]
    v_pk_fma_f32 v[98:99], v[98:99], s[32:33], v[122:123] op_sel_hi:[1,1,0] neg_lo:[0,0,1] neg_hi:[0,0,1]
    v_exp_f32 v100, v100
    v_exp_f32 v101, v101
    v_exp_f32 v96, v96
    v_cvt_pk_bf16_f32 v108, v100, v101
    v_exp_f32 v97, v97
    v_exp_f32 v98, v98
    v_mov_b32_dpp v109, v108 row_ror:8 row_mask:0xf bank_mask:0xf
    v_cvt_pk_bf16_f32 v104, v96, v97
    v_exp_f32 v99, v99
    v_mfma_f32_16x16x16_bf16 v[60:63], v[110:111], v[108:109], 0
    v_cvt_pk_bf16_f32 v105, v98, v99
    v_mov_b32_dpp v106, v104 row_ror:8 row_mask:0xf bank_mask:0xf
    v_mfma_f32_16x16x16_bf16 v[100:103], v[74:75], v[108:109], 0
    v_mov_b32_dpp v107, v105 row_ror:8 row_mask:0xf bank_mask:0xf
    v_mfma_f32_16x16x16_bf16 v[96:99], v[72:73], v[108:109], 0
    ds_read_b128 v[80:83], v121 offset:16384
    ds_read_b128 v[84:87], v121 offset:17408
    v_mfma_f32_16x16x32_bf16 v[60:63], v[76:79], v[104:107], v[60:63]
    v_mfma_f32_16x16x32_bf16 v[100:103], v[92:95], v[104:107], v[100:103]
    v_mfma_f32_16x16x32_bf16 v[96:99], v[88:91], v[104:107], v[96:99]
    v_mov_b64 v[104:105], 0
    v_rcp_f32 v122, v60
    v_mov_b64 v[106:107], 0
    v_mov_b64 v[108:109], 0
    v_pk_mul_f32 v[100:101], v[100:101], v[122:123] op_sel_hi:[1,0]
    v_pk_mul_f32 v[102:103], v[102:103], v[122:123] op_sel_hi:[1,0]
    v_cvt_pk_bf16_f32 v74, v100, v101
    v_cvt_pk_bf16_f32 v75, v102, v103
    v_pk_mul_f32 v[96:97], v[96:97], v[122:123] op_sel_hi:[1,0]
    v_pk_mul_f32 v[98:99], v[98:99], v[122:123] op_sel_hi:[1,0]
    v_cvt_pk_bf16_f32 v72, v96, v97
    v_cvt_pk_bf16_f32 v73, v98, v99
    ds_write_b128 v116, v[72:75] offset:3072
    v_mov_b32_dpp v74, v74 row_ror:8 row_mask:0xf bank_mask:0xc
    v_mov_b32_dpp v75, v75 row_ror:8 row_mask:0xf bank_mask:0xc
    v_mov_b32_dpp v72, v72 row_ror:8 row_mask:0xf bank_mask:0xc
    v_mov_b32_dpp v73, v73 row_ror:8 row_mask:0xf bank_mask:0xc
    v_mov_b64 v[110:111], 0
    v_mov_b64 v[96:97], 0
    v_smfmac_f32_16x16x64_bf16 v[104:107], v[72:75], v[32:39], v120
    ds_read_b128 v[88:91], v121 offset:24576
    ds_read_b128 v[92:95], v121 offset:25600
    v_mov_b64 v[98:99], 0
    v_smfmac_f32_16x16x64_bf16 v[108:111], v[72:75], v[40:47], v120
    v_mov_b64 v[100:101], 0
    v_mov_b64 v[102:103], 0
    s_waitcnt lgkmcnt(2)
    s_barrier
    ds_read_b128 v[8:11], v115 offset:2048
    ds_read_b128 v[12:15], v115 offset:1024
    ds_read_b128 v[76:79], v115 offset:0
    v_smfmac_f32_16x16x64_bf16 v[96:99], v[72:75], v[216:223], v120
    v_smfmac_f32_16x16x64_bf16 v[100:103], v[72:75], v[248:255], v120
    s_waitcnt lgkmcnt(2)
    v_smfmac_f32_16x16x64_bf16 v[96:99], v[8:11], v[208:215], v120
    s_waitcnt lgkmcnt(1)
    v_smfmac_f32_16x16x64_bf16 v[96:99], v[12:15], v[200:207], v120
    s_waitcnt lgkmcnt(0)
    v_smfmac_f32_16x16x64_bf16 v[96:99], v[76:79], v[192:199], v120
    v_smfmac_f32_16x16x64_bf16 v[100:103], v[8:11], v[240:247], v120
    v_smfmac_f32_16x16x64_bf16 v[100:103], v[12:15], v[232:239], v120
    v_cvt_pk_bf16_f32 v96, v96, v97
    v_smfmac_f32_16x16x64_bf16 v[100:103], v[76:79], v[224:231], v120
    v_cvt_pk_bf16_f32 v97, v98, v99
    v_smfmac_f32_16x16x64_bf16 v[104:107], v[8:11], v[48:55], v120
    v_and_or_b32 v96, v96, -2, s29
    v_smfmac_f32_16x16x64_bf16 v[104:107], v[12:15], v[64:71], v120
    buffer_store_dwordx2 v[96:97], v117, s[4:7], s18 offen
    v_cvt_pk_bf16_f32 v100, v100, v101
    v_smfmac_f32_16x16x64_bf16 v[104:107], v[76:79], v[80:87], v120
    v_cvt_pk_bf16_f32 v101, v102, v103
    v_smfmac_f32_16x16x64_bf16 v[108:111], v[8:11], v[16:23], v120
    v_and_or_b32 v100, v100, -2, s29
    v_smfmac_f32_16x16x64_bf16 v[108:111], v[12:15], v[24:31], v120
    buffer_store_dwordx2 v[100:101], v117, s[4:7], s19 offen
    v_cvt_pk_bf16_f32 v104, v104, v105
    v_smfmac_f32_16x16x64_bf16 v[108:111], v[76:79], v[88:95], v120
    ds_read_b128 v[24:27], v112 offset:9216
    v_cvt_pk_bf16_f32 v105, v106, v107
    v_and_or_b32 v104, v104, -2, s29
    buffer_store_dwordx2 v[104:105], v117, s[4:7], s20 offen
    v_permlane32_swap_b32 v0, v4
    v_permlane32_swap_b32 v1, v5
s_nop 1
    v_cvt_pk_bf16_f32 v108, v108, v109
    v_cvt_pk_bf16_f32 v109, v110, v111
    v_and_or_b32 v108, v108, -2, s29
    buffer_store_dwordx2 v[108:109], v117, s[4:7], s21 offen
    s_xor_b32 s19, s19, 0x40000
    s_xor_b32 s20, s20, 0x40000
    s_xor_b32 s21, s21, 0x40000
    s_add_u32 s23, s23, 0x2000
    s_bitset0_b32 s23, 15
    s_add_u32 s28, s28, 0x2000
    s_bitset0_b32 s28, 15
    s_add_u32 s27, s27, 131072
    s_add_u32 s16, s16, 1
    v_permlane32_swap_b32 v2, v6
    v_permlane32_swap_b32 v3, v7
    v_permlane32_swap_b32 v56, v58
    v_permlane32_swap_b32 v57, v59
    v_pk_add_f32 v[0:1], v[0:1], v[4:5]
    v_pk_add_f32 v[2:3], v[2:3], v[6:7]
    v_lshlrev_b32 v64, 16, v56
    v_and_b32 v65, 0xffff0000, v56
    v_lshlrev_b32 v66, 16, v58
    v_and_b32 v67, 0xffff0000, v58
    v_lshlrev_b32 v68, 16, v57
    v_and_b32 v69, 0xffff0000, v57
    v_lshlrev_b32 v70, 16, v59
    v_and_b32 v71, 0xffff0000, v59
    v_pk_add_f32 v[64:65], v[64:65], v[66:67]
    v_pk_add_f32 v[68:69], v[68:69], v[70:71]
    v_cvt_pk_bf16_f32 v126, v0, v1
    v_cvt_pk_bf16_f32 v127, v2, v3
    v_cvt_pk_bf16_f32 v124, v64, v65
    v_cvt_pk_bf16_f32 v125, v68, v69
    v_mov_b64 v[0:1], 0
    v_mov_b64 v[2:3], 0
    v_mov_b64 v[4:5], 0
    v_mov_b64 v[6:7], 0
    v_mov_b64 v[96:97], 0
    v_mov_b64 v[98:99], 0
    v_mov_b64 v[100:101], 0
    v_mov_b64 v[102:103], 0
    v_mov_b64 v[104:105], 0
    v_mov_b64 v[106:107], 0
    v_mov_b64 v[108:109], 0
    v_mov_b64 v[110:111], 0
    ds_read_b128 v[32:35], v121 offset:0
    ds_read_b128 v[36:39], v121 offset:1024
    ds_read_b128 v[40:43], v121 offset:2048
    ds_read_b128 v[44:47], v121 offset:3072
    buffer_load_dwordx4 v[8:11], v118, s[4:7], s18 offen offset:0 sc1
    buffer_load_dwordx4 v[12:15], v118, s[4:7], s18 offen offset:1024 sc1
    s_waitcnt lgkmcnt(4)
    s_barrier
RD_57:
    s_waitcnt vmcnt(1)
    v_mfma_f32_16x16x32_bf16 v[28:31], v[24:27], v[8:11], 0
    v_bitop3_b32 v122, v8, v10, s29 bitop3:0x7e
    s_waitcnt vmcnt(0)
    v_mfma_f32_16x16x32_bf16 v[28:31], v[24:27], v[12:15], v[28:31]
    v_bitop3_b32 v123, v12, v14, s29 bitop3:0x7e
    v_bitop3_b32 v122, v122, v123, 1 bitop3:0xa8
    v_cmp_ne_u32 vcc, 0, v122
    s_cbranch_vccnz RO_58
s_nop 3
    v_add_f32_dpp v28, v28, v28 row_ror:8 row_mask:0xf bank_mask:0xf
    v_add_f32_dpp v29, v29, v29 row_ror:8 row_mask:0xf bank_mask:0xf
s_nop 0
    v_add_f32_dpp v28, v28, v28 row_ror:4 row_mask:0xf bank_mask:0xf
    v_add_f32_dpp v29, v29, v29 row_ror:4 row_mask:0xf bank_mask:0xf
    v_cvt_pk_bf16_f32 v122, v28, v29
    buffer_store_dword v122, v119, s[4:7], s24 offen
    s_xor_b32 s18, s18, 0x40000
    s_bfe_u32 s29, s16, 0x10001
    s_add_u32 s24, s24, 0x2000
    s_bitset0_b32 s24, 15
    s_branch RL_46
RO_58:
    s_sub_u32 s30, s30, 1
    s_cbranch_scc1 L_abort
    s_mov_b64 exec, vcc
    buffer_load_dwordx4 v[8:11], v118, s[4:7], s18 offen offset:0 sc1
    buffer_load_dwordx4 v[12:15], v118, s[4:7], s18 offen offset:1024 sc1
    s_mov_b64 exec, -1
    s_branch RD_57
RF_49:
    s_sub_u32 s30, s30, 1
    s_cbranch_scc1 L_abort
    s_mov_b64 exec, vcc
    buffer_load_dwordx4 v[64:67], v112, s[4:7], s23 offen sc1
    buffer_load_dwordx4 v[68:71], v112, s[4:7], s23 offen offset:1024 sc1
    s_mov_b64 exec, -1
    v_mov_b64 v[96:97], 0
    v_mov_b64 v[98:99], 0
    v_mov_b64 v[100:101], 0
    v_mov_b64 v[102:103], 0
    s_branch RC_47
KC_52:
    v_lshrrev_b32 v122, 2, v112
    buffer_load_dword v123, v122, s[4:7], s40 offen sc1
    s_sub_u32 s30, s30, 1
    s_cbranch_scc1 L_abort
    s_waitcnt vmcnt(0)
    v_cmp_ne_u32 vcc, 0, v123
    s_nop 4
    s_ff0_i32_b64 s17, vcc
    s_cmp_gt_u32 s17, s41
    s_cbranch_scc0 KC_52
    s_branch KC_53
KC_54:
    v_lshrrev_b32 v122, 2, v112
    buffer_load_dword v123, v122, s[4:7], s40 offen sc1
    s_sub_u32 s30, s30, 1
    s_cbranch_scc1 L_abort
    s_waitcnt vmcnt(0)
    v_cmp_ne_u32 vcc, 0, v123
    s_nop 4
    s_ff0_i32_b64 s17, vcc
    s_cmp_gt_u32 s17, s41
    s_cbranch_scc0 KC_54
    s_branch KC_55
RZ_56:
    s_waitcnt lgkmcnt(0)
    s_nop 7
    s_nop 7
    s_add_u32 s27, s27, 131072
    v_permlane32_swap_b32 v0, v4
    v_permlane32_swap_b32 v1, v5
    v_permlane32_swap_b32 v2, v6
    v_permlane32_swap_b32 v3, v7
    v_permlane32_swap_b32 v56, v58
    v_permlane32_swap_b32 v57, v59
    v_pk_add_f32 v[0:1], v[0:1], v[4:5]
    v_pk_add_f32 v[2:3], v[2:3], v[6:7]
    v_lshlrev_b32 v64, 16, v56
    v_and_b32 v65, 0xffff0000, v56
    v_lshlrev_b32 v66, 16, v58
    v_and_b32 v67, 0xffff0000, v58
    v_lshlrev_b32 v68, 16, v57
    v_and_b32 v69, 0xffff0000, v57
    v_lshlrev_b32 v70, 16, v59
    v_and_b32 v71, 0xffff0000, v59
    v_pk_add_f32 v[64:65], v[64:65], v[66:67]
    v_pk_add_f32 v[68:69], v[68:69], v[70:71]
    v_cvt_pk_bf16_f32 v126, v0, v1
    v_cvt_pk_bf16_f32 v127, v2, v3
    v_cvt_pk_bf16_f32 v124, v64, v65
    v_cvt_pk_bf16_f32 v125, v68, v69
    buffer_store_dwordx4 v[124:127], v113, s[4:7], s27 offen sc1
    s_branch L_rdone
L_safe:
    s_cmp_eq_u32 s15, 1
    s_cbranch_scc1 RW_60
    s_cmp_eq_u32 s15, 2
    s_cbranch_scc1 RW_61
    s_cmp_eq_u32 s15, 3
    s_cbranch_scc1 RW_62
RW_59:
    s_cmp_gt_u32 s17, s41
    s_cbranch_scc0 KC_69
KC_70:
    s_add_u32 s41, s41, 1
    s_mov_b32 m0, 12288
s_nop 0
    buffer_load_dwordx4 v112, s[4:7], s25 offen sc1 lds
    buffer_load_dwordx4 v112, s[4:7], s25 offen offset:1024 sc1 lds
    s_mov_b32 m0, 57344
s_nop 0
    buffer_load_dwordx4 v114, s[4:7], s26 offen sc1 lds
    s_mov_b32 m0, 58240
s_nop 0
    buffer_load_dwordx4 v114, s[4:7], s26 offen offset:128 sc1 lds
    ds_read_b128 v[32:35], v121 offset:0
    ds_read_b128 v[36:39], v121 offset:1024
    ds_read_b128 v[40:43], v121 offset:2048
    ds_read_b128 v[44:47], v121 offset:3072
    ds_read_b128 v[48:51], v121 offset:4096
    ds_read_b128 v[52:55], v121 offset:5120
    ds_read_b128 v[56:59], v121 offset:6144
    ds_read_b128 v[60:63], v121 offset:7168
    v_mov_b64 v[96:97], 0
    v_mov_b64 v[98:99], 0
    v_mov_b64 v[100:101], 0
    v_mov_b64 v[102:103], 0
    v_mov_b64 v[104:105], 0
    v_mov_b64 v[106:107], 0
    v_mov_b64 v[108:109], 0
    v_mov_b64 v[110:111], 0
    v_mov_b64 v[0:1], 0
    v_mov_b64 v[2:3], 0
    v_mov_b64 v[4:5], 0
    v_mov_b64 v[6:7], 0
    s_waitcnt vmcnt(0)
RL_63:
    ds_read_b128 v[48:51], v121 offset:4096
    ds_read_b128 v[52:55], v121 offset:5120
    ds_read_b128 v[56:59], v121 offset:6144
    ds_read_b128 v[60:63], v121 offset:7168
    ds_read_b128 v[80:83], v112 offset:12288
    ds_read_b128 v[84:87], v112 offset:13312
    ds_read_b128 v[88:91], v121 offset:32768
    ds_read_b128 v[92:95], v121 offset:33792
    s_add_u32 s25, s25, 524288
    s_add_u32 s26, s26, 524288
    buffer_load_dwordx4 v[64:67], v112, s[4:7], s23 offen sc1
    buffer_load_dwordx4 v[68:71], v112, s[4:7], s23 offen offset:1024 sc1
    s_cmp_gt_u32 s17, s41
    s_cbranch_scc0 KC_71
KC_72:
    s_add_u32 s41, s41, 1
RC_64:
    s_waitcnt vmcnt(1) lgkmcnt(0)
    v_max3_u32 v122, v64, v65, v66
    v_max_u32 v122, v122, v67
    v_smfmac_f32_16x16x64_bf16 v[96:99], v[64:67], v[32:39], v120
    ds_write_b128 v112, v[64:67] offset:0
    s_waitcnt vmcnt(0)
    v_max3_u32 v122, v122, v68, v69
    v_smfmac_f32_16x16x64_bf16 v[100:103], v[64:67], v[40:47], v120
    v_max3_u32 v122, v122, v70, v71
    v_cmp_eq_u32 vcc, -1, v122
    s_cbranch_vccnz RF_66
    v_smfmac_f32_16x16x64_bf16 v[96:99], v[68:71], v[48:55], v120
    ds_write_b128 v112, v[68:71] offset:1024
    v_smfmac_f32_16x16x64_bf16 v[100:103], v[68:71], v[56:63], v120
    v_smfmac_f32_16x16x64_bf16 v[104:107], v[64:67], a[64:71], v120
    ds_read_b128 v[32:35], v121 offset:8192
    ds_read_b128 v[36:39], v121 offset:9216
    v_smfmac_f32_16x16x64_bf16 v[108:111], v[64:67], a[72:79], v120
    ds_read_b128 v[40:43], v121 offset:10240
    ds_read_b128 v[44:47], v121 offset:11264
    s_waitcnt lgkmcnt(4)
    s_barrier
    ds_read_b128 v[16:19], v112 offset:4096
    ds_read_b128 v[20:23], v112 offset:5120
    v_smfmac_f32_16x16x64_bf16 v[104:107], v[68:71], a[80:87], v120
    ds_read_b128 v[24:27], v112 offset:6144
    ds_read_b128 v[28:31], v112 offset:7168
    v_smfmac_f32_16x16x64_bf16 v[108:111], v[68:71], a[88:95], v120
    ds_read_b128 v[8:11], v112 offset:2048
    ds_read_b128 v[12:15], v112 offset:3072
    v_smfmac_f32_16x16x64_bf16 v[0:3], v[64:67], a[192:199], v120
    ds_read_b128 v[48:51], v121 offset:12288
    ds_read_b128 v[52:55], v121 offset:13312
    v_smfmac_f32_16x16x64_bf16 v[4:7], v[64:67], a[200:207], v120
    ds_read_b128 v[56:59], v121 offset:14336
    ds_read_b128 v[60:63], v121 offset:15360
    v_smfmac_f32_16x16x64_bf16 v[0:3], v[68:71], a[208:215], v120
    v_smfmac_f32_16x16x64_bf16 v[4:7], v[68:71], a[216:223], v120
RB_68:
    s_waitcnt lgkmcnt(9)
    v_smfmac_f32_16x16x64_bf16 v[96:99], v[16:19], a[0:7], v120
    buffer_store_dwordx4 v[124:127], v113, s[4:7], s27 offen sc1
    v_smfmac_f32_16x16x64_bf16 v[100:103], v[16:19], a[8:15], v120
    s_waitcnt lgkmcnt(8)
    v_smfmac_f32_16x16x64_bf16 v[96:99], v[20:23], a[16:23], v120
    v_smfmac_f32_16x16x64_bf16 v[100:103], v[20:23], a[24:31], v120
    s_waitcnt lgkmcnt(7)
    v_smfmac_f32_16x16x64_bf16 v[96:99], v[24:27], a[32:39], v120
    s_mov_b32 m0, 12288
s_nop 0
    buffer_load_dwordx4 v112, s[4:7], s25 offen sc1 lds
    v_smfmac_f32_16x16x64_bf16 v[100:103], v[24:27], a[40:47], v120
    v_mov_b64 v[124:125], -1
    s_waitcnt lgkmcnt(6)
    v_smfmac_f32_16x16x64_bf16 v[96:99], v[28:31], a[48:55], v120
    v_smfmac_f32_16x16x64_bf16 v[100:103], v[28:31], a[56:63], v120
    s_waitcnt vmcnt(2)
    s_waitcnt lgkmcnt(5)
    v_smfmac_f32_16x16x64_bf16 v[96:99], v[8:11], v[32:39], v120
    buffer_load_dwordx4 v112, s[4:7], s25 offen offset:1024 sc1 lds
    ds_read_b128 v[76:79], v112 offset:10240
    s_waitcnt lgkmcnt(3)
    v_smfmac_f32_16x16x64_bf16 v[96:99], v[12:15], v[48:55], v120
    v_smfmac_f32_16x16x64_bf16 v[100:103], v[8:11], v[40:47], v120
    s_waitcnt lgkmcnt(1)
    v_smfmac_f32_16x16x64_bf16 v[100:103], v[12:15], v[56:63], v120
    v_cvt_pk_bf16_f32 v122, v96, v97
    v_smfmac_f32_16x16x64_bf16 v[104:107], v[8:11], a[96:103], v120
    s_mov_b32 m0, 57344
s_nop 0
    buffer_load_dwordx4 v114, s[4:7], s26 offen sc1 lds
    ds_read_b128 v[32:35], v121 offset:16384
    v_cvt_pk_bf16_f32 v123, v98, v99
    v_smfmac_f32_16x16x64_bf16 v[104:107], v[12:15], a[112:119], v120
    ds_read_b128 v[36:39], v121 offset:17408
    v_cvt_pk_bf16_f32 v60, v100, v101
    s_waitcnt lgkmcnt(2)
    v_mfma_f32_16x16x16_bf16 v[96:99], v[122:123], v[76:77], 0
    v_cvt_pk_bf16_f32 v61, v102, v103
    v_smfmac_f32_16x16x64_bf16 v[104:107], v[16:19], a[128:135], v120
    ds_read_b128 v[40:43], v121 offset:24576
    v_mfma_f32_16x16x16_bf16 v[100:103], v[60:61], v[76:77], 0
    v_smfmac_f32_16x16x64_bf16 v[104:107], v[20:23], a[144:151], v120
    ds_read_b128 v[44:47], v121 offset:25600
    v_cvt_pk_bf16_f32 v72, v96, v97
    v_smfmac_f32_16x16x64_bf16 v[104:107], v[24:27], a[160:167], v120
    s_mov_b32 m0, 58240
s_nop 0
    buffer_load_dwordx4 v114, s[4:7], s26 offen offset:128 sc1 lds
    ds_read_b128 v[48:51], v121 offset:18432
    v_cvt_pk_bf16_f32 v73, v98, v99
    v_smfmac_f32_16x16x64_bf16 v[104:107], v[28:31], a[176:183], v120
    ds_read_b128 v[52:55], v121 offset:19456
    v_cvt_pk_bf16_f32 v74, v100, v101
    v_smfmac_f32_16x16x64_bf16 v[108:111], v[8:11], a[104:111], v120
    ds_read_b128 v[64:67], v121 offset:20480
    v_cvt_pk_bf16_f32 v75, v102, v103
    v_smfmac_f32_16x16x64_bf16 v[108:111], v[12:15], a[120:127], v120
    ds_read_b128 v[68:71], v121 offset:21504
    v_cvt_pk_bf16_f32 v56, v104, v105
    v_smfmac_f32_16x16x64_bf16 v[108:111], v[16:19], a[136:143], v120
    buffer_store_dword v124, v119, s[4:7], s28 offen sc1
    v_cvt_pk_bf16_f32 v57, v106, v107
    v_smfmac_f32_16x16x64_bf16 v[108:111], v[20:23], a[152:159], v120
    v_smfmac_f32_16x16x64_bf16 v[108:111], v[24:27], a[168:175], v120
    v_smfmac_f32_16x16x64_bf16 v[108:111], v[28:31], a[184:191], v120
    v_mfma_f32_16x16x16_bf16 v[104:107], v[56:57], v[78:79], 0
    v_mfma_f32_16x16x32_bf16 v[96:99], v[80:83], v[72:75], 0
    v_cvt_pk_bf16_f32 v58, v108, v109
    v_cvt_pk_bf16_f32 v59, v110, v111
s_nop 1
    v_cvt_pk_bf16_f32 v60, v104, v105
    v_cvt_pk_bf16_f32 v61, v106, v107
    v_mfma_f32_16x16x16_bf16 v[108:111], v[58:59], v[78:79], 0
    v_mov_b64 v[76:77], s[38:39]
    v_mov_b64 v[78:79], s[38:39]
    v_mfma_f32_16x16x32_bf16 v[100:103], v[84:87], v[72:75], 0
    v_smfmac_f32_16x16x64_bf16 v[0:3], v[8:11], a[224:231], v120
    v_cvt_pk_bf16_f32 v62, v108, v109
    v_cvt_pk_bf16_f32 v63, v110, v111
s_nop 1
    v_mov_b32_dpp v96, v100 quad_perm:[0,1,2,3] row_mask:0xf bank_mask:0xc
    v_mov_b32_dpp v97, v101 quad_perm:[0,1,2,3] row_mask:0xf bank_mask:0xc
    v_mfma_f32_16x16x32_bf16 v[104:107], v[60:63], v[72:75], 0
    v_mov_b32_dpp v98, v102 quad_perm:[0,1,2,3] row_mask:0xf bank_mask:0xc
    v_mov_b32_dpp v99, v103 quad_perm:[0,1,2,3] row_mask:0xf bank_mask:0xc
    v_smfmac_f32_16x16x64_bf16 v[0:3], v[12:15], a[240:247], v120
    ds_write_b128 v112, v[96:99] offset:20480
    v_smfmac_f32_16x16x64_bf16 v[0:3], v[16:19], v[128:135], v120
    ds_write_b64 v113, v[104:105] offset:8192
    v_smfmac_f32_16x16x64_bf16 v[0:3], v[20:23], v[144:151], v120
    v_smfmac_f32_16x16x64_bf16 v[0:3], v[24:27], v[160:167], v120
    v_smfmac_f32_16x16x64_bf16 v[0:3], v[28:31], v[176:183], v120
    v_smfmac_f32_16x16x64_bf16 v[4:7], v[8:11], a[232:239], v120
    s_waitcnt lgkmcnt(0)
    s_barrier
    ds_read_b128 v[104:107], v112 offset:8192
    ds_read_b128 v[108:111], v112 offset:11264
    v_smfmac_f32_16x16x64_bf16 v[4:7], v[12:15], a[248:255], v120
    ds_read_b128 v[80:83], v112 offset:21504
    ds_read_b128 v[84:87], v112 offset:22528
    v_smfmac_f32_16x16x64_bf16 v[4:7], v[16:19], v[136:143], v120
    ds_read_b128 v[100:103], v112 offset:23552
    v_cvt_pk_bf16_f32 v72, v0, v1
    v_smfmac_f32_16x16x64_bf16 v[4:7], v[20:23], v[152:159], v120
    v_cvt_pk_bf16_f32 v73, v2, v3
    v_smfmac_f32_16x16x64_bf16 v[4:7], v[24:27], v[168:175], v120
    s_cmp_eq_u32 s16, 63
    v_smfmac_f32_16x16x64_bf16 v[4:7], v[28:31], v[184:191], v120
    s_cbranch_scc1 RZ_73
    ds_read_b128 v[16:19], v121 offset:26624
    ds_read_b128 v[20:23], v121 offset:27648
    ds_read_b128 v[24:27], v121 offset:28672
    ds_read_b128 v[28:31], v121 offset:29696
    s_waitcnt lgkmcnt(7)
    v_pk_add_f32 v[104:105], v[104:105], v[106:107]
    v_pk_add_f32 v[108:109], v[108:109], v[110:111]
    s_waitcnt lgkmcnt(6)
    v_pk_add_f32 v[96:97], v[96:97], v[80:81]
    v_pk_add_f32 v[98:99], v[98:99], v[82:83]
    s_waitcnt lgkmcnt(4)
    v_pk_add_f32 v[84:85], v[84:85], v[100:101]
    v_pk_add_f32 v[86:87], v[86:87], v[102:103]
    v_pk_add_f32 v[100:101], v[104:105], v[108:109]
    v_pk_add_f32 v[96:97], v[96:97], v[84:85]
    v_pk_add_f32 v[98:99], v[98:99], v[86:87]
    v_max3_f32 v122, v100, v101, v96
    v_max3_f32 v123, v97, v98, v99
    v_max_f32 v102, v122, v123
    v_cvt_pk_bf16_f32 v74, v4, v5
    v_cvt_pk_bf16_f32 v75, v6, v7
    v_max_f32_dpp v122, v102, v102 row_ror:8 row_mask:0xf bank_mask:0xf
    v_max_f32_dpp v123, v102, v102 row_ror:8 row_mask:0xf bank_mask:0xf
    v_mov_b64 v[110:111], s[34:35]
s_nop 0
    v_permlane16_swap_b32 v122, v123
    v_max_f32 v102, v122, v123
    v_max_f32 v103, v122, v123
s_nop 1
    v_permlane32_swap_b32 v102, v103
    v_max_f32 v122, v102, v103
    v_mul_f32 v122, s32, v122
    v_pk_fma_f32 v[100:101], v[100:101], s[32:33], v[122:123] op_sel_hi:[1,1,0] neg_lo:[0,0,1] neg_hi:[0,0,1]
    v_pk_fma_f32 v[96:97], v[96:97], s[32:33], v[122:123] op_sel_hi:[1,1,0] neg_lo:[0,0,1] neg_hi:[0,0,1]
    v_pk_fma_f32 v[98:99], v[98:99], s[32:33], v[122:123] op_sel_hi:[1,1,0] neg_lo:[0,0,1] neg_hi:[0,0,1]
    v_exp_f32 v100, v100
    v_exp_f32 v101, v101
    v_exp_f32 v96, v96
    v_cvt_pk_bf16_f32 v108, v100, v101
    v_exp_f32 v97, v97
    v_exp_f32 v98, v98
    v_mov_b32_dpp v109, v108 row_ror:8 row_mask:0xf bank_mask:0xf
    v_cvt_pk_bf16_f32 v104, v96, v97
    v_exp_f32 v99, v99
    v_mfma_f32_16x16x16_bf16 v[60:63], v[110:111], v[108:109], 0
    v_cvt_pk_bf16_f32 v105, v98, v99
    v_mov_b32_dpp v106, v104 row_ror:8 row_mask:0xf bank_mask:0xf
    v_mfma_f32_16x16x16_bf16 v[100:103], v[74:75], v[108:109], 0
    v_mov_b32_dpp v107, v105 row_ror:8 row_mask:0xf bank_mask:0xf
    v_mfma_f32_16x16x16_bf16 v[96:99], v[72:73], v[108:109], 0
    ds_read_b128 v[80:83], v121 offset:22528
    ds_read_b128 v[84:87], v121 offset:23552
    v_mfma_f32_16x16x32_bf16 v[60:63], v[76:79], v[104:107], v[60:63]
    v_mfma_f32_16x16x32_bf16 v[100:103], v[92:95], v[104:107], v[100:103]
    v_mfma_f32_16x16x32_bf16 v[96:99], v[88:91], v[104:107], v[96:99]
    v_mov_b64 v[104:105], 0
    v_rcp_f32 v122, v60
    v_mov_b64 v[106:107], 0
    v_mov_b64 v[108:109], 0
    v_pk_mul_f32 v[100:101], v[100:101], v[122:123] op_sel_hi:[1,0]
    v_pk_mul_f32 v[102:103], v[102:103], v[122:123] op_sel_hi:[1,0]
    v_cvt_pk_bf16_f32 v74, v100, v101
    v_cvt_pk_bf16_f32 v75, v102, v103
    v_pk_mul_f32 v[96:97], v[96:97], v[122:123] op_sel_hi:[1,0]
    v_pk_mul_f32 v[98:99], v[98:99], v[122:123] op_sel_hi:[1,0]
    v_cvt_pk_bf16_f32 v72, v96, v97
    v_cvt_pk_bf16_f32 v73, v98, v99
    ds_write_b128 v116, v[72:75] offset:0
    v_mov_b32_dpp v74, v74 row_ror:8 row_mask:0xf bank_mask:0xc
    v_mov_b32_dpp v75, v75 row_ror:8 row_mask:0xf bank_mask:0xc
    v_mov_b32_dpp v72, v72 row_ror:8 row_mask:0xf bank_mask:0xc
    v_mov_b32_dpp v73, v73 row_ror:8 row_mask:0xf bank_mask:0xc
    v_mov_b64 v[110:111], 0
    v_mov_b64 v[96:97], 0
    v_smfmac_f32_16x16x64_bf16 v[104:107], v[72:75], v[32:39], v120
    ds_read_b128 v[88:91], v121 offset:30720
    ds_read_b128 v[92:95], v121 offset:31744
    v_mov_b64 v[98:99], 0
    v_smfmac_f32_16x16x64_bf16 v[108:111], v[72:75], v[40:47], v120
    v_mov_b64 v[100:101], 0
    v_mov_b64 v[102:103], 0
    s_waitcnt lgkmcnt(2)
    s_barrier
    ds_read_b128 v[8:11], v115 offset:1024
    ds_read_b128 v[12:15], v115 offset:2048
    ds_read_b128 v[76:79], v115 offset:3072
    v_smfmac_f32_16x16x64_bf16 v[96:99], v[72:75], v[192:199], v120
    v_smfmac_f32_16x16x64_bf16 v[100:103], v[72:75], v[224:231], v120
    s_waitcnt lgkmcnt(2)
    v_smfmac_f32_16x16x64_bf16 v[96:99], v[8:11], v[200:207], v120
    s_waitcnt lgkmcnt(1)
    v_smfmac_f32_16x16x64_bf16 v[96:99], v[12:15], v[208:215], v120
    s_waitcnt lgkmcnt(0)
    v_smfmac_f32_16x16x64_bf16 v[96:99], v[76:79], v[216:223], v120
    v_smfmac_f32_16x16x64_bf16 v[100:103], v[8:11], v[232:239], v120
    v_smfmac_f32_16x16x64_bf16 v[100:103], v[12:15], v[240:247], v120
    v_cvt_pk_bf16_f32 v96, v96, v97
    v_smfmac_f32_16x16x64_bf16 v[100:103], v[76:79], v[248:255], v120
    v_cvt_pk_bf16_f32 v97, v98, v99
    v_smfmac_f32_16x16x64_bf16 v[104:107], v[8:11], v[48:55], v120
    v_and_or_b32 v96, v96, -2, s29
    v_smfmac_f32_16x16x64_bf16 v[104:107], v[12:15], v[64:71], v120
    buffer_store_dwordx2 v[96:97], v117, s[4:7], s18 offen sc1
    v_cvt_pk_bf16_f32 v100, v100, v101
    v_smfmac_f32_16x16x64_bf16 v[104:107], v[76:79], v[80:87], v120
    v_cvt_pk_bf16_f32 v101, v102, v103
    v_smfmac_f32_16x16x64_bf16 v[108:111], v[8:11], v[16:23], v120
    v_and_or_b32 v100, v100, -2, s29
    v_smfmac_f32_16x16x64_bf16 v[108:111], v[12:15], v[24:31], v120
    buffer_store_dwordx2 v[100:101], v117, s[4:7], s19 offen sc1
    v_cvt_pk_bf16_f32 v104, v104, v105
    v_smfmac_f32_16x16x64_bf16 v[108:111], v[76:79], v[88:95], v120
    ds_read_b128 v[24:27], v112 offset:9216
    v_cvt_pk_bf16_f32 v105, v106, v107
    v_and_or_b32 v104, v104, -2, s29
    buffer_store_dwordx2 v[104:105], v117, s[4:7], s20 offen sc1
    v_permlane32_swap_b32 v0, v4
    v_permlane32_swap_b32 v1, v5
s_nop 1
    v_cvt_pk_bf16_f32 v108, v108, v109
    v_cvt_pk_bf16_f32 v109, v110, v111
    v_and_or_b32 v108, v108, -2, s29
    buffer_store_dwordx2 v[108:109], v117, s[4:7], s21 offen sc1
    s_xor_b32 s19, s19, 0x40000
    s_xor_b32 s20, s20, 0x40000
    s_xor_b32 s21, s21, 0x40000
    s_add_u32 s23, s23, 0x2000
    s_bitset0_b32 s23, 15
    s_add_u32 s28, s28, 0x2000
    s_bitset0_b32 s28, 15
    s_add_u32 s27, s27, 131072
    s_add_u32 s16, s16, 1
    v_permlane32_swap_b32 v2, v6
    v_permlane32_swap_b32 v3, v7
    v_permlane32_swap_b32 v56, v58
    v_permlane32_swap_b32 v57, v59
    v_pk_add_f32 v[0:1], v[0:1], v[4:5]
    v_pk_add_f32 v[2:3], v[2:3], v[6:7]
    v_lshlrev_b32 v64, 16, v56
    v_and_b32 v65, 0xffff0000, v56
    v_lshlrev_b32 v66, 16, v58
    v_and_b32 v67, 0xffff0000, v58
    v_lshlrev_b32 v68, 16, v57
    v_and_b32 v69, 0xffff0000, v57
    v_lshlrev_b32 v70, 16, v59
    v_and_b32 v71, 0xffff0000, v59
    v_pk_add_f32 v[64:65], v[64:65], v[66:67]
    v_pk_add_f32 v[68:69], v[68:69], v[70:71]
    v_cvt_pk_bf16_f32 v126, v0, v1
    v_cvt_pk_bf16_f32 v127, v2, v3
    v_cvt_pk_bf16_f32 v124, v64, v65
    v_cvt_pk_bf16_f32 v125, v68, v69
    v_mov_b64 v[0:1], 0
    v_mov_b64 v[2:3], 0
    v_mov_b64 v[4:5], 0
    v_mov_b64 v[6:7], 0
    v_mov_b64 v[96:97], 0
    v_mov_b64 v[98:99], 0
    v_mov_b64 v[100:101], 0
    v_mov_b64 v[102:103], 0
    v_mov_b64 v[104:105], 0
    v_mov_b64 v[106:107], 0
    v_mov_b64 v[108:109], 0
    v_mov_b64 v[110:111], 0
    ds_read_b128 v[32:35], v121 offset:0
    ds_read_b128 v[36:39], v121 offset:1024
    ds_read_b128 v[40:43], v121 offset:2048
    ds_read_b128 v[44:47], v121 offset:3072
    buffer_load_dwordx4 v[8:11], v118, s[4:7], s18 offen offset:0 sc1
    buffer_load_dwordx4 v[12:15], v118, s[4:7], s18 offen offset:1024 sc1
    s_waitcnt lgkmcnt(4)
    s_barrier
RD_74:
    s_waitcnt vmcnt(1)
    v_mfma_f32_16x16x32_bf16 v[28:31], v[24:27], v[8:11], 0
    v_bitop3_b32 v122, v8, v10, s29 bitop3:0x7e
    s_waitcnt vmcnt(0)
    v_mfma_f32_16x16x32_bf16 v[28:31], v[24:27], v[12:15], v[28:31]
    v_bitop3_b32 v123, v12, v14, s29 bitop3:0x7e
    v_bitop3_b32 v122, v122, v123, 1 bitop3:0xa8
    v_cmp_ne_u32 vcc, 0, v122
    s_cbranch_vccnz RO_75
s_nop 3
    v_add_f32_dpp v28, v28, v28 row_ror:8 row_mask:0xf bank_mask:0xf
    v_add_f32_dpp v29, v29, v29 row_ror:8 row_mask:0xf bank_mask:0xf
s_nop 0
    v_add_f32_dpp v28, v28, v28 row_ror:4 row_mask:0xf bank_mask:0xf
    v_add_f32_dpp v29, v29, v29 row_ror:4 row_mask:0xf bank_mask:0xf
    v_cvt_pk_bf16_f32 v122, v28, v29
    buffer_store_dword v122, v119, s[4:7], s24 offen sc1
    s_xor_b32 s18, s18, 0x40000
    s_bfe_u32 s29, s16, 0x10001
    s_add_u32 s24, s24, 0x2000
    s_bitset0_b32 s24, 15
    s_branch RL_63
RO_75:
    s_sub_u32 s30, s30, 1
    s_cbranch_scc1 L_abort
    s_mov_b64 exec, vcc
    buffer_load_dwordx4 v[8:11], v118, s[4:7], s18 offen offset:0 sc1
    buffer_load_dwordx4 v[12:15], v118, s[4:7], s18 offen offset:1024 sc1
    s_mov_b64 exec, -1
    s_branch RD_74
RF_66:
    s_sub_u32 s30, s30, 1
    s_cbranch_scc1 L_abort
    s_mov_b64 exec, vcc
    buffer_load_dwordx4 v[64:67], v112, s[4:7], s23 offen sc1
    buffer_load_dwordx4 v[68:71], v112, s[4:7], s23 offen offset:1024 sc1
    s_mov_b64 exec, -1
    v_mov_b64 v[96:97], 0
    v_mov_b64 v[98:99], 0
    v_mov_b64 v[100:101], 0
    v_mov_b64 v[102:103], 0
    s_branch RC_64
KC_69:
    v_lshrrev_b32 v122, 2, v112
    buffer_load_dword v123, v122, s[4:7], s40 offen sc1
    s_sub_u32 s30, s30, 1
    s_cbranch_scc1 L_abort
    s_waitcnt vmcnt(0)
    v_cmp_ne_u32 vcc, 0, v123
    s_nop 4
    s_ff0_i32_b64 s17, vcc
    s_cmp_gt_u32 s17, s41
    s_cbranch_scc0 KC_69
    s_branch KC_70
KC_71:
    v_lshrrev_b32 v122, 2, v112
    buffer_load_dword v123, v122, s[4:7], s40 offen sc1
    s_sub_u32 s30, s30, 1
    s_cbranch_scc1 L_abort
    s_waitcnt vmcnt(0)
    v_cmp_ne_u32 vcc, 0, v123
    s_nop 4
    s_ff0_i32_b64 s17, vcc
    s_cmp_gt_u32 s17, s41
    s_cbranch_scc0 KC_71
    s_branch KC_72
RZ_73:
    s_waitcnt lgkmcnt(0)
    s_nop 7
    s_nop 7
    s_add_u32 s27, s27, 131072
    v_permlane32_swap_b32 v0, v4
    v_permlane32_swap_b32 v1, v5
    v_permlane32_swap_b32 v2, v6
    v_permlane32_swap_b32 v3, v7
    v_permlane32_swap_b32 v56, v58
    v_permlane32_swap_b32 v57, v59
    v_pk_add_f32 v[0:1], v[0:1], v[4:5]
    v_pk_add_f32 v[2:3], v[2:3], v[6:7]
    v_lshlrev_b32 v64, 16, v56
    v_and_b32 v65, 0xffff0000, v56
    v_lshlrev_b32 v66, 16, v58
    v_and_b32 v67, 0xffff0000, v58
    v_lshlrev_b32 v68, 16, v57
    v_and_b32 v69, 0xffff0000, v57
    v_lshlrev_b32 v70, 16, v59
    v_and_b32 v71, 0xffff0000, v59
    v_pk_add_f32 v[64:65], v[64:65], v[66:67]
    v_pk_add_f32 v[68:69], v[68:69], v[70:71]
    v_cvt_pk_bf16_f32 v126, v0, v1
    v_cvt_pk_bf16_f32 v127, v2, v3
    v_cvt_pk_bf16_f32 v124, v64, v65
    v_cvt_pk_bf16_f32 v125, v68, v69
    buffer_store_dwordx4 v[124:127], v113, s[4:7], s27 offen sc1
    s_branch L_rdone
RW_60:
    s_cmp_gt_u32 s17, s41
    s_cbranch_scc0 KC_82
KC_83:
    s_add_u32 s41, s41, 1
    s_mov_b32 m0, 14336
s_nop 0
    buffer_load_dwordx4 v112, s[4:7], s25 offen sc1 lds
    buffer_load_dwordx4 v112, s[4:7], s25 offen offset:1024 sc1 lds
    s_mov_b32 m0, 92160
s_nop 0
    buffer_load_dwordx4 v114, s[4:7], s26 offen sc1 lds
    s_mov_b32 m0, 93056
s_nop 0
    buffer_load_dwordx4 v114, s[4:7], s26 offen offset:128 sc1 lds
    ds_read_b128 v[32:35], v121 offset:0
    ds_read_b128 v[36:39], v121 offset:1024
    ds_read_b128 v[40:43], v121 offset:2048
    ds_read_b128 v[44:47], v121 offset:3072
    ds_read_b128 v[48:51], v121 offset:4096
    ds_read_b128 v[52:55], v121 offset:5120
    ds_read_b128 v[56:59], v121 offset:6144
    ds_read_b128 v[60:63], v121 offset:7168
    v_mov_b64 v[96:97], 0
    v_mov_b64 v[98:99], 0
    v_mov_b64 v[100:101], 0
    v_mov_b64 v[102:103], 0
    v_mov_b64 v[104:105], 0
    v_mov_b64 v[106:107], 0
    v_mov_b64 v[108:109], 0
    v_mov_b64 v[110:111], 0
    v_mov_b64 v[0:1], 0
    v_mov_b64 v[2:3], 0
    v_mov_b64 v[4:5], 0
    v_mov_b64 v[6:7], 0
    s_waitcnt vmcnt(0)
RL_76:
    ds_read_b128 v[48:51], v121 offset:4096
    ds_read_b128 v[52:55], v121 offset:5120
    ds_read_b128 v[56:59], v121 offset:6144
    ds_read_b128 v[60:63], v121 offset:7168
    ds_read_b128 v[80:83], v112 offset:14336
    ds_read_b128 v[84:87], v112 offset:15360
    ds_read_b128 v[88:91], v121 offset:32768
    ds_read_b128 v[92:95], v121 offset:33792
    s_add_u32 s25, s25, 524288
    s_add_u32 s26, s26, 524288
    buffer_load_dwordx4 v[64:67], v112, s[4:7], s23 offen sc1
    buffer_load_dwordx4 v[68:71], v112, s[4:7], s23 offen offset:1024 sc1
    s_cmp_gt_u32 s17, s41
    s_cbranch_scc0 KC_84
KC_85:
    s_add_u32 s41, s41, 1
RC_77:
    s_waitcnt vmcnt(1) lgkmcnt(0)
    v_max3_u32 v122, v64, v65, v66
    v_max_u32 v122, v122, v67
    v_smfmac_f32_16x16x64_bf16 v[96:99], v[64:67], v[32:39], v120
    ds_write_b128 v112, v[64:67] offset:2048
    s_waitcnt vmcnt(0)
    v_max3_u32 v122, v122, v68, v69
    v_smfmac_f32_16x16x64_bf16 v[100:103], v[64:67], v[40:47], v120
    v_max3_u32 v122, v122, v70, v71
    v_cmp_eq_u32 vcc, -1, v122
    s_cbranch_vccnz RF_79
    v_smfmac_f32_16x16x64_bf16 v[96:99], v[68:71], v[48:55], v120
    ds_write_b128 v112, v[68:71] offset:3072
    v_smfmac_f32_16x16x64_bf16 v[100:103], v[68:71], v[56:63], v120
    v_smfmac_f32_16x16x64_bf16 v[104:107], v[64:67], a[64:71], v120
    ds_read_b128 v[32:35], v121 offset:8192
    ds_read_b128 v[36:39], v121 offset:9216
    v_smfmac_f32_16x16x64_bf16 v[108:111], v[64:67], a[72:79], v120
    ds_read_b128 v[40:43], v121 offset:10240
    ds_read_b128 v[44:47], v121 offset:11264
    s_waitcnt lgkmcnt(4)
    s_barrier
    ds_read_b128 v[16:19], v112 offset:6144
    ds_read_b128 v[20:23], v112 offset:7168
    v_smfmac_f32_16x16x64_bf16 v[104:107], v[68:71], a[80:87], v120
    ds_read_b128 v[24:27], v112 offset:4096
    ds_read_b128 v[28:31], v112 offset:5120
    v_smfmac_f32_16x16x64_bf16 v[108:111], v[68:71], a[88:95], v120
    ds_read_b128 v[8:11], v112 offset:0
    ds_read_b128 v[12:15], v112 offset:1024
    v_smfmac_f32_16x16x64_bf16 v[0:3], v[64:67], a[192:199], v120
    ds_read_b128 v[48:51], v121 offset:12288
    ds_read_b128 v[52:55], v121 offset:13312
    v_smfmac_f32_16x16x64_bf16 v[4:7], v[64:67], a[200:207], v120
    ds_read_b128 v[56:59], v121 offset:14336
    ds_read_b128 v[60:63], v121 offset:15360
    v_smfmac_f32_16x16x64_bf16 v[0:3], v[68:71], a[208:215], v120
    v_smfmac_f32_16x16x64_bf16 v[4:7], v[68:71], a[216:223], v120
RB_81:
    s_waitcnt lgkmcnt(9)
    v_smfmac_f32_16x16x64_bf16 v[96:99], v[16:19], a[0:7], v120
    v_smfmac_f32_16x16x64_bf16 v[100:103], v[16:19], a[8:15], v120
    buffer_store_dwordx4 v[124:127], v113, s[4:7], s27 offen sc1
    s_waitcnt lgkmcnt(8)
    v_smfmac_f32_16x16x64_bf16 v[96:99], v[20:23], a[16:23], v120
    v_smfmac_f32_16x16x64_bf16 v[100:103], v[20:23], a[24:31], v120
    s_waitcnt lgkmcnt(7)
    v_smfmac_f32_16x16x64_bf16 v[96:99], v[24:27], a[32:39], v120
    v_smfmac_f32_16x16x64_bf16 v[100:103], v[24:27], a[40:47], v120
    s_mov_b32 m0, 14336
s_nop 0
    buffer_load_dwordx4 v112, s[4:7], s25 offen sc1 lds
    v_mov_b64 v[124:125], -1
    s_waitcnt lgkmcnt(6)
    v_smfmac_f32_16x16x64_bf16 v[96:99], v[28:31], a[48:55], v120
    v_smfmac_f32_16x16x64_bf16 v[100:103], v[28:31], a[56:63], v120
    s_waitcnt vmcnt(2)
    s_waitcnt lgkmcnt(5)
    v_smfmac_f32_16x16x64_bf16 v[96:99], v[8:11], v[32:39], v120
    ds_read_b128 v[76:79], v112 offset:10240
    s_waitcnt lgkmcnt(3)
    v_smfmac_f32_16x16x64_bf16 v[96:99], v[12:15], v[48:55], v120
    buffer_load_dwordx4 v112, s[4:7], s25 offen offset:1024 sc1 lds
    v_smfmac_f32_16x16x64_bf16 v[100:103], v[8:11], v[40:47], v120
    s_waitcnt lgkmcnt(1)
    v_smfmac_f32_16x16x64_bf16 v[100:103], v[12:15], v[56:63], v120
    v_cvt_pk_bf16_f32 v122, v96, v97
    v_smfmac_f32_16x16x64_bf16 v[104:107], v[8:11], a[96:103], v120
    ds_read_b128 v[32:35], v121 offset:18432
    v_cvt_pk_bf16_f32 v123, v98, v99
    v_smfmac_f32_16x16x64_bf16 v[104:107], v[12:15], a[112:119], v120
    s_mov_b32 m0, 92160
s_nop 0
    buffer_load_dwordx4 v114, s[4:7], s26 offen sc1 lds
    ds_read_b128 v[36:39], v121 offset:19456
    v_cvt_pk_bf16_f32 v60, v100, v101
    s_waitcnt lgkmcnt(2)
    v_mfma_f32_16x16x16_bf16 v[96:99], v[122:123], v[76:77], 0
    v_cvt_pk_bf16_f32 v61, v102, v103
    v_smfmac_f32_16x16x64_bf16 v[104:107], v[16:19], a[128:135], v120
    ds_read_b128 v[40:43], v121 offset:26624
    v_mfma_f32_16x16x16_bf16 v[100:103], v[60:61], v[76:77], 0
    v_smfmac_f32_16x16x64_bf16 v[104:107], v[20:23], a[144:151], v120
    ds_read_b128 v[44:47], v121 offset:27648
    v_cvt_pk_bf16_f32 v72, v96, v97
    v_smfmac_f32_16x16x64_bf16 v[104:107], v[24:27], a[160:167], v120
    ds_read_b128 v[48:51], v121 offset:16384
    v_cvt_pk_bf16_f32 v73, v98, v99
    v_smfmac_f32_16x16x64_bf16 v[104:107], v[28:31], a[176:183], v120
    s_mov_b32 m0, 93056
s_nop 0
    buffer_load_dwordx4 v114, s[4:7], s26 offen offset:128 sc1 lds
    ds_read_b128 v[52:55], v121 offset:17408
    v_cvt_pk_bf16_f32 v74, v100, v101
    v_smfmac_f32_16x16x64_bf16 v[108:111], v[8:11], a[104:111], v120
    ds_read_b128 v[64:67], v121 offset:22528
    v_cvt_pk_bf16_f32 v75, v102, v103
    v_smfmac_f32_16x16x64_bf16 v[108:111], v[12:15], a[120:127], v120
    ds_read_b128 v[68:71], v121 offset:23552
    v_cvt_pk_bf16_f32 v56, v104, v105
    v_smfmac_f32_16x16x64_bf16 v[108:111], v[16:19], a[136:143], v120
    v_cvt_pk_bf16_f32 v57, v106, v107
    v_smfmac_f32_16x16x64_bf16 v[108:111], v[20:23], a[152:159], v120
    buffer_store_dword v124, v119, s[4:7], s28 offen sc1
    v_smfmac_f32_16x16x64_bf16 v[108:111], v[24:27], a[168:175], v120
    v_smfmac_f32_16x16x64_bf16 v[108:111], v[28:31], a[184:191], v120
    v_mfma_f32_16x16x16_bf16 v[104:107], v[56:57], v[78:79], 0
    v_mfma_f32_16x16x32_bf16 v[96:99], v[80:83], v[72:75], 0
    v_cvt_pk_bf16_f32 v58, v108, v109
    v_cvt_pk_bf16_f32 v59, v110, v111
s_nop 1
    v_cvt_pk_bf16_f32 v60, v104, v105
    v_cvt_pk_bf16_f32 v61, v106, v107
    v_mfma_f32_16x16x16_bf16 v[108:111], v[58:59], v[78:79], 0
    v_mov_b64 v[76:77], s[38:39]
    v_mov_b64 v[78:79], s[38:39]
    v_mfma_f32_16x16x32_bf16 v[100:103], v[84:87], v[72:75], 0
    v_smfmac_f32_16x16x64_bf16 v[0:3], v[8:11], a[224:231], v120
    v_cvt_pk_bf16_f32 v62, v108, v109
    v_cvt_pk_bf16_f32 v63, v110, v111
s_nop 1
    v_mov_b32_dpp v96, v100 quad_perm:[0,1,2,3] row_mask:0xf bank_mask:0xc
    v_mov_b32_dpp v97, v101 quad_perm:[0,1,2,3] row_mask:0xf bank_mask:0xc
    v_mfma_f32_16x16x32_bf16 v[104:107], v[60:63], v[72:75], 0
    v_mov_b32_dpp v98, v102 quad_perm:[0,1,2,3] row_mask:0xf bank_mask:0xc
    v_mov_b32_dpp v99, v103 quad_perm:[0,1,2,3] row_mask:0xf bank_mask:0xc
    v_smfmac_f32_16x16x64_bf16 v[0:3], v[12:15], a[240:247], v120
    ds_write_b128 v112, v[96:99] offset:21504
    v_smfmac_f32_16x16x64_bf16 v[0:3], v[16:19], v[128:135], v120
    ds_write_b64 v113, v[104:105] offset:8200
    v_smfmac_f32_16x16x64_bf16 v[0:3], v[20:23], v[144:151], v120
    v_smfmac_f32_16x16x64_bf16 v[0:3], v[24:27], v[160:167], v120
    v_smfmac_f32_16x16x64_bf16 v[0:3], v[28:31], v[176:183], v120
    v_smfmac_f32_16x16x64_bf16 v[4:7], v[8:11], a[232:239], v120
    s_waitcnt lgkmcnt(0)
    s_barrier
    ds_read_b128 v[104:107], v112 offset:8192
    ds_read_b128 v[108:111], v112 offset:11264
    v_smfmac_f32_16x16x64_bf16 v[4:7], v[12:15], a[248:255], v120
    ds_read_b128 v[80:83], v112 offset:20480
    ds_read_b128 v[84:87], v112 offset:23552
    v_smfmac_f32_16x16x64_bf16 v[4:7], v[16:19], v[136:143], v120
    ds_read_b128 v[100:103], v112 offset:22528
    v_cvt_pk_bf16_f32 v72, v0, v1
    v_smfmac_f32_16x16x64_bf16 v[4:7], v[20:23], v[152:159], v120
    v_cvt_pk_bf16_f32 v73, v2, v3
    v_smfmac_f32_16x16x64_bf16 v[4:7], v[24:27], v[168:175], v120
    s_cmp_eq_u32 s16, 63
    v_smfmac_f32_16x16x64_bf16 v[4:7], v[28:31], v[184:191], v120
    s_cbranch_scc1 RZ_86
    ds_read_b128 v[16:19], v121 offset:24576
    ds_read_b128 v[20:23], v121 offset:25600
    ds_read_b128 v[24:27], v121 offset:30720
    ds_read_b128 v[28:31], v121 offset:31744
    s_waitcnt lgkmcnt(7)
    v_pk_add_f32 v[104:105], v[104:105], v[106:107]
    v_pk_add_f32 v[108:109], v[108:109], v[110:111]
    s_waitcnt lgkmcnt(6)
    v_pk_add_f32 v[96:97], v[96:97], v[80:81]
    v_pk_add_f32 v[98:99], v[98:99], v[82:83]
    s_waitcnt lgkmcnt(4)
    v_pk_add_f32 v[84:85], v[84:85], v[100:101]
    v_pk_add_f32 v[86:87], v[86:87], v[102:103]
    v_pk_add_f32 v[100:101], v[104:105], v[108:109]
    v_pk_add_f32 v[96:97], v[96:97], v[84:85]
    v_pk_add_f32 v[98:99], v[98:99], v[86:87]
    v_max3_f32 v122, v100, v101, v96
    v_max3_f32 v123, v97, v98, v99
    v_max_f32 v102, v122, v123
    v_cvt_pk_bf16_f32 v74, v4, v5
    v_cvt_pk_bf16_f32 v75, v6, v7
    v_max_f32_dpp v122, v102, v102 row_ror:8 row_mask:0xf bank_mask:0xf
    v_max_f32_dpp v123, v102, v102 row_ror:8 row_mask:0xf bank_mask:0xf
    v_mov_b64 v[110:111], s[34:35]
s_nop 0
    v_permlane16_swap_b32 v122, v123
    v_max_f32 v102, v122, v123
    v_max_f32 v103, v122, v123
s_nop 1
    v_permlane32_swap_b32 v102, v103
    v_max_f32 v122, v102, v103
    v_mul_f32 v122, s32, v122
    v_pk_fma_f32 v[100:101], v[100:101], s[32:33], v[122:123] op_sel_hi:[1,1,0] neg_lo:[0,0,1] neg_hi:[0,0,1]
    v_pk_fma_f32 v[96:97], v[96:97], s[32:33], v[122:123] op_sel_hi:[1,1,0] neg_lo:[0,0,1] neg_hi:[0,0,1]
    v_pk_fma_f32 v[98:99], v[98:99], s[32:33], v[122:123] op_sel_hi:[1,1,0] neg_lo:[0,0,1] neg_hi:[0,0,1]
    v_exp_f32 v100, v100
    v_exp_f32 v101, v101
    v_exp_f32 v96, v96
    v_cvt_pk_bf16_f32 v108, v100, v101
    v_exp_f32 v97, v97
    v_exp_f32 v98, v98
    v_mov_b32_dpp v109, v108 row_ror:8 row_mask:0xf bank_mask:0xf
    v_cvt_pk_bf16_f32 v104, v96, v97
    v_exp_f32 v99, v99
    v_mfma_f32_16x16x16_bf16 v[60:63], v[110:111], v[108:109], 0
    v_cvt_pk_bf16_f32 v105, v98, v99
    v_mov_b32_dpp v106, v104 row_ror:8 row_mask:0xf bank_mask:0xf
    v_mfma_f32_16x16x16_bf16 v[100:103], v[74:75], v[108:109], 0
    v_mov_b32_dpp v107, v105 row_ror:8 row_mask:0xf bank_mask:0xf
    v_mfma_f32_16x16x16_bf16 v[96:99], v[72:73], v[108:109], 0
    ds_read_b128 v[80:83], v121 offset:20480
    ds_read_b128 v[84:87], v121 offset:21504
    v_mfma_f32_16x16x32_bf16 v[60:63], v[76:79], v[104:107], v[60:63]
    v_mfma_f32_16x16x32_bf16 v[100:103], v[92:95], v[104:107], v[100:103]
    v_mfma_f32_16x16x32_bf16 v[96:99], v[88:91], v[104:107], v[96:99]
    v_mov_b64 v[104:105], 0
    v_rcp_f32 v122, v60
    v_mov_b64 v[106:107], 0
    v_mov_b64 v[108:109], 0
    v_pk_mul_f32 v[100:101], v[100:101], v[122:123] op_sel_hi:[1,0]
    v_pk_mul_f32 v[102:103], v[102:103], v[122:123] op_sel_hi:[1,0]
    v_cvt_pk_bf16_f32 v74, v100, v101
    v_cvt_pk_bf16_f32 v75, v102, v103
    v_pk_mul_f32 v[96:97], v[96:97], v[122:123] op_sel_hi:[1,0]
    v_pk_mul_f32 v[98:99], v[98:99], v[122:123] op_sel_hi:[1,0]
    v_cvt_pk_bf16_f32 v72, v96, v97
    v_cvt_pk_bf16_f32 v73, v98, v99
    ds_write_b128 v116, v[72:75] offset:1024
    v_mov_b32_dpp v74, v74 row_ror:8 row_mask:0xf bank_mask:0xc
    v_mov_b32_dpp v75, v75 row_ror:8 row_mask:0xf bank_mask:0xc
    v_mov_b32_dpp v72, v72 row_ror:8 row_mask:0xf bank_mask:0xc
    v_mov_b32_dpp v73, v73 row_ror:8 row_mask:0xf bank_mask:0xc
    v_mov_b64 v[110:111], 0
    v_mov_b64 v[96:97], 0
    v_smfmac_f32_16x16x64_bf16 v[104:107], v[72:75], v[32:39], v120
    ds_read_b128 v[88:91], v121 offset:28672
    ds_read_b128 v[92:95], v121 offset:29696
    v_mov_b64 v[98:99], 0
    v_smfmac_f32_16x16x64_bf16 v[108:111], v[72:75], v[40:47], v120
    v_mov_b64 v[100:101], 0
    v_mov_b64 v[102:103], 0
    s_waitcnt lgkmcnt(2)
    s_barrier
    ds_read_b128 v[8:11], v115 offset:0
    ds_read_b128 v[12:15], v115 offset:3072
    ds_read_b128 v[76:79], v115 offset:2048
    v_smfmac_f32_16x16x64_bf16 v[96:99], v[72:75], v[200:207], v120
    v_smfmac_f32_16x16x64_bf16 v[100:103], v[72:75], v[232:239], v120
    s_waitcnt lgkmcnt(2)
    v_smfmac_f32_16x16x64_bf16 v[96:99], v[8:11], v[192:199], v120
    s_waitcnt lgkmcnt(1)
    v_smfmac_f32_16x16x64_bf16 v[96:99], v[12:15], v[216:223], v120
    s_waitcnt lgkmcnt(0)
    v_smfmac_f32_16x16x64_bf16 v[96:99], v[76:79], v[208:215], v120
    v_smfmac_f32_16x16x64_bf16 v[100:103], v[8:11], v[224:231], v120
    v_smfmac_f32_16x16x64_bf16 v[100:103], v[12:15], v[248:255], v120
    v_cvt_pk_bf16_f32 v96, v96, v97
    v_smfmac_f32_16x16x64_bf16 v[100:103], v[76:79], v[240:247], v120
    v_cvt_pk_bf16_f32 v97, v98, v99
    v_smfmac_f32_16x16x64_bf16 v[104:107], v[8:11], v[48:55], v120
    v_and_or_b32 v96, v96, -2, s29
    v_smfmac_f32_16x16x64_bf16 v[104:107], v[12:15], v[64:71], v120
    buffer_store_dwordx2 v[96:97], v117, s[4:7], s18 offen sc1
    v_cvt_pk_bf16_f32 v100, v100, v101
    v_smfmac_f32_16x16x64_bf16 v[104:107], v[76:79], v[80:87], v120
    v_cvt_pk_bf16_f32 v101, v102, v103
    v_smfmac_f32_16x16x64_bf16 v[108:111], v[8:11], v[16:23], v120
    v_and_or_b32 v100, v100, -2, s29
    v_smfmac_f32_16x16x64_bf16 v[108:111], v[12:15], v[24:31], v120
    buffer_store_dwordx2 v[100:101], v117, s[4:7], s19 offen sc1
    v_cvt_pk_bf16_f32 v104, v104, v105
    v_smfmac_f32_16x16x64_bf16 v[108:111], v[76:79], v[88:95], v120
    ds_read_b128 v[24:27], v112 offset:9216
    v_cvt_pk_bf16_f32 v105, v106, v107
    v_and_or_b32 v104, v104, -2, s29
    buffer_store_dwordx2 v[104:105], v117, s[4:7], s20 offen sc1
    v_permlane32_swap_b32 v0, v4
    v_permlane32_swap_b32 v1, v5
s_nop 1
    v_cvt_pk_bf16_f32 v108, v108, v109
    v_cvt_pk_bf16_f32 v109, v110, v111
    v_and_or_b32 v108, v108, -2, s29
    buffer_store_dwordx2 v[108:109], v117, s[4:7], s21 offen sc1
    s_xor_b32 s19, s19, 0x40000
    s_xor_b32 s20, s20, 0x40000
    s_xor_b32 s21, s21, 0x40000
    s_add_u32 s23, s23, 0x2000
    s_bitset0_b32 s23, 15
    s_add_u32 s28, s28, 0x2000
    s_bitset0_b32 s28, 15
    s_add_u32 s27, s27, 131072
    s_add_u32 s16, s16, 1
    v_permlane32_swap_b32 v2, v6
    v_permlane32_swap_b32 v3, v7
    v_permlane32_swap_b32 v56, v58
    v_permlane32_swap_b32 v57, v59
    v_pk_add_f32 v[0:1], v[0:1], v[4:5]
    v_pk_add_f32 v[2:3], v[2:3], v[6:7]
    v_lshlrev_b32 v64, 16, v56
    v_and_b32 v65, 0xffff0000, v56
    v_lshlrev_b32 v66, 16, v58
    v_and_b32 v67, 0xffff0000, v58
    v_lshlrev_b32 v68, 16, v57
    v_and_b32 v69, 0xffff0000, v57
    v_lshlrev_b32 v70, 16, v59
    v_and_b32 v71, 0xffff0000, v59
    v_pk_add_f32 v[64:65], v[64:65], v[66:67]
    v_pk_add_f32 v[68:69], v[68:69], v[70:71]
    v_cvt_pk_bf16_f32 v126, v0, v1
    v_cvt_pk_bf16_f32 v127, v2, v3
    v_cvt_pk_bf16_f32 v124, v64, v65
    v_cvt_pk_bf16_f32 v125, v68, v69
    v_mov_b64 v[0:1], 0
    v_mov_b64 v[2:3], 0
    v_mov_b64 v[4:5], 0
    v_mov_b64 v[6:7], 0
    v_mov_b64 v[96:97], 0
    v_mov_b64 v[98:99], 0
    v_mov_b64 v[100:101], 0
    v_mov_b64 v[102:103], 0
    v_mov_b64 v[104:105], 0
    v_mov_b64 v[106:107], 0
    v_mov_b64 v[108:109], 0
    v_mov_b64 v[110:111], 0
    ds_read_b128 v[32:35], v121 offset:0
    ds_read_b128 v[36:39], v121 offset:1024
    ds_read_b128 v[40:43], v121 offset:2048
    ds_read_b128 v[44:47], v121 offset:3072
    buffer_load_dwordx4 v[8:11], v118, s[4:7], s18 offen offset:0 sc1
    buffer_load_dwordx4 v[12:15], v118, s[4:7], s18 offen offset:1024 sc1
    s_waitcnt lgkmcnt(4)
    s_barrier
RD_87:
    s_waitcnt vmcnt(1)
    v_mfma_f32_16x16x32_bf16 v[28:31], v[24:27], v[8:11], 0
    v_bitop3_b32 v122, v8, v10, s29 bitop3:0x7e
    s_waitcnt vmcnt(0)
    v_mfma_f32_16x16x32_bf16 v[28:31], v[24:27], v[12:15], v[28:31]
    v_bitop3_b32 v123, v12, v14, s29 bitop3:0x7e
    v_bitop3_b32 v122, v122, v123, 1 bitop3:0xa8
    v_cmp_ne_u32 vcc, 0, v122
    s_cbranch_vccnz RO_88
s_nop 3
    v_add_f32_dpp v28, v28, v28 row_ror:8 row_mask:0xf bank_mask:0xf
    v_add_f32_dpp v29, v29, v29 row_ror:8 row_mask:0xf bank_mask:0xf
s_nop 0
    v_add_f32_dpp v28, v28, v28 row_ror:4 row_mask:0xf bank_mask:0xf
    v_add_f32_dpp v29, v29, v29 row_ror:4 row_mask:0xf bank_mask:0xf
    v_cvt_pk_bf16_f32 v122, v28, v29
    buffer_store_dword v122, v119, s[4:7], s24 offen sc1
    s_xor_b32 s18, s18, 0x40000
    s_bfe_u32 s29, s16, 0x10001
    s_add_u32 s24, s24, 0x2000
    s_bitset0_b32 s24, 15
    s_branch RL_76
RO_88:
    s_sub_u32 s30, s30, 1
    s_cbranch_scc1 L_abort
    s_mov_b64 exec, vcc
    buffer_load_dwordx4 v[8:11], v118, s[4:7], s18 offen offset:0 sc1
    buffer_load_dwordx4 v[12:15], v118, s[4:7], s18 offen offset:1024 sc1
    s_mov_b64 exec, -1
    s_branch RD_87
RF_79:
    s_sub_u32 s30, s30, 1
    s_cbranch_scc1 L_abort
    s_mov_b64 exec, vcc
    buffer_load_dwordx4 v[64:67], v112, s[4:7], s23 offen sc1
    buffer_load_dwordx4 v[68:71], v112, s[4:7], s23 offen offset:1024 sc1
    s_mov_b64 exec, -1
    v_mov_b64 v[96:97], 0
    v_mov_b64 v[98:99], 0
    v_mov_b64 v[100:101], 0
    v_mov_b64 v[102:103], 0
    s_branch RC_77
KC_82:
    v_lshrrev_b32 v122, 2, v112
    buffer_load_dword v123, v122, s[4:7], s40 offen sc1
    s_sub_u32 s30, s30, 1
    s_cbranch_scc1 L_abort
    s_waitcnt vmcnt(0)
    v_cmp_ne_u32 vcc, 0, v123
    s_nop 4
    s_ff0_i32_b64 s17, vcc
    s_cmp_gt_u32 s17, s41
    s_cbranch_scc0 KC_82
    s_branch KC_83
KC_84:
    v_lshrrev_b32 v122, 2, v112
    buffer_load_dword v123, v122, s[4:7], s40 offen sc1
    s_sub_u32 s30, s30, 1
    s_cbranch_scc1 L_abort
    s_waitcnt vmcnt(0)
    v_cmp_ne_u32 vcc, 0, v123
    s_nop 4
    s_ff0_i32_b64 s17, vcc
    s_cmp_gt_u32 s17, s41
    s_cbranch_scc0 KC_84
    s_branch KC_85
RZ_86:
    s_waitcnt lgkmcnt(0)
    s_nop 7
    s_nop 7
    s_add_u32 s27, s27, 131072
    v_permlane32_swap_b32 v0, v4
    v_permlane32_swap_b32 v1, v5
    v_permlane32_swap_b32 v2, v6
    v_permlane32_swap_b32 v3, v7
    v_permlane32_swap_b32 v56, v58
    v_permlane32_swap_b32 v57, v59
    v_pk_add_f32 v[0:1], v[0:1], v[4:5]
    v_pk_add_f32 v[2:3], v[2:3], v[6:7]
    v_lshlrev_b32 v64, 16, v56
    v_and_b32 v65, 0xffff0000, v56
    v_lshlrev_b32 v66, 16, v58
    v_and_b32 v67, 0xffff0000, v58
    v_lshlrev_b32 v68, 16, v57
    v_and_b32 v69, 0xffff0000, v57
    v_lshlrev_b32 v70, 16, v59
    v_and_b32 v71, 0xffff0000, v59
    v_pk_add_f32 v[64:65], v[64:65], v[66:67]
    v_pk_add_f32 v[68:69], v[68:69], v[70:71]
    v_cvt_pk_bf16_f32 v126, v0, v1
    v_cvt_pk_bf16_f32 v127, v2, v3
    v_cvt_pk_bf16_f32 v124, v64, v65
    v_cvt_pk_bf16_f32 v125, v68, v69
    buffer_store_dwordx4 v[124:127], v113, s[4:7], s27 offen sc1
    s_branch L_rdone
RW_61:
    s_cmp_gt_u32 s17, s41
    s_cbranch_scc0 KC_95
KC_96:
    s_add_u32 s41, s41, 1
    s_mov_b32 m0, 16384
s_nop 0
    buffer_load_dwordx4 v112, s[4:7], s25 offen sc1 lds
    buffer_load_dwordx4 v112, s[4:7], s25 offen offset:1024 sc1 lds
    s_mov_b32 m0, 126976
s_nop 0
    buffer_load_dwordx4 v114, s[4:7], s26 offen sc1 lds
    s_mov_b32 m0, 127872
s_nop 0
    buffer_load_dwordx4 v114, s[4:7], s26 offen offset:128 sc1 lds
    ds_read_b128 v[32:35], v121 offset:0
    ds_read_b128 v[36:39], v121 offset:1024
    ds_read_b128 v[40:43], v121 offset:2048
    ds_read_b128 v[44:47], v121 offset:3072
    ds_read_b128 v[48:51], v121 offset:4096
    ds_read_b128 v[52:55], v121 offset:5120
    ds_read_b128 v[56:59], v121 offset:6144
    ds_read_b128 v[60:63], v121 offset:7168
    v_mov_b64 v[96:97], 0
    v_mov_b64 v[98:99], 0
    v_mov_b64 v[100:101], 0
    v_mov_b64 v[102:103], 0
    v_mov_b64 v[104:105], 0
    v_mov_b64 v[106:107], 0
    v_mov_b64 v[108:109], 0
    v_mov_b64 v[110:111], 0
    v_mov_b64 v[0:1], 0
    v_mov_b64 v[2:3], 0
    v_mov_b64 v[4:5], 0
    v_mov_b64 v[6:7], 0
    s_waitcnt vmcnt(0)
RL_89:
    ds_read_b128 v[48:51], v121 offset:4096
    ds_read_b128 v[52:55], v121 offset:5120
    ds_read_b128 v[56:59], v121 offset:6144
    ds_read_b128 v[60:63], v121 offset:7168
    ds_read_b128 v[80:83], v112 offset:16384
    ds_read_b128 v[84:87], v112 offset:17408
    ds_read_b128 v[88:91], v121 offset:32768
    ds_read_b128 v[92:95], v121 offset:33792
    s_add_u32 s25, s25, 524288
    s_add_u32 s26, s26, 524288
    buffer_load_dwordx4 v[64:67], v112, s[4:7], s23 offen sc1
    buffer_load_dwordx4 v[68:71], v112, s[4:7], s23 offen offset:1024 sc1
    s_cmp_gt_u32 s17, s41
    s_cbranch_scc0 KC_97
KC_98:
    s_add_u32 s41, s41, 1
RC_90:
    s_waitcnt vmcnt(1) lgkmcnt(0)
    v_max3_u32 v122, v64, v65, v66
    v_max_u32 v122, v122, v67
    v_smfmac_f32_16x16x64_bf16 v[96:99], v[64:67], v[32:39], v120
    ds_write_b128 v112, v[64:67] offset:4096
    s_waitcnt vmcnt(0)
    v_max3_u32 v122, v122, v68, v69
    v_smfmac_f32_16x16x64_bf16 v[100:103], v[64:67], v[40:47], v120
    v_max3_u32 v122, v122, v70, v71
    v_cmp_eq_u32 vcc, -1, v122
    s_cbranch_vccnz RF_92
    v_smfmac_f32_16x16x64_bf16 v[96:99], v[68:71], v[48:55], v120
    ds_write_b128 v112, v[68:71] offset:5120
    v_smfmac_f32_16x16x64_bf16 v[100:103], v[68:71], v[56:63], v120
    v_smfmac_f32_16x16x64_bf16 v[104:107], v[64:67], a[64:71], v120
    ds_read_b128 v[32:35], v121 offset:8192
    ds_read_b128 v[36:39], v121 offset:9216
    v_smfmac_f32_16x16x64_bf16 v[108:111], v[64:67], a[72:79], v120
    ds_read_b128 v[40:43], v121 offset:10240
    ds_read_b128 v[44:47], v121 offset:11264
    s_waitcnt lgkmcnt(4)
    s_barrier
    ds_read_b128 v[16:19], v112 offset:0
    ds_read_b128 v[20:23], v112 offset:1024
    v_smfmac_f32_16x16x64_bf16 v[104:107], v[68:71], a[80:87], v120
    ds_read_b128 v[24:27], v112 offset:2048
    ds_read_b128 v[28:31], v112 offset:3072
    v_smfmac_f32_16x16x64_bf16 v[108:111], v[68:71], a[88:95], v120
    ds_read_b128 v[8:11], v112 offset:6144
    ds_read_b128 v[12:15], v112 offset:7168
    v_smfmac_f32_16x16x64_bf16 v[0:3], v[64:67], a[192:199], v120
    ds_read_b128 v[48:51], v121 offset:12288
    ds_read_b128 v[52:55], v121 offset:13312
    v_smfmac_f32_16x16x64_bf16 v[4:7], v[64:67], a[200:207], v120
    ds_read_b128 v[56:59], v121 offset:14336
    ds_read_b128 v[60:63], v121 offset:15360
    v_smfmac_f32_16x16x64_bf16 v[0:3], v[68:71], a[208:215], v120
    v_smfmac_f32_16x16x64_bf16 v[4:7], v[68:71], a[216:223], v120
RB_94:
    s_waitcnt lgkmcnt(9)
    v_smfmac_f32_16x16x64_bf16 v[96:99], v[16:19], a[0:7], v120
    v_smfmac_f32_16x16x64_bf16 v[100:103], v[16:19], a[8:15], v120
    s_waitcnt lgkmcnt(8)
    v_smfmac_f32_16x16x64_bf16 v[96:99], v[20:23], a[16:23], v120
    buffer_store_dwordx4 v[124:127], v113, s[4:7], s27 offen sc1
    v_smfmac_f32_16x16x64_bf16 v[100:103], v[20:23], a[24:31], v120
    s_waitcnt lgkmcnt(7)
    v_smfmac_f32_16x16x64_bf16 v[96:99], v[24:27], a[32:39], v120
    v_smfmac_f32_16x16x64_bf16 v[100:103], v[24:27], a[40:47], v120
    v_mov_b64 v[124:125], -1
    s_waitcnt lgkmcnt(6)
    v_smfmac_f32_16x16x64_bf16 v[96:99], v[28:31], a[48:55], v120
    s_mov_b32 m0, 16384
s_nop 0
    buffer_load_dwordx4 v112, s[4:7], s25 offen sc1 lds
    v_smfmac_f32_16x16x64_bf16 v[100:103], v[28:31], a[56:63], v120
    s_waitcnt vmcnt(2)
    s_waitcnt lgkmcnt(5)
    v_smfmac_f32_16x16x64_bf16 v[96:99], v[8:11], v[32:39], v120
    ds_read_b128 v[76:79], v112 offset:10240
    s_waitcnt lgkmcnt(3)
    v_smfmac_f32_16x16x64_bf16 v[96:99], v[12:15], v[48:55], v120
    v_smfmac_f32_16x16x64_bf16 v[100:103], v[8:11], v[40:47], v120
    buffer_load_dwordx4 v112, s[4:7], s25 offen offset:1024 sc1 lds
    s_waitcnt lgkmcnt(1)
    v_smfmac_f32_16x16x64_bf16 v[100:103], v[12:15], v[56:63], v120
    v_cvt_pk_bf16_f32 v122, v96, v97
    v_smfmac_f32_16x16x64_bf16 v[104:107], v[8:11], a[96:103], v120
    ds_read_b128 v[32:35], v121 offset:20480
    v_cvt_pk_bf16_f32 v123, v98, v99
    v_smfmac_f32_16x16x64_bf16 v[104:107], v[12:15], a[112:119], v120
    ds_read_b128 v[36:39], v121 offset:21504
    v_cvt_pk_bf16_f32 v60, v100, v101
    s_waitcnt lgkmcnt(2)
    v_mfma_f32_16x16x16_bf16 v[96:99], v[122:123], v[76:77], 0
    v_cvt_pk_bf16_f32 v61, v102, v103
    v_smfmac_f32_16x16x64_bf16 v[104:107], v[16:19], a[128:135], v120
    s_mov_b32 m0, 126976
s_nop 0
    buffer_load_dwordx4 v114, s[4:7], s26 offen sc1 lds
    ds_read_b128 v[40:43], v121 offset:28672
    v_mfma_f32_16x16x16_bf16 v[100:103], v[60:61], v[76:77], 0
    v_smfmac_f32_16x16x64_bf16 v[104:107], v[20:23], a[144:151], v120
    ds_read_b128 v[44:47], v121 offset:29696
    v_cvt_pk_bf16_f32 v72, v96, v97
    v_smfmac_f32_16x16x64_bf16 v[104:107], v[24:27], a[160:167], v120
    ds_read_b128 v[48:51], v121 offset:22528
    v_cvt_pk_bf16_f32 v73, v98, v99
    v_smfmac_f32_16x16x64_bf16 v[104:107], v[28:31], a[176:183], v120
    ds_read_b128 v[52:55], v121 offset:23552
    v_cvt_pk_bf16_f32 v74, v100, v101
    v_smfmac_f32_16x16x64_bf16 v[108:111], v[8:11], a[104:111], v120
    s_mov_b32 m0, 127872
s_nop 0
    buffer_load_dwordx4 v114, s[4:7], s26 offen offset:128 sc1 lds
    ds_read_b128 v[64:67], v121 offset:16384
    v_cvt_pk_bf16_f32 v75, v102, v103
    v_smfmac_f32_16x16x64_bf16 v[108:111], v[12:15], a[120:127], v120
    ds_read_b128 v[68:71], v121 offset:17408
    v_cvt_pk_bf16_f32 v56, v104, v105
    v_smfmac_f32_16x16x64_bf16 v[108:111], v[16:19], a[136:143], v120
    v_cvt_pk_bf16_f32 v57, v106, v107
    v_smfmac_f32_16x16x64_bf16 v[108:111], v[20:23], a[152:159], v120
    v_smfmac_f32_16x16x64_bf16 v[108:111], v[24:27], a[168:175], v120
    buffer_store_dword v124, v119, s[4:7], s28 offen sc1
    v_smfmac_f32_16x16x64_bf16 v[108:111], v[28:31], a[184:191], v120
    v_mfma_f32_16x16x16_bf16 v[104:107], v[56:57], v[78:79], 0
    v_mfma_f32_16x16x32_bf16 v[96:99], v[80:83], v[72:75], 0
    v_cvt_pk_bf16_f32 v58, v108, v109
    v_cvt_pk_bf16_f32 v59, v110, v111
s_nop 1
    v_cvt_pk_bf16_f32 v60, v104, v105
    v_cvt_pk_bf16_f32 v61, v106, v107
    v_mfma_f32_16x16x16_bf16 v[108:111], v[58:59], v[78:79], 0
    v_mov_b64 v[76:77], s[38:39]
    v_mov_b64 v[78:79], s[38:39]
    v_mfma_f32_16x16x32_bf16 v[100:103], v[84:87], v[72:75], 0
    v_smfmac_f32_16x16x64_bf16 v[0:3], v[8:11], a[224:231], v120
    v_cvt_pk_bf16_f32 v62, v108, v109
    v_cvt_pk_bf16_f32 v63, v110, v111
s_nop 1
    v_mov_b32_dpp v96, v100 quad_perm:[0,1,2,3] row_mask:0xf bank_mask:0xc
    v_mov_b32_dpp v97, v101 quad_perm:[0,1,2,3] row_mask:0xf bank_mask:0xc
    v_mfma_f32_16x16x32_bf16 v[104:107], v[60:63], v[72:75], 0
    v_mov_b32_dpp v98, v102 quad_perm:[0,1,2,3] row_mask:0xf bank_mask:0xc
    v_mov_b32_dpp v99, v103 quad_perm:[0,1,2,3] row_mask:0xf bank_mask:0xc
    v_smfmac_f32_16x16x64_bf16 v[0:3], v[12:15], a[240:247], v120
    ds_write_b128 v112, v[96:99] offset:22528
    v_smfmac_f32_16x16x64_bf16 v[0:3], v[16:19], v[128:135], v120
    ds_write_b64 v113, v[104:105] offset:11264
    v_smfmac_f32_16x16x64_bf16 v[0:3], v[20:23], v[144:151], v120
    v_smfmac_f32_16x16x64_bf16 v[0:3], v[24:27], v[160:167], v120
    v_smfmac_f32_16x16x64_bf16 v[0:3], v[28:31], v[176:183], v120
    v_smfmac_f32_16x16x64_bf16 v[4:7], v[8:11], a[232:239], v120
    s_waitcnt lgkmcnt(0)
    s_barrier
    ds_read_b128 v[104:107], v112 offset:8192
    ds_read_b128 v[108:111], v112 offset:11264
    v_smfmac_f32_16x16x64_bf16 v[4:7], v[12:15], a[248:255], v120
    ds_read_b128 v[80:83], v112 offset:23552
    ds_read_b128 v[84:87], v112 offset:20480
    v_smfmac_f32_16x16x64_bf16 v[4:7], v[16:19], v[136:143], v120
    ds_read_b128 v[100:103], v112 offset:21504
    v_cvt_pk_bf16_f32 v72, v0, v1
    v_smfmac_f32_16x16x64_bf16 v[4:7], v[20:23], v[152:159], v120
    v_cvt_pk_bf16_f32 v73, v2, v3
    v_smfmac_f32_16x16x64_bf16 v[4:7], v[24:27], v[168:175], v120
    s_cmp_eq_u32 s16, 63
    v_smfmac_f32_16x16x64_bf16 v[4:7], v[28:31], v[184:191], v120
    s_cbranch_scc1 RZ_99
    ds_read_b128 v[16:19], v121 offset:30720
    ds_read_b128 v[20:23], v121 offset:31744
    ds_read_b128 v[24:27], v121 offset:24576
    ds_read_b128 v[28:31], v121 offset:25600
    s_waitcnt lgkmcnt(7)
    v_pk_add_f32 v[104:105], v[104:105], v[106:107]
    v_pk_add_f32 v[108:109], v[108:109], v[110:111]
    s_waitcnt lgkmcnt(6)
    v_pk_add_f32 v[96:97], v[96:97], v[80:81]
    v_pk_add_f32 v[98:99], v[98:99], v[82:83]
    s_waitcnt lgkmcnt(4)
    v_pk_add_f32 v[84:85], v[84:85], v[100:101]
    v_pk_add_f32 v[86:87], v[86:87], v[102:103]
    v_pk_add_f32 v[100:101], v[104:105], v[108:109]
    v_pk_add_f32 v[96:97], v[96:97], v[84:85]
    v_pk_add_f32 v[98:99], v[98:99], v[86:87]
    v_max3_f32 v122, v100, v101, v96
    v_max3_f32 v123, v97, v98, v99
    v_max_f32 v102, v122, v123
    v_cvt_pk_bf16_f32 v74, v4, v5
    v_cvt_pk_bf16_f32 v75, v6, v7
    v_max_f32_dpp v122, v102, v102 row_ror:8 row_mask:0xf bank_mask:0xf
    v_max_f32_dpp v123, v102, v102 row_ror:8 row_mask:0xf bank_mask:0xf
    v_mov_b64 v[110:111], s[34:35]
s_nop 0
    v_permlane16_swap_b32 v122, v123
    v_max_f32 v102, v122, v123
    v_max_f32 v103, v122, v123
s_nop 1
    v_permlane32_swap_b32 v102, v103
    v_max_f32 v122, v102, v103
    v_mul_f32 v122, s32, v122
    v_pk_fma_f32 v[100:101], v[100:101], s[32:33], v[122:123] op_sel_hi:[1,1,0] neg_lo:[0,0,1] neg_hi:[0,0,1]
    v_pk_fma_f32 v[96:97], v[96:97], s[32:33], v[122:123] op_sel_hi:[1,1,0] neg_lo:[0,0,1] neg_hi:[0,0,1]
    v_pk_fma_f32 v[98:99], v[98:99], s[32:33], v[122:123] op_sel_hi:[1,1,0] neg_lo:[0,0,1] neg_hi:[0,0,1]
    v_exp_f32 v100, v100
    v_exp_f32 v101, v101
    v_exp_f32 v96, v96
    v_cvt_pk_bf16_f32 v108, v100, v101
    v_exp_f32 v97, v97
    v_exp_f32 v98, v98
    v_mov_b32_dpp v109, v108 row_ror:8 row_mask:0xf bank_mask:0xf
    v_cvt_pk_bf16_f32 v104, v96, v97
    v_exp_f32 v99, v99
    v_mfma_f32_16x16x16_bf16 v[60:63], v[110:111], v[108:109], 0
    v_cvt_pk_bf16_f32 v105, v98, v99
    v_mov_b32_dpp v106, v104 row_ror:8 row_mask:0xf bank_mask:0xf
    v_mfma_f32_16x16x16_bf16 v[100:103], v[74:75], v[108:109], 0
    v_mov_b32_dpp v107, v105 row_ror:8 row_mask:0xf bank_mask:0xf
    v_mfma_f32_16x16x16_bf16 v[96:99], v[72:73], v[108:109], 0
    ds_read_b128 v[80:83], v121 offset:18432
    ds_read_b128 v[84:87], v121 offset:19456
    v_mfma_f32_16x16x32_bf16 v[60:63], v[76:79], v[104:107], v[60:63]
    v_mfma_f32_16x16x32_bf16 v[100:103], v[92:95], v[104:107], v[100:103]
    v_mfma_f32_16x16x32_bf16 v[96:99], v[88:91], v[104:107], v[96:99]
    v_mov_b64 v[104:105], 0
    v_rcp_f32 v122, v60
    v_mov_b64 v[106:107], 0
    v_mov_b64 v[108:109], 0
    v_pk_mul_f32 v[100:101], v[100:101], v[122:123] op_sel_hi:[1,0]
    v_pk_mul_f32 v[102:103], v[102:103], v[122:123] op_sel_hi:[1,0]
    v_cvt_pk_bf16_f32 v74, v100, v101
    v_cvt_pk_bf16_f32 v75, v102, v103
    v_pk_mul_f32 v[96:97], v[96:97], v[122:123] op_sel_hi:[1,0]
    v_pk_mul_f32 v[98:99], v[98:99], v[122:123] op_sel_hi:[1,0]
    v_cvt_pk_bf16_f32 v72, v96, v97
    v_cvt_pk_bf16_f32 v73, v98, v99
    ds_write_b128 v116, v[72:75] offset:2048
    v_mov_b32_dpp v74, v74 row_ror:8 row_mask:0xf bank_mask:0xc
    v_mov_b32_dpp v75, v75 row_ror:8 row_mask:0xf bank_mask:0xc
    v_mov_b32_dpp v72, v72 row_ror:8 row_mask:0xf bank_mask:0xc
    v_mov_b32_dpp v73, v73 row_ror:8 row_mask:0xf bank_mask:0xc
    v_mov_b64 v[110:111], 0
    v_mov_b64 v[96:97], 0
    v_smfmac_f32_16x16x64_bf16 v[104:107], v[72:75], v[32:39], v120
    ds_read_b128 v[88:91], v121 offset:26624
    ds_read_b128 v[92:95], v121 offset:27648
    v_mov_b64 v[98:99], 0
    v_smfmac_f32_16x16x64_bf16 v[108:111], v[72:75], v[40:47], v120
    v_mov_b64 v[100:101], 0
    v_mov_b64 v[102:103], 0
    s_waitcnt lgkmcnt(2)
    s_barrier
    ds_read_b128 v[8:11], v115 offset:3072
    ds_read_b128 v[12:15], v115 offset:0
    ds_read_b128 v[76:79], v115 offset:1024
    v_smfmac_f32_16x16x64_bf16 v[96:99], v[72:75], v[208:215], v120
    v_smfmac_f32_16x16x64_bf16 v[100:103], v[72:75], v[240:247], v120
    s_waitcnt lgkmcnt(2)
    v_smfmac_f32_16x16x64_bf16 v[96:99], v[8:11], v[216:223], v120
    s_waitcnt lgkmcnt(1)
    v_smfmac_f32_16x16x64_bf16 v[96:99], v[12:15], v[192:199], v120
    s_waitcnt lgkmcnt(0)
    v_smfmac_f32_16x16x64_bf16 v[96:99], v[76:79], v[200:207], v120
    v_smfmac_f32_16x16x64_bf16 v[100:103], v[8:11], v[248:255], v120
    v_smfmac_f32_16x16x64_bf16 v[100:103], v[12:15], v[224:231], v120
    v_cvt_pk_bf16_f32 v96, v96, v97
    v_smfmac_f32_16x16x64_bf16 v[100:103], v[76:79], v[232:239], v120
    v_cvt_pk_bf16_f32 v97, v98, v99
    v_smfmac_f32_16x16x64_bf16 v[104:107], v[8:11], v[48:55], v120
    v_and_or_b32 v96, v96, -2, s29
    v_smfmac_f32_16x16x64_bf16 v[104:107], v[12:15], v[64:71], v120
    buffer_store_dwordx2 v[96:97], v117, s[4:7], s18 offen sc1
    v_cvt_pk_bf16_f32 v100, v100, v101
    v_smfmac_f32_16x16x64_bf16 v[104:107], v[76:79], v[80:87], v120
    v_cvt_pk_bf16_f32 v101, v102, v103
    v_smfmac_f32_16x16x64_bf16 v[108:111], v[8:11], v[16:23], v120
    v_and_or_b32 v100, v100, -2, s29
    v_smfmac_f32_16x16x64_bf16 v[108:111], v[12:15], v[24:31], v120
    buffer_store_dwordx2 v[100:101], v117, s[4:7], s19 offen sc1
    v_cvt_pk_bf16_f32 v104, v104, v105
    v_smfmac_f32_16x16x64_bf16 v[108:111], v[76:79], v[88:95], v120
    ds_read_b128 v[24:27], v112 offset:9216
    v_cvt_pk_bf16_f32 v105, v106, v107
    v_and_or_b32 v104, v104, -2, s29
    buffer_store_dwordx2 v[104:105], v117, s[4:7], s20 offen sc1
    v_permlane32_swap_b32 v0, v4
    v_permlane32_swap_b32 v1, v5
s_nop 1
    v_cvt_pk_bf16_f32 v108, v108, v109
    v_cvt_pk_bf16_f32 v109, v110, v111
    v_and_or_b32 v108, v108, -2, s29
    buffer_store_dwordx2 v[108:109], v117, s[4:7], s21 offen sc1
    s_xor_b32 s19, s19, 0x40000
    s_xor_b32 s20, s20, 0x40000
    s_xor_b32 s21, s21, 0x40000
    s_add_u32 s23, s23, 0x2000
    s_bitset0_b32 s23, 15
    s_add_u32 s28, s28, 0x2000
    s_bitset0_b32 s28, 15
    s_add_u32 s27, s27, 131072
    s_add_u32 s16, s16, 1
    v_permlane32_swap_b32 v2, v6
    v_permlane32_swap_b32 v3, v7
    v_permlane32_swap_b32 v56, v58
    v_permlane32_swap_b32 v57, v59
    v_pk_add_f32 v[0:1], v[0:1], v[4:5]
    v_pk_add_f32 v[2:3], v[2:3], v[6:7]
    v_lshlrev_b32 v64, 16, v56
    v_and_b32 v65, 0xffff0000, v56
    v_lshlrev_b32 v66, 16, v58
    v_and_b32 v67, 0xffff0000, v58
    v_lshlrev_b32 v68, 16, v57
    v_and_b32 v69, 0xffff0000, v57
    v_lshlrev_b32 v70, 16, v59
    v_and_b32 v71, 0xffff0000, v59
    v_pk_add_f32 v[64:65], v[64:65], v[66:67]
    v_pk_add_f32 v[68:69], v[68:69], v[70:71]
    v_cvt_pk_bf16_f32 v126, v0, v1
    v_cvt_pk_bf16_f32 v127, v2, v3
    v_cvt_pk_bf16_f32 v124, v64, v65
    v_cvt_pk_bf16_f32 v125, v68, v69
    v_mov_b64 v[0:1], 0
    v_mov_b64 v[2:3], 0
    v_mov_b64 v[4:5], 0
    v_mov_b64 v[6:7], 0
    v_mov_b64 v[96:97], 0
    v_mov_b64 v[98:99], 0
    v_mov_b64 v[100:101], 0
    v_mov_b64 v[102:103], 0
    v_mov_b64 v[104:105], 0
    v_mov_b64 v[106:107], 0
    v_mov_b64 v[108:109], 0
    v_mov_b64 v[110:111], 0
    ds_read_b128 v[32:35], v121 offset:0
    ds_read_b128 v[36:39], v121 offset:1024
    ds_read_b128 v[40:43], v121 offset:2048
    ds_read_b128 v[44:47], v121 offset:3072
    buffer_load_dwordx4 v[8:11], v118, s[4:7], s18 offen offset:0 sc1
    buffer_load_dwordx4 v[12:15], v118, s[4:7], s18 offen offset:1024 sc1
    s_waitcnt lgkmcnt(4)
    s_barrier
RD_100:
    s_waitcnt vmcnt(1)
    v_mfma_f32_16x16x32_bf16 v[28:31], v[24:27], v[8:11], 0
    v_bitop3_b32 v122, v8, v10, s29 bitop3:0x7e
    s_waitcnt vmcnt(0)
    v_mfma_f32_16x16x32_bf16 v[28:31], v[24:27], v[12:15], v[28:31]
    v_bitop3_b32 v123, v12, v14, s29 bitop3:0x7e
    v_bitop3_b32 v122, v122, v123, 1 bitop3:0xa8
    v_cmp_ne_u32 vcc, 0, v122
    s_cbranch_vccnz RO_101
s_nop 3
    v_add_f32_dpp v28, v28, v28 row_ror:8 row_mask:0xf bank_mask:0xf
    v_add_f32_dpp v29, v29, v29 row_ror:8 row_mask:0xf bank_mask:0xf
s_nop 0
    v_add_f32_dpp v28, v28, v28 row_ror:4 row_mask:0xf bank_mask:0xf
    v_add_f32_dpp v29, v29, v29 row_ror:4 row_mask:0xf bank_mask:0xf
    v_cvt_pk_bf16_f32 v122, v28, v29
    buffer_store_dword v122, v119, s[4:7], s24 offen sc1
    s_xor_b32 s18, s18, 0x40000
    s_bfe_u32 s29, s16, 0x10001
    s_add_u32 s24, s24, 0x2000
    s_bitset0_b32 s24, 15
    s_branch RL_89
RO_101:
    s_sub_u32 s30, s30, 1
    s_cbranch_scc1 L_abort
    s_mov_b64 exec, vcc
    buffer_load_dwordx4 v[8:11], v118, s[4:7], s18 offen offset:0 sc1
    buffer_load_dwordx4 v[12:15], v118, s[4:7], s18 offen offset:1024 sc1
    s_mov_b64 exec, -1
    s_branch RD_100
RF_92:
    s_sub_u32 s30, s30, 1
    s_cbranch_scc1 L_abort
    s_mov_b64 exec, vcc
    buffer_load_dwordx4 v[64:67], v112, s[4:7], s23 offen sc1
    buffer_load_dwordx4 v[68:71], v112, s[4:7], s23 offen offset:1024 sc1
    s_mov_b64 exec, -1
    v_mov_b64 v[96:97], 0
    v_mov_b64 v[98:99], 0
    v_mov_b64 v[100:101], 0
    v_mov_b64 v[102:103], 0
    s_branch RC_90
KC_95:
    v_lshrrev_b32 v122, 2, v112
    buffer_load_dword v123, v122, s[4:7], s40 offen sc1
    s_sub_u32 s30, s30, 1
    s_cbranch_scc1 L_abort
    s_waitcnt vmcnt(0)
    v_cmp_ne_u32 vcc, 0, v123
    s_nop 4
    s_ff0_i32_b64 s17, vcc
    s_cmp_gt_u32 s17, s41
    s_cbranch_scc0 KC_95
    s_branch KC_96
KC_97:
    v_lshrrev_b32 v122, 2, v112
    buffer_load_dword v123, v122, s[4:7], s40 offen sc1
    s_sub_u32 s30, s30, 1
    s_cbranch_scc1 L_abort
    s_waitcnt vmcnt(0)
    v_cmp_ne_u32 vcc, 0, v123
    s_nop 4
    s_ff0_i32_b64 s17, vcc
    s_cmp_gt_u32 s17, s41
    s_cbranch_scc0 KC_97
    s_branch KC_98
RZ_99:
    s_waitcnt lgkmcnt(0)
    s_nop 7
    s_nop 7
    s_add_u32 s27, s27, 131072
    v_permlane32_swap_b32 v0, v4
    v_permlane32_swap_b32 v1, v5
    v_permlane32_swap_b32 v2, v6
    v_permlane32_swap_b32 v3, v7
    v_permlane32_swap_b32 v56, v58
    v_permlane32_swap_b32 v57, v59
    v_pk_add_f32 v[0:1], v[0:1], v[4:5]
    v_pk_add_f32 v[2:3], v[2:3], v[6:7]
    v_lshlrev_b32 v64, 16, v56
    v_and_b32 v65, 0xffff0000, v56
    v_lshlrev_b32 v66, 16, v58
    v_and_b32 v67, 0xffff0000, v58
    v_lshlrev_b32 v68, 16, v57
    v_and_b32 v69, 0xffff0000, v57
    v_lshlrev_b32 v70, 16, v59
    v_and_b32 v71, 0xffff0000, v59
    v_pk_add_f32 v[64:65], v[64:65], v[66:67]
    v_pk_add_f32 v[68:69], v[68:69], v[70:71]
    v_cvt_pk_bf16_f32 v126, v0, v1
    v_cvt_pk_bf16_f32 v127, v2, v3
    v_cvt_pk_bf16_f32 v124, v64, v65
    v_cvt_pk_bf16_f32 v125, v68, v69
    buffer_store_dwordx4 v[124:127], v113, s[4:7], s27 offen sc1
    s_branch L_rdone
RW_62:
    s_cmp_gt_u32 s17, s41
    s_cbranch_scc0 KC_108
KC_109:
    s_add_u32 s41, s41, 1
    s_mov_b32 m0, 18432
s_nop 0
    buffer_load_dwordx4 v112, s[4:7], s25 offen sc1 lds
    buffer_load_dwordx4 v112, s[4:7], s25 offen offset:1024 sc1 lds
    s_mov_b32 m0, 161792
s_nop 0
    buffer_load_dwordx4 v114, s[4:7], s26 offen sc1 lds
    s_mov_b32 m0, 162688
s_nop 0
    buffer_load_dwordx4 v114, s[4:7], s26 offen offset:128 sc1 lds
    ds_read_b128 v[32:35], v121 offset:0
    ds_read_b128 v[36:39], v121 offset:1024
    ds_read_b128 v[40:43], v121 offset:2048
    ds_read_b128 v[44:47], v121 offset:3072
    ds_read_b128 v[48:51], v121 offset:4096
    ds_read_b128 v[52:55], v121 offset:5120
    ds_read_b128 v[56:59], v121 offset:6144
    ds_read_b128 v[60:63], v121 offset:7168
    v_mov_b64 v[96:97], 0
    v_mov_b64 v[98:99], 0
    v_mov_b64 v[100:101], 0
    v_mov_b64 v[102:103], 0
    v_mov_b64 v[104:105], 0
    v_mov_b64 v[106:107], 0
    v_mov_b64 v[108:109], 0
    v_mov_b64 v[110:111], 0
    v_mov_b64 v[0:1], 0
    v_mov_b64 v[2:3], 0
    v_mov_b64 v[4:5], 0
    v_mov_b64 v[6:7], 0
    s_waitcnt vmcnt(0)
RL_102:
    ds_read_b128 v[48:51], v121 offset:4096
    ds_read_b128 v[52:55], v121 offset:5120
    ds_read_b128 v[56:59], v121 offset:6144
    ds_read_b128 v[60:63], v121 offset:7168
    ds_read_b128 v[80:83], v112 offset:18432
    ds_read_b128 v[84:87], v112 offset:19456
    ds_read_b128 v[88:91], v121 offset:32768
    ds_read_b128 v[92:95], v121 offset:33792
    s_add_u32 s25, s25, 524288
    s_add_u32 s26, s26, 524288
    buffer_load_dwordx4 v[64:67], v112, s[4:7], s23 offen sc1
    buffer_load_dwordx4 v[68:71], v112, s[4:7], s23 offen offset:1024 sc1
    s_cmp_gt_u32 s17, s41
    s_cbranch_scc0 KC_110
KC_111:
    s_add_u32 s41, s41, 1
RC_103:
    s_waitcnt vmcnt(1) lgkmcnt(0)
    v_max3_u32 v122, v64, v65, v66
    v_max_u32 v122, v122, v67
    v_smfmac_f32_16x16x64_bf16 v[96:99], v[64:67], v[32:39], v120
    ds_write_b128 v112, v[64:67] offset:6144
    s_waitcnt vmcnt(0)
    v_max3_u32 v122, v122, v68, v69
    v_smfmac_f32_16x16x64_bf16 v[100:103], v[64:67], v[40:47], v120
    v_max3_u32 v122, v122, v70, v71
    v_cmp_eq_u32 vcc, -1, v122
    s_cbranch_vccnz RF_105
    v_smfmac_f32_16x16x64_bf16 v[96:99], v[68:71], v[48:55], v120
    ds_write_b128 v112, v[68:71] offset:7168
    v_smfmac_f32_16x16x64_bf16 v[100:103], v[68:71], v[56:63], v120
    v_smfmac_f32_16x16x64_bf16 v[104:107], v[64:67], a[64:71], v120
    ds_read_b128 v[32:35], v121 offset:8192
    ds_read_b128 v[36:39], v121 offset:9216
    v_smfmac_f32_16x16x64_bf16 v[108:111], v[64:67], a[72:79], v120
    ds_read_b128 v[40:43], v121 offset:10240
    ds_read_b128 v[44:47], v121 offset:11264
    s_waitcnt lgkmcnt(4)
    s_barrier
    ds_read_b128 v[16:19], v112 offset:2048
    ds_read_b128 v[20:23], v112 offset:3072
    v_smfmac_f32_16x16x64_bf16 v[104:107], v[68:71], a[80:87], v120
    ds_read_b128 v[24:27], v112 offset:0
    ds_read_b128 v[28:31], v112 offset:1024
    v_smfmac_f32_16x16x64_bf16 v[108:111], v[68:71], a[88:95], v120
    ds_read_b128 v[8:11], v112 offset:4096
    ds_read_b128 v[12:15], v112 offset:5120
    v_smfmac_f32_16x16x64_bf16 v[0:3], v[64:67], a[192:199], v120
    ds_read_b128 v[48:51], v121 offset:12288
    ds_read_b128 v[52:55], v121 offset:13312
    v_smfmac_f32_16x16x64_bf16 v[4:7], v[64:67], a[200:207], v120
    ds_read_b128 v[56:59], v121 offset:14336
    ds_read_b128 v[60:63], v121 offset:15360
    v_smfmac_f32_16x16x64_bf16 v[0:3], v[68:71], a[208:215], v120
    v_smfmac_f32_16x16x64_bf16 v[4:7], v[68:71], a[216:223], v120
RB_107:
    s_waitcnt lgkmcnt(9)
    v_smfmac_f32_16x16x64_bf16 v[96:99], v[16:19], a[0:7], v120
    v_smfmac_f32_16x16x64_bf16 v[100:103], v[16:19], a[8:15], v120
    s_waitcnt lgkmcnt(8)
    v_smfmac_f32_16x16x64_bf16 v[96:99], v[20:23], a[16:23], v120
    v_smfmac_f32_16x16x64_bf16 v[100:103], v[20:23], a[24:31], v120
    buffer_store_dwordx4 v[124:127], v113, s[4:7], s27 offen sc1
    s_waitcnt lgkmcnt(7)
    v_smfmac_f32_16x16x64_bf16 v[96:99], v[24:27], a[32:39], v120
    v_smfmac_f32_16x16x64_bf16 v[100:103], v[24:27], a[40:47], v120
    v_mov_b64 v[124:125], -1
    s_waitcnt lgkmcnt(6)
    v_smfmac_f32_16x16x64_bf16 v[96:99], v[28:31], a[48:55], v120
    v_smfmac_f32_16x16x64_bf16 v[100:103], v[28:31], a[56:63], v120
    s_mov_b32 m0, 18432
s_nop 0
    buffer_load_dwordx4 v112, s[4:7], s25 offen sc1 lds
    s_waitcnt vmcnt(2)
    s_waitcnt lgkmcnt(5)
    v_smfmac_f32_16x16x64_bf16 v[96:99], v[8:11], v[32:39], v120
    ds_read_b128 v[76:79], v112 offset:10240
    s_waitcnt lgkmcnt(3)
    v_smfmac_f32_16x16x64_bf16 v[96:99], v[12:15], v[48:55], v120
    v_smfmac_f32_16x16x64_bf16 v[100:103], v[8:11], v[40:47], v120
    s_waitcnt lgkmcnt(1)
    v_smfmac_f32_16x16x64_bf16 v[100:103], v[12:15], v[56:63], v120
    buffer_load_dwordx4 v112, s[4:7], s25 offen offset:1024 sc1 lds
    v_cvt_pk_bf16_f32 v122, v96, v97
    v_smfmac_f32_16x16x64_bf16 v[104:107], v[8:11], a[96:103], v120
    ds_read_b128 v[32:35], v121 offset:22528
    v_cvt_pk_bf16_f32 v123, v98, v99
    v_smfmac_f32_16x16x64_bf16 v[104:107], v[12:15], a[112:119], v120
    ds_read_b128 v[36:39], v121 offset:23552
    v_cvt_pk_bf16_f32 v60, v100, v101
    s_waitcnt lgkmcnt(2)
    v_mfma_f32_16x16x16_bf16 v[96:99], v[122:123], v[76:77], 0
    v_cvt_pk_bf16_f32 v61, v102, v103
    v_smfmac_f32_16x16x64_bf16 v[104:107], v[16:19], a[128:135], v120
    ds_read_b128 v[40:43], v121 offset:30720
    v_mfma_f32_16x16x16_bf16 v[100:103], v[60:61], v[76:77], 0
    v_smfmac_f32_16x16x64_bf16 v[104:107], v[20:23], a[144:151], v120
    s_mov_b32 m0, 161792
s_nop 0
    buffer_load_dwordx4 v114, s[4:7], s26 offen sc1 lds
    ds_read_b128 v[44:47], v121 offset:31744
    v_cvt_pk_bf16_f32 v72, v96, v97
    v_smfmac_f32_16x16x64_bf16 v[104:107], v[24:27], a[160:167], v120
    ds_read_b128 v[48:51], v121 offset:20480
    v_cvt_pk_bf16_f32 v73, v98, v99
    v_smfmac_f32_16x16x64_bf16 v[104:107], v[28:31], a[176:183], v120
    ds_read_b128 v[52:55], v121 offset:21504
    v_cvt_pk_bf16_f32 v74, v100, v101
    v_smfmac_f32_16x16x64_bf16 v[108:111], v[8:11], a[104:111], v120
    ds_read_b128 v[64:67], v121 offset:18432
    v_cvt_pk_bf16_f32 v75, v102, v103
    v_smfmac_f32_16x16x64_bf16 v[108:111], v[12:15], a[120:127], v120
    s_mov_b32 m0, 162688
s_nop 0
    buffer_load_dwordx4 v114, s[4:7], s26 offen offset:128 sc1 lds
    ds_read_b128 v[68:71], v121 offset:19456
    v_cvt_pk_bf16_f32 v56, v104, v105
    v_smfmac_f32_16x16x64_bf16 v[108:111], v[16:19], a[136:143], v120
    v_cvt_pk_bf16_f32 v57, v106, v107
    v_smfmac_f32_16x16x64_bf16 v[108:111], v[20:23], a[152:159], v120
    v_smfmac_f32_16x16x64_bf16 v[108:111], v[24:27], a[168:175], v120
    v_smfmac_f32_16x16x64_bf16 v[108:111], v[28:31], a[184:191], v120
    buffer_store_dword v124, v119, s[4:7], s28 offen sc1
    v_mfma_f32_16x16x16_bf16 v[104:107], v[56:57], v[78:79], 0
    v_mfma_f32_16x16x32_bf16 v[96:99], v[80:83], v[72:75], 0
    v_cvt_pk_bf16_f32 v58, v108, v109
    v_cvt_pk_bf16_f32 v59, v110, v111
s_nop 1
    v_cvt_pk_bf16_f32 v60, v104, v105
    v_cvt_pk_bf16_f32 v61, v106, v107
    v_mfma_f32_16x16x16_bf16 v[108:111], v[58:59], v[78:79], 0
    v_mov_b64 v[76:77], s[38:39]
    v_mov_b64 v[78:79], s[38:39]
    v_mfma_f32_16x16x32_bf16 v[100:103], v[84:87], v[72:75], 0
    v_smfmac_f32_16x16x64_bf16 v[0:3], v[8:11], a[224:231], v120
    v_cvt_pk_bf16_f32 v62, v108, v109
    v_cvt_pk_bf16_f32 v63, v110, v111
s_nop 1
    v_mov_b32_dpp v96, v100 quad_perm:[0,1,2,3] row_mask:0xf bank_mask:0xc
    v_mov_b32_dpp v97, v101 quad_perm:[0,1,2,3] row_mask:0xf bank_mask:0xc
    v_mfma_f32_16x16x32_bf16 v[104:107], v[60:63], v[72:75], 0
    v_mov_b32_dpp v98, v102 quad_perm:[0,1,2,3] row_mask:0xf bank_mask:0xc
    v_mov_b32_dpp v99, v103 quad_perm:[0,1,2,3] row_mask:0xf bank_mask:0xc
    v_smfmac_f32_16x16x64_bf16 v[0:3], v[12:15], a[240:247], v120
    ds_write_b128 v112, v[96:99] offset:23552
    v_smfmac_f32_16x16x64_bf16 v[0:3], v[16:19], v[128:135], v120
    ds_write_b64 v113, v[104:105] offset:11272
    v_smfmac_f32_16x16x64_bf16 v[0:3], v[20:23], v[144:151], v120
    v_smfmac_f32_16x16x64_bf16 v[0:3], v[24:27], v[160:167], v120
    v_smfmac_f32_16x16x64_bf16 v[0:3], v[28:31], v[176:183], v120
    v_smfmac_f32_16x16x64_bf16 v[4:7], v[8:11], a[232:239], v120
    s_waitcnt lgkmcnt(0)
    s_barrier
    ds_read_b128 v[104:107], v112 offset:8192
    ds_read_b128 v[108:111], v112 offset:11264
    v_smfmac_f32_16x16x64_bf16 v[4:7], v[12:15], a[248:255], v120
    ds_read_b128 v[80:83], v112 offset:22528
    ds_read_b128 v[84:87], v112 offset:21504
    v_smfmac_f32_16x16x64_bf16 v[4:7], v[16:19], v[136:143], v120
    ds_read_b128 v[100:103], v112 offset:20480
    v_cvt_pk_bf16_f32 v72, v0, v1
    v_smfmac_f32_16x16x64_bf16 v[4:7], v[20:23], v[152:159], v120
    v_cvt_pk_bf16_f32 v73, v2, v3
    v_smfmac_f32_16x16x64_bf16 v[4:7], v[24:27], v[168:175], v120
    s_cmp_eq_u32 s16, 63
    v_smfmac_f32_16x16x64_bf16 v[4:7], v[28:31], v[184:191], v120
    s_cbranch_scc1 RZ_112
    ds_read_b128 v[16:19], v121 offset:28672
    ds_read_b128 v[20:23], v121 offset:29696
    ds_read_b128 v[24:27], v121 offset:26624
    ds_read_b128 v[28:31], v121 offset:27648
    s_waitcnt lgkmcnt(7)
    v_pk_add_f32 v[104:105], v[104:105], v[106:107]
    v_pk_add_f32 v[108:109], v[108:109], v[110:111]
    s_waitcnt lgkmcnt(6)
    v_pk_add_f32 v[96:97], v[96:97], v[80:81]
    v_pk_add_f32 v[98:99], v[98:99], v[82:83]
    s_waitcnt lgkmcnt(4)
    v_pk_add_f32 v[84:85], v[84:85], v[100:101]
    v_pk_add_f32 v[86:87], v[86:87], v[102:103]
    v_pk_add_f32 v[100:101], v[104:105], v[108:109]
    v_pk_add_f32 v[96:97], v[96:97], v[84:85]
    v_pk_add_f32 v[98:99], v[98:99], v[86:87]
    v_max3_f32 v122, v100, v101, v96
    v_max3_f32 v123, v97, v98, v99
    v_max_f32 v102, v122, v123
    v_cvt_pk_bf16_f32 v74, v4, v5
    v_cvt_pk_bf16_f32 v75, v6, v7
    v_max_f32_dpp v122, v102, v102 row_ror:8 row_mask:0xf bank_mask:0xf
    v_max_f32_dpp v123, v102, v102 row_ror:8 row_mask:0xf bank_mask:0xf
    v_mov_b64 v[110:111], s[34:35]
s_nop 0
    v_permlane16_swap_b32 v122, v123
    v_max_f32 v102, v122, v123
    v_max_f32 v103, v122, v123
s_nop 1
    v_permlane32_swap_b32 v102, v103
    v_max_f32 v122, v102, v103
    v_mul_f32 v122, s32, v122
    v_pk_fma_f32 v[100:101], v[100:101], s[32:33], v[122:123] op_sel_hi:[1,1,0] neg_lo:[0,0,1] neg_hi:[0,0,1]
    v_pk_fma_f32 v[96:97], v[96:97], s[32:33], v[122:123] op_sel_hi:[1,1,0] neg_lo:[0,0,1] neg_hi:[0,0,1]
    v_pk_fma_f32 v[98:99], v[98:99], s[32:33], v[122:123] op_sel_hi:[1,1,0] neg_lo:[0,0,1] neg_hi:[0,0,1]
    v_exp_f32 v100, v100
    v_exp_f32 v101, v101
    v_exp_f32 v96, v96
    v_cvt_pk_bf16_f32 v108, v100, v101
    v_exp_f32 v97, v97
    v_exp_f32 v98, v98
    v_mov_b32_dpp v109, v108 row_ror:8 row_mask:0xf bank_mask:0xf
    v_cvt_pk_bf16_f32 v104, v96, v97
    v_exp_f32 v99, v99
    v_mfma_f32_16x16x16_bf16 v[60:63], v[110:111], v[108:109], 0
    v_cvt_pk_bf16_f32 v105, v98, v99
    v_mov_b32_dpp v106, v104 row_ror:8 row_mask:0xf bank_mask:0xf
    v_mfma_f32_16x16x16_bf16 v[100:103], v[74:75], v[108:109], 0
    v_mov_b32_dpp v107, v105 row_ror:8 row_mask:0xf bank_mask:0xf
    v_mfma_f32_16x16x16_bf16 v[96:99], v[72:73], v[108:109], 0
    ds_read_b128 v[80:83], v121 offset:16384
    ds_read_b128 v[84:87], v121 offset:17408
    v_mfma_f32_16x16x32_bf16 v[60:63], v[76:79], v[104:107], v[60:63]
    v_mfma_f32_16x16x32_bf16 v[100:103], v[92:95], v[104:107], v[100:103]
    v_mfma_f32_16x16x32_bf16 v[96:99], v[88:91], v[104:107], v[96:99]
    v_mov_b64 v[104:105], 0
    v_rcp_f32 v122, v60
    v_mov_b64 v[106:107], 0
    v_mov_b64 v[108:109], 0
    v_pk_mul_f32 v[100:101], v[100:101], v[122:123] op_sel_hi:[1,0]
    v_pk_mul_f32 v[102:103], v[102:103], v[122:123] op_sel_hi:[1,0]
    v_cvt_pk_bf16_f32 v74, v100, v101
    v_cvt_pk_bf16_f32 v75, v102, v103
    v_pk_mul_f32 v[96:97], v[96:97], v[122:123] op_sel_hi:[1,0]
    v_pk_mul_f32 v[98:99], v[98:99], v[122:123] op_sel_hi:[1,0]
    v_cvt_pk_bf16_f32 v72, v96, v97
    v_cvt_pk_bf16_f32 v73, v98, v99
    ds_write_b128 v116, v[72:75] offset:3072
    v_mov_b32_dpp v74, v74 row_ror:8 row_mask:0xf bank_mask:0xc
    v_mov_b32_dpp v75, v75 row_ror:8 row_mask:0xf bank_mask:0xc
    v_mov_b32_dpp v72, v72 row_ror:8 row_mask:0xf bank_mask:0xc
    v_mov_b32_dpp v73, v73 row_ror:8 row_mask:0xf bank_mask:0xc
    v_mov_b64 v[110:111], 0
    v_mov_b64 v[96:97], 0
    v_smfmac_f32_16x16x64_bf16 v[104:107], v[72:75], v[32:39], v120
    ds_read_b128 v[88:91], v121 offset:24576
    ds_read_b128 v[92:95], v121 offset:25600
    v_mov_b64 v[98:99], 0
    v_smfmac_f32_16x16x64_bf16 v[108:111], v[72:75], v[40:47], v120
    v_mov_b64 v[100:101], 0
    v_mov_b64 v[102:103], 0
    s_waitcnt lgkmcnt(2)
    s_barrier
    ds_read_b128 v[8:11], v115 offset:2048
    ds_read_b128 v[12:15], v115 offset:1024
    ds_read_b128 v[76:79], v115 offset:0
    v_smfmac_f32_16x16x64_bf16 v[96:99], v[72:75], v[216:223], v120
    v_smfmac_f32_16x16x64_bf16 v[100:103], v[72:75], v[248:255], v120
    s_waitcnt lgkmcnt(2)
    v_smfmac_f32_16x16x64_bf16 v[96:99], v[8:11], v[208:215], v120
    s_waitcnt lgkmcnt(1)
    v_smfmac_f32_16x16x64_bf16 v[96:99], v[12:15], v[200:207], v120
    s_waitcnt lgkmcnt(0)
    v_smfmac_f32_16x16x64_bf16 v[96:99], v[76:79], v[192:199], v120
    v_smfmac_f32_16x16x64_bf16 v[100:103], v[8:11], v[240:247], v120
    v_smfmac_f32_16x16x64_bf16 v[100:103], v[12:15], v[232:239], v120
    v_cvt_pk_bf16_f32 v96, v96, v97
    v_smfmac_f32_16x16x64_bf16 v[100:103], v[76:79], v[224:231], v120
    v_cvt_pk_bf16_f32 v97, v98, v99
    v_smfmac_f32_16x16x64_bf16 v[104:107], v[8:11], v[48:55], v120
    v_and_or_b32 v96, v96, -2, s29
    v_smfmac_f32_16x16x64_bf16 v[104:107], v[12:15], v[64:71], v120
    buffer_store_dwordx2 v[96:97], v117, s[4:7], s18 offen sc1
    v_cvt_pk_bf16_f32 v100, v100, v101
    v_smfmac_f32_16x16x64_bf16 v[104:107], v[76:79], v[80:87], v120
    v_cvt_pk_bf16_f32 v101, v102, v103
    v_smfmac_f32_16x16x64_bf16 v[108:111], v[8:11], v[16:23], v120
    v_and_or_b32 v100, v100, -2, s29
    v_smfmac_f32_16x16x64_bf16 v[108:111], v[12:15], v[24:31], v120
    buffer_store_dwordx2 v[100:101], v117, s[4:7], s19 offen sc1
    v_cvt_pk_bf16_f32 v104, v104, v105
    v_smfmac_f32_16x16x64_bf16 v[108:111], v[76:79], v[88:95], v120
    ds_read_b128 v[24:27], v112 offset:9216
    v_cvt_pk_bf16_f32 v105, v106, v107
    v_and_or_b32 v104, v104, -2, s29
    buffer_store_dwordx2 v[104:105], v117, s[4:7], s20 offen sc1
    v_permlane32_swap_b32 v0, v4
    v_permlane32_swap_b32 v1, v5
s_nop 1
    v_cvt_pk_bf16_f32 v108, v108, v109
    v_cvt_pk_bf16_f32 v109, v110, v111
    v_and_or_b32 v108, v108, -2, s29
    buffer_store_dwordx2 v[108:109], v117, s[4:7], s21 offen sc1
    s_xor_b32 s19, s19, 0x40000
    s_xor_b32 s20, s20, 0x40000
    s_xor_b32 s21, s21, 0x40000
    s_add_u32 s23, s23, 0x2000
    s_bitset0_b32 s23, 15
    s_add_u32 s28, s28, 0x2000
    s_bitset0_b32 s28, 15
    s_add_u32 s27, s27, 131072
    s_add_u32 s16, s16, 1
    v_permlane32_swap_b32 v2, v6
    v_permlane32_swap_b32 v3, v7
    v_permlane32_swap_b32 v56, v58
    v_permlane32_swap_b32 v57, v59
    v_pk_add_f32 v[0:1], v[0:1], v[4:5]
    v_pk_add_f32 v[2:3], v[2:3], v[6:7]
    v_lshlrev_b32 v64, 16, v56
    v_and_b32 v65, 0xffff0000, v56
    v_lshlrev_b32 v66, 16, v58
    v_and_b32 v67, 0xffff0000, v58
    v_lshlrev_b32 v68, 16, v57
    v_and_b32 v69, 0xffff0000, v57
    v_lshlrev_b32 v70, 16, v59
    v_and_b32 v71, 0xffff0000, v59
    v_pk_add_f32 v[64:65], v[64:65], v[66:67]
    v_pk_add_f32 v[68:69], v[68:69], v[70:71]
    v_cvt_pk_bf16_f32 v126, v0, v1
    v_cvt_pk_bf16_f32 v127, v2, v3
    v_cvt_pk_bf16_f32 v124, v64, v65
    v_cvt_pk_bf16_f32 v125, v68, v69
    v_mov_b64 v[0:1], 0
    v_mov_b64 v[2:3], 0
    v_mov_b64 v[4:5], 0
    v_mov_b64 v[6:7], 0
    v_mov_b64 v[96:97], 0
    v_mov_b64 v[98:99], 0
    v_mov_b64 v[100:101], 0
    v_mov_b64 v[102:103], 0
    v_mov_b64 v[104:105], 0
    v_mov_b64 v[106:107], 0
    v_mov_b64 v[108:109], 0
    v_mov_b64 v[110:111], 0
    ds_read_b128 v[32:35], v121 offset:0
    ds_read_b128 v[36:39], v121 offset:1024
    ds_read_b128 v[40:43], v121 offset:2048
    ds_read_b128 v[44:47], v121 offset:3072
    buffer_load_dwordx4 v[8:11], v118, s[4:7], s18 offen offset:0 sc1
    buffer_load_dwordx4 v[12:15], v118, s[4:7], s18 offen offset:1024 sc1
    s_waitcnt lgkmcnt(4)
    s_barrier
RD_113:
    s_waitcnt vmcnt(1)
    v_mfma_f32_16x16x32_bf16 v[28:31], v[24:27], v[8:11], 0
    v_bitop3_b32 v122, v8, v10, s29 bitop3:0x7e
    s_waitcnt vmcnt(0)
    v_mfma_f32_16x16x32_bf16 v[28:31], v[24:27], v[12:15], v[28:31]
    v_bitop3_b32 v123, v12, v14, s29 bitop3:0x7e
    v_bitop3_b32 v122, v122, v123, 1 bitop3:0xa8
    v_cmp_ne_u32 vcc, 0, v122
    s_cbranch_vccnz RO_114
s_nop 3
    v_add_f32_dpp v28, v28, v28 row_ror:8 row_mask:0xf bank_mask:0xf
    v_add_f32_dpp v29, v29, v29 row_ror:8 row_mask:0xf bank_mask:0xf
s_nop 0
    v_add_f32_dpp v28, v28, v28 row_ror:4 row_mask:0xf bank_mask:0xf
    v_add_f32_dpp v29, v29, v29 row_ror:4 row_mask:0xf bank_mask:0xf
    v_cvt_pk_bf16_f32 v122, v28, v29
    buffer_store_dword v122, v119, s[4:7], s24 offen sc1
    s_xor_b32 s18, s18, 0x40000
    s_bfe_u32 s29, s16, 0x10001
    s_add_u32 s24, s24, 0x2000
    s_bitset0_b32 s24, 15
    s_branch RL_102
RO_114:
    s_sub_u32 s30, s30, 1
    s_cbranch_scc1 L_abort
    s_mov_b64 exec, vcc
    buffer_load_dwordx4 v[8:11], v118, s[4:7], s18 offen offset:0 sc1
    buffer_load_dwordx4 v[12:15], v118, s[4:7], s18 offen offset:1024 sc1
    s_mov_b64 exec, -1
    s_branch RD_113
RF_105:
    s_sub_u32 s30, s30, 1
    s_cbranch_scc1 L_abort
    s_mov_b64 exec, vcc
    buffer_load_dwordx4 v[64:67], v112, s[4:7], s23 offen sc1
    buffer_load_dwordx4 v[68:71], v112, s[4:7], s23 offen offset:1024 sc1
    s_mov_b64 exec, -1
    v_mov_b64 v[96:97], 0
    v_mov_b64 v[98:99], 0
    v_mov_b64 v[100:101], 0
    v_mov_b64 v[102:103], 0
    s_branch RC_103
KC_108:
    v_lshrrev_b32 v122, 2, v112
    buffer_load_dword v123, v122, s[4:7], s40 offen sc1
    s_sub_u32 s30, s30, 1
    s_cbranch_scc1 L_abort
    s_waitcnt vmcnt(0)
    v_cmp_ne_u32 vcc, 0, v123
    s_nop 4
    s_ff0_i32_b64 s17, vcc
    s_cmp_gt_u32 s17, s41
    s_cbranch_scc0 KC_108
    s_branch KC_109
KC_110:
    v_lshrrev_b32 v122, 2, v112
    buffer_load_dword v123, v122, s[4:7], s40 offen sc1
    s_sub_u32 s30, s30, 1
    s_cbranch_scc1 L_abort
    s_waitcnt vmcnt(0)
    v_cmp_ne_u32 vcc, 0, v123
    s_nop 4
    s_ff0_i32_b64 s17, vcc
    s_cmp_gt_u32 s17, s41
    s_cbranch_scc0 KC_110
    s_branch KC_111
RZ_112:
    s_waitcnt lgkmcnt(0)
    s_nop 7
    s_nop 7
    s_add_u32 s27, s27, 131072
    v_permlane32_swap_b32 v0, v4
    v_permlane32_swap_b32 v1, v5
    v_permlane32_swap_b32 v2, v6
    v_permlane32_swap_b32 v3, v7
    v_permlane32_swap_b32 v56, v58
    v_permlane32_swap_b32 v57, v59
    v_pk_add_f32 v[0:1], v[0:1], v[4:5]
    v_pk_add_f32 v[2:3], v[2:3], v[6:7]
    v_lshlrev_b32 v64, 16, v56
    v_and_b32 v65, 0xffff0000, v56
    v_lshlrev_b32 v66, 16, v58
    v_and_b32 v67, 0xffff0000, v58
    v_lshlrev_b32 v68, 16, v57
    v_and_b32 v69, 0xffff0000, v57
    v_lshlrev_b32 v70, 16, v59
    v_and_b32 v71, 0xffff0000, v59
    v_pk_add_f32 v[64:65], v[64:65], v[66:67]
    v_pk_add_f32 v[68:69], v[68:69], v[70:71]
    v_cvt_pk_bf16_f32 v126, v0, v1
    v_cvt_pk_bf16_f32 v127, v2, v3
    v_cvt_pk_bf16_f32 v124, v64, v65
    v_cvt_pk_bf16_f32 v125, v68, v69
    buffer_store_dwordx4 v[124:127], v113, s[4:7], s27 offen sc1
    s_branch L_rdone
L_worker:

    v_lshrrev_b32 v1, 6, v0
    v_and_b32 v0, 63, v0
    v_readfirstlane_b32 s15, v1
    s_load_dwordx2 s[40:41], s[0:1], 0
    s_load_dwordx2 s[44:45], s[0:1], 24
    s_load_dwordx2 s[46:47], s[0:1], 32
    s_load_dwordx2 s[42:43], s[0:1], 16
    s_load_dwordx2 s[48:49], s[0:1], 40
    s_load_dwordx2 s[50:51], s[0:1], 64
    s_load_dwordx2 s[52:53], s[0:1], 72
    s_load_dwordx2 s[54:55], s[0:1], 80
    s_load_dwordx2 s[56:57], s[0:1], 88
    s_load_dwordx2 s[58:59], s[0:1], 96
    s_mov_b32 s30, 400000
    s_mov_b32 s11, 0x00020000
    s_cmp_eq_u32 s17, 0
    s_cselect_b32 s18, 10, 9
    s_lshl_b32 s36, s15, 15
    s_lshl_b32 s23, s17, 11
    s_add_u32 s23, s23, 80805888
    v_lshlrev_b32 v112, 4, v0
    v_lshrrev_b32 v8, 2, v0
    v_and_b32 v9, 3, v0
    v_lshlrev_b32 v10, 4, v9
    v_lshl_add_u32 v100, v8, 13, v10
    v_lshl_add_u32 v101, v8, 10, v10
    v_mul_u32_u24 v102, 2752, v8
    v_add_u32 v102, v102, v10
    v_lshrrev_b32 v11, 5, v0
    v_bfe_u32 v12, v0, 4, 1
    v_bfe_u32 v13, v0, 2, 2
    v_lshlrev_b32 v14, 3, v9
    v_lshl_add_u32 v14, v12, 5, v14
    v_lshl_add_u32 v14, v13, 6, v14
    v_add_u32 v14, s36, v14
    v_lshl_add_u32 v103, v11, 9, v14
    v_lshl_add_u32 v104, v11, 8, v14
    s_lshl_b32 s38, s14, 8
    s_lshl_b32 s3, s15, 6
    s_add_u32 s38, s38, s3
    s_waitcnt lgkmcnt(0)
    s_mov_b32 s64, s40
    s_mov_b32 s65, s41
    s_mov_b32 s66, 0x200000
    s_mov_b32 s67, 0x00020000
    s_mov_b32 s68, s58
    s_mov_b32 s69, s59
    s_mov_b32 s70, 0x200000
    s_mov_b32 s71, 0x00020000

    s_cmp_lt_u32 s17, 5
    s_cbranch_scc1 WR_116

    s_sub_u32 s19, s17, 5
    s_lshl_b32 s19, s19, 5
    s_add_u32 s19, s19, s14
    v_lshrrev_b32 v2, 1, v0
    s_lshl_b32 s3, s15, 7
    v_add_u32 v2, s3, v2
    v_lshlrev_b32 v3, 1, v2
    v_mul_u32_u24 v2, 6144, v2
    v_and_b32 v4, 1, v0
    v_lshl_add_u32 v2, v4, 4, v2
    s_lshl_b32 s29, s19, 5
    s_lshl_b32 s28, s19, 6
    s_add_u32 s28, s28, 2048
    v_add_u32 v5, s28, v2
    v_add_u32 v2, s29, v2
    s_lshl_b32 s20, s19, 15
    s_lshl_b32 s3, s15, 13
    s_add_u32 s20, s20, s3
    s_add_u32 s21, s20, 4096

    s_mov_b32 s8, s54
    s_mov_b32 s9, s55
    s_mov_b32 s10, 1024
    buffer_load_ushort v16, v3, s[8:11], 0 offen offset:0
    buffer_load_ushort v17, v3, s[8:11], 0 offen offset:64
    buffer_load_ushort v18, v3, s[8:11], 0 offen offset:128
    buffer_load_ushort v19, v3, s[8:11], 0 offen offset:192
    s_mov_b32 s8, s56
    s_mov_b32 s9, s57
    s_mov_b32 s10, 3145728
    s_mov_b32 s3, 0
    buffer_load_dwordx4 v[20:23], v2, s[8:11], s3 offen
    s_mov_b32 s3, 196608
    buffer_load_dwordx4 v[24:27], v2, s[8:11], s3 offen
    s_mov_b32 s3, 393216
    buffer_load_dwordx4 v[28:31], v2, s[8:11], s3 offen
    s_mov_b32 s3, 589824
    buffer_load_dwordx4 v[32:35], v2, s[8:11], s3 offen
    buffer_load_dwordx4 v[128:131], v112, s[64:67], s20 offen offset:0
    buffer_load_dwordx4 v[132:135], v112, s[64:67], s20 offen offset:1024
    buffer_load_dwordx4 v[136:139], v112, s[64:67], s20 offen offset:2048
    buffer_load_dwordx4 v[140:143], v112, s[64:67], s20 offen offset:3072
    buffer_load_dwordx4 v[144:147], v112, s[64:67], s21 offen offset:0
    buffer_load_dwordx4 v[148:151], v112, s[64:67], s21 offen offset:1024
    buffer_load_dwordx4 v[152:155], v112, s[64:67], s21 offen offset:2048
    buffer_load_dwordx4 v[156:159], v112, s[64:67], s21 offen offset:3072
    s_mov_b32 s3, 0
    buffer_load_dwordx4 v[160:163], v5, s[8:11], s3 offen offset:0
    s_mov_b32 s3, 196608
    buffer_load_dwordx4 v[164:167], v5, s[8:11], s3 offen offset:0
    s_mov_b32 s3, 393216
    buffer_load_dwordx4 v[168:171], v5, s[8:11], s3 offen offset:0
    s_mov_b32 s3, 589824
    buffer_load_dwordx4 v[172:175], v5, s[8:11], s3 offen offset:0
    s_mov_b32 s3, 0
    buffer_load_dwordx4 v[176:179], v5, s[8:11], s3 offen offset:32
    s_mov_b32 s3, 196608
    buffer_load_dwordx4 v[180:183], v5, s[8:11], s3 offen offset:32
    s_mov_b32 s3, 393216
    buffer_load_dwordx4 v[184:187], v5, s[8:11], s3 offen offset:32
    s_mov_b32 s3, 589824
    buffer_load_dwordx4 v[188:191], v5, s[8:11], s3 offen offset:32
    s_waitcnt vmcnt(20)
    v_lshlrev_b32 v16, 16, v16
    v_mul_f32 v48, 0xbfb8aa3b, v16
    v_exp_f32 v48, v48
s_nop 0
    v_add_f32 v48, 1.0, v48
    v_rcp_f32 v48, v48
s_nop 0
    v_mul_f32 v16, v16, v48
    v_cvt_pk_bf16_f32 v16, v16, v16
    v_lshlrev_b32 v16, 16, v16
    v_lshlrev_b32 v17, 16, v17
    v_mul_f32 v48, 0xbfb8aa3b, v17
    v_exp_f32 v48, v48
s_nop 0
    v_add_f32 v48, 1.0, v48
    v_rcp_f32 v48, v48
s_nop 0
    v_mul_f32 v17, v17, v48
    v_cvt_pk_bf16_f32 v17, v17, v17
    v_lshlrev_b32 v17, 16, v17
    v_lshlrev_b32 v18, 16, v18
    v_mul_f32 v48, 0xbfb8aa3b, v18
    v_exp_f32 v48, v48
s_nop 0
    v_add_f32 v48, 1.0, v48
    v_rcp_f32 v48, v48
s_nop 0
    v_mul_f32 v18, v18, v48
    v_cvt_pk_bf16_f32 v18, v18, v18
    v_lshlrev_b32 v18, 16, v18
    v_lshlrev_b32 v19, 16, v19
    v_mul_f32 v48, 0xbfb8aa3b, v19
    v_exp_f32 v48, v48
s_nop 0
    v_add_f32 v48, 1.0, v48
    v_rcp_f32 v48, v48
s_nop 0
    v_mul_f32 v19, v19, v48
    v_cvt_pk_bf16_f32 v19, v19, v19
    v_lshlrev_b32 v19, 16, v19
    v_lshrrev_b32 v6, 4, v0
    v_lshlrev_b32 v6, 6, v6
    v_lshl_add_u32 v6, v4, 5, v6
    s_lshl_b32 s3, s15, 8
    s_add_u32 s3, s3, 131072
    v_add_u32 v6, s3, v6
    s_waitcnt vmcnt(19)
    v_and_b32 v49, 0xffff0000, v20
    v_lshlrev_b32 v48, 16, v20
    v_and_b32 v51, 0xffff0000, v21
    v_lshlrev_b32 v50, 16, v21
    v_and_b32 v53, 0xffff0000, v22
    v_lshlrev_b32 v52, 16, v22
    v_and_b32 v55, 0xffff0000, v23
    v_lshlrev_b32 v54, 16, v23
    v_mul_f32 v56, v16, v48
    v_mul_f32 v57, v16, v49
    v_mul_f32 v58, v16, v50
    v_mul_f32 v59, v16, v51
    v_mul_f32 v60, v16, v52
    v_mul_f32 v61, v16, v53
    v_mul_f32 v62, v16, v54
    v_mul_f32 v63, v16, v55
    s_waitcnt vmcnt(18)
    v_and_b32 v49, 0xffff0000, v24
    v_lshlrev_b32 v48, 16, v24
    v_and_b32 v51, 0xffff0000, v25
    v_lshlrev_b32 v50, 16, v25
    v_and_b32 v53, 0xffff0000, v26
    v_lshlrev_b32 v52, 16, v26
    v_and_b32 v55, 0xffff0000, v27
    v_lshlrev_b32 v54, 16, v27
    v_fmac_f32 v56, v17, v48
    v_fmac_f32 v57, v17, v49
    v_fmac_f32 v58, v17, v50
    v_fmac_f32 v59, v17, v51
    v_fmac_f32 v60, v17, v52
    v_fmac_f32 v61, v17, v53
    v_fmac_f32 v62, v17, v54
    v_fmac_f32 v63, v17, v55
    s_waitcnt vmcnt(17)
    v_and_b32 v49, 0xffff0000, v28
    v_lshlrev_b32 v48, 16, v28
    v_and_b32 v51, 0xffff0000, v29
    v_lshlrev_b32 v50, 16, v29
    v_and_b32 v53, 0xffff0000, v30
    v_lshlrev_b32 v52, 16, v30
    v_and_b32 v55, 0xffff0000, v31
    v_lshlrev_b32 v54, 16, v31
    v_fmac_f32 v56, v18, v48
    v_fmac_f32 v57, v18, v49
    v_fmac_f32 v58, v18, v50
    v_fmac_f32 v59, v18, v51
    v_fmac_f32 v60, v18, v52
    v_fmac_f32 v61, v18, v53
    v_fmac_f32 v62, v18, v54
    v_fmac_f32 v63, v18, v55
    s_waitcnt vmcnt(16)
    v_and_b32 v49, 0xffff0000, v32
    v_lshlrev_b32 v48, 16, v32
    v_and_b32 v51, 0xffff0000, v33
    v_lshlrev_b32 v50, 16, v33
    v_and_b32 v53, 0xffff0000, v34
    v_lshlrev_b32 v52, 16, v34
    v_and_b32 v55, 0xffff0000, v35
    v_lshlrev_b32 v54, 16, v35
    v_fmac_f32 v56, v19, v48
    v_fmac_f32 v57, v19, v49
    v_fmac_f32 v58, v19, v50
    v_fmac_f32 v59, v19, v51
    v_fmac_f32 v60, v19, v52
    v_fmac_f32 v61, v19, v53
    v_fmac_f32 v62, v19, v54
    v_fmac_f32 v63, v19, v55
    v_add_f32 v56, v56, v56 quad_perm:[2,3,0,1] row_mask:0xf bank_mask:0xf
    v_add_f32 v57, v57, v57 quad_perm:[2,3,0,1] row_mask:0xf bank_mask:0xf
    v_add_f32 v58, v58, v58 quad_perm:[2,3,0,1] row_mask:0xf bank_mask:0xf
    v_add_f32 v59, v59, v59 quad_perm:[2,3,0,1] row_mask:0xf bank_mask:0xf
    v_add_f32 v60, v60, v60 quad_perm:[2,3,0,1] row_mask:0xf bank_mask:0xf
    v_add_f32 v61, v61, v61 quad_perm:[2,3,0,1] row_mask:0xf bank_mask:0xf
    v_add_f32 v62, v62, v62 quad_perm:[2,3,0,1] row_mask:0xf bank_mask:0xf
    v_add_f32 v63, v63, v63 quad_perm:[2,3,0,1] row_mask:0xf bank_mask:0xf
    v_add_f32 v56, v56, v56 row_ror:4 row_mask:0xf bank_mask:0xf
    v_add_f32 v57, v57, v57 row_ror:4 row_mask:0xf bank_mask:0xf
    v_add_f32 v58, v58, v58 row_ror:4 row_mask:0xf bank_mask:0xf
    v_add_f32 v59, v59, v59 row_ror:4 row_mask:0xf bank_mask:0xf
    v_add_f32 v60, v60, v60 row_ror:4 row_mask:0xf bank_mask:0xf
    v_add_f32 v61, v61, v61 row_ror:4 row_mask:0xf bank_mask:0xf
    v_add_f32 v62, v62, v62 row_ror:4 row_mask:0xf bank_mask:0xf
    v_add_f32 v63, v63, v63 row_ror:4 row_mask:0xf bank_mask:0xf
    v_add_f32 v56, v56, v56 row_ror:8 row_mask:0xf bank_mask:0xf
    v_add_f32 v57, v57, v57 row_ror:8 row_mask:0xf bank_mask:0xf
    v_add_f32 v58, v58, v58 row_ror:8 row_mask:0xf bank_mask:0xf
    v_add_f32 v59, v59, v59 row_ror:8 row_mask:0xf bank_mask:0xf
    v_add_f32 v60, v60, v60 row_ror:8 row_mask:0xf bank_mask:0xf
    v_add_f32 v61, v61, v61 row_ror:8 row_mask:0xf bank_mask:0xf
    v_add_f32 v62, v62, v62 row_ror:8 row_mask:0xf bank_mask:0xf
    v_add_f32 v63, v63, v63 row_ror:8 row_mask:0xf bank_mask:0xf
    ds_write_b128 v6, v[56:59] offset:0
    ds_write_b128 v6, v[60:63] offset:16
    s_waitcnt lgkmcnt(0)
    s_barrier
    s_cmp_lg_u32 s15, 0
    s_cbranch_scc1 WA_117
    v_and_b32 v20, 15, v0
    v_lshlrev_b32 v21, 2, v20
    v_add_u32 v21, 131072, v21
    ds_read_b32 v24, v21 offset:0
    ds_read_b32 v25, v21 offset:64
    ds_read_b32 v26, v21 offset:128
    ds_read_b32 v27, v21 offset:192
    ds_read_b32 v28, v21 offset:256
    ds_read_b32 v29, v21 offset:320
    ds_read_b32 v30, v21 offset:384
    ds_read_b32 v31, v21 offset:448
    ds_read_b32 v32, v21 offset:512
    ds_read_b32 v33, v21 offset:576
    ds_read_b32 v34, v21 offset:640
    ds_read_b32 v35, v21 offset:704
    ds_read_b32 v36, v21 offset:768
    ds_read_b32 v37, v21 offset:832
    ds_read_b32 v38, v21 offset:896
    ds_read_b32 v39, v21 offset:960
    v_lshlrev_b32 v20, 1, v20
    s_add_u32 s29, s29, 80740352
    s_waitcnt lgkmcnt(0)
    v_add_f32 v24, v24, v32
    v_add_f32 v25, v25, v33
    v_add_f32 v26, v26, v34
    v_add_f32 v27, v27, v35
    v_add_f32 v28, v28, v36
    v_add_f32 v29, v29, v37
    v_add_f32 v30, v30, v38
    v_add_f32 v31, v31, v39
    v_add_f32 v24, v24, v28
    v_add_f32 v25, v25, v29
    v_add_f32 v26, v26, v30
    v_add_f32 v27, v27, v31
    v_add_f32 v24, v24, v26
    v_add_f32 v25, v25, v27
    v_add_f32 v24, v24, v25
    v_cvt_pk_bf16_f32 v24, v24, v24
    buffer_store_short v24, v20, s[4:7], s29 offen sc1
    s_cmp_ge_u32 s19, 7
    s_cbranch_scc1 WA_117
    v_mov_b32 v24, 0
    v_mov_b32 v25, 0
    v_mov_b32 v26, 0
    v_mov_b32 v27, 0
    s_lshl_b32 s3, s19, 11
    s_add_u32 s3, s3, 80805888
    buffer_store_dwordx4 v[24:27], v112, s[4:7], s3 offen sc1
    buffer_store_dwordx4 v[24:27], v112, s[4:7], s3 offen offset:1024 sc1
WA_117:
    s_waitcnt vmcnt(8)
    v_and_b32 v193, 0xffff0000, v128
    v_lshlrev_b32 v192, 16, v128
    v_and_b32 v195, 0xffff0000, v129
    v_lshlrev_b32 v194, 16, v129
    v_and_b32 v197, 0xffff0000, v130
    v_lshlrev_b32 v196, 16, v130
    v_and_b32 v199, 0xffff0000, v131
    v_lshlrev_b32 v198, 16, v131
    v_add_f32 v64, v192, v193
    v_add_f32 v64, v64, v194
    v_add_f32 v64, v64, v195
    v_add_f32 v64, v64, v196
    v_add_f32 v64, v64, v197
    v_add_f32 v64, v64, v198
    v_add_f32 v64, v64, v199
    v_and_b32 v201, 0xffff0000, v132
    v_lshlrev_b32 v200, 16, v132
    v_and_b32 v203, 0xffff0000, v133
    v_lshlrev_b32 v202, 16, v133
    v_and_b32 v205, 0xffff0000, v134
    v_lshlrev_b32 v204, 16, v134
    v_and_b32 v207, 0xffff0000, v135
    v_lshlrev_b32 v206, 16, v135
    v_add_f32 v65, v200, v201
    v_add_f32 v65, v65, v202
    v_add_f32 v65, v65, v203
    v_add_f32 v65, v65, v204
    v_add_f32 v65, v65, v205
    v_add_f32 v65, v65, v206
    v_add_f32 v65, v65, v207
    v_and_b32 v209, 0xffff0000, v136
    v_lshlrev_b32 v208, 16, v136
    v_and_b32 v211, 0xffff0000, v137
    v_lshlrev_b32 v210, 16, v137
    v_and_b32 v213, 0xffff0000, v138
    v_lshlrev_b32 v212, 16, v138
    v_and_b32 v215, 0xffff0000, v139
    v_lshlrev_b32 v214, 16, v139
    v_add_f32 v66, v208, v209
    v_add_f32 v66, v66, v210
    v_add_f32 v66, v66, v211
    v_add_f32 v66, v66, v212
    v_add_f32 v66, v66, v213
    v_add_f32 v66, v66, v214
    v_add_f32 v66, v66, v215
    v_and_b32 v217, 0xffff0000, v140
    v_lshlrev_b32 v216, 16, v140
    v_and_b32 v219, 0xffff0000, v141
    v_lshlrev_b32 v218, 16, v141
    v_and_b32 v221, 0xffff0000, v142
    v_lshlrev_b32 v220, 16, v142
    v_and_b32 v223, 0xffff0000, v143
    v_lshlrev_b32 v222, 16, v143
    v_add_f32 v67, v216, v217
    v_add_f32 v67, v67, v218
    v_add_f32 v67, v67, v219
    v_add_f32 v67, v67, v220
    v_add_f32 v67, v67, v221
    v_add_f32 v67, v67, v222
    v_add_f32 v67, v67, v223
    v_and_b32 v225, 0xffff0000, v144
    v_lshlrev_b32 v224, 16, v144
    v_and_b32 v227, 0xffff0000, v145
    v_lshlrev_b32 v226, 16, v145
    v_and_b32 v229, 0xffff0000, v146
    v_lshlrev_b32 v228, 16, v146
    v_and_b32 v231, 0xffff0000, v147
    v_lshlrev_b32 v230, 16, v147
    v_add_f32 v68, v224, v225
    v_add_f32 v68, v68, v226
    v_add_f32 v68, v68, v227
    v_add_f32 v68, v68, v228
    v_add_f32 v68, v68, v229
    v_add_f32 v68, v68, v230
    v_add_f32 v68, v68, v231
    v_and_b32 v233, 0xffff0000, v148
    v_lshlrev_b32 v232, 16, v148
    v_and_b32 v235, 0xffff0000, v149
    v_lshlrev_b32 v234, 16, v149
    v_and_b32 v237, 0xffff0000, v150
    v_lshlrev_b32 v236, 16, v150
    v_and_b32 v239, 0xffff0000, v151
    v_lshlrev_b32 v238, 16, v151
    v_add_f32 v69, v232, v233
    v_add_f32 v69, v69, v234
    v_add_f32 v69, v69, v235
    v_add_f32 v69, v69, v236
    v_add_f32 v69, v69, v237
    v_add_f32 v69, v69, v238
    v_add_f32 v69, v69, v239
    v_and_b32 v241, 0xffff0000, v152
    v_lshlrev_b32 v240, 16, v152
    v_and_b32 v243, 0xffff0000, v153
    v_lshlrev_b32 v242, 16, v153
    v_and_b32 v245, 0xffff0000, v154
    v_lshlrev_b32 v244, 16, v154
    v_and_b32 v247, 0xffff0000, v155
    v_lshlrev_b32 v246, 16, v155
    v_add_f32 v70, v240, v241
    v_add_f32 v70, v70, v242
    v_add_f32 v70, v70, v243
    v_add_f32 v70, v70, v244
    v_add_f32 v70, v70, v245
    v_add_f32 v70, v70, v246
    v_add_f32 v70, v70, v247
    v_and_b32 v249, 0xffff0000, v156
    v_lshlrev_b32 v248, 16, v156
    v_and_b32 v251, 0xffff0000, v157
    v_lshlrev_b32 v250, 16, v157
    v_and_b32 v253, 0xffff0000, v158
    v_lshlrev_b32 v252, 16, v158
    v_and_b32 v255, 0xffff0000, v159
    v_lshlrev_b32 v254, 16, v159
    v_add_f32 v71, v248, v249
    v_add_f32 v71, v71, v250
    v_add_f32 v71, v71, v251
    v_add_f32 v71, v71, v252
    v_add_f32 v71, v71, v253
    v_add_f32 v71, v71, v254
    v_add_f32 v71, v71, v255
    v_add_f32 v64, v64, v64 quad_perm:[1,0,3,2] row_mask:0xf bank_mask:0xf
    v_add_f32 v65, v65, v65 quad_perm:[1,0,3,2] row_mask:0xf bank_mask:0xf
    v_add_f32 v66, v66, v66 quad_perm:[1,0,3,2] row_mask:0xf bank_mask:0xf
    v_add_f32 v67, v67, v67 quad_perm:[1,0,3,2] row_mask:0xf bank_mask:0xf
    v_add_f32 v68, v68, v68 quad_perm:[1,0,3,2] row_mask:0xf bank_mask:0xf
    v_add_f32 v69, v69, v69 quad_perm:[1,0,3,2] row_mask:0xf bank_mask:0xf
    v_add_f32 v70, v70, v70 quad_perm:[1,0,3,2] row_mask:0xf bank_mask:0xf
    v_add_f32 v71, v71, v71 quad_perm:[1,0,3,2] row_mask:0xf bank_mask:0xf
    v_add_f32 v64, v64, v64 quad_perm:[2,3,0,1] row_mask:0xf bank_mask:0xf
    v_add_f32 v65, v65, v65 quad_perm:[2,3,0,1] row_mask:0xf bank_mask:0xf
    v_add_f32 v66, v66, v66 quad_perm:[2,3,0,1] row_mask:0xf bank_mask:0xf
    v_add_f32 v67, v67, v67 quad_perm:[2,3,0,1] row_mask:0xf bank_mask:0xf
    v_add_f32 v68, v68, v68 quad_perm:[2,3,0,1] row_mask:0xf bank_mask:0xf
    v_add_f32 v69, v69, v69 quad_perm:[2,3,0,1] row_mask:0xf bank_mask:0xf
    v_add_f32 v70, v70, v70 quad_perm:[2,3,0,1] row_mask:0xf bank_mask:0xf
    v_add_f32 v71, v71, v71 quad_perm:[2,3,0,1] row_mask:0xf bank_mask:0xf
    v_add_f32 v64, v64, v64 row_ror:4 row_mask:0xf bank_mask:0xf
    v_add_f32 v65, v65, v65 row_ror:4 row_mask:0xf bank_mask:0xf
    v_add_f32 v66, v66, v66 row_ror:4 row_mask:0xf bank_mask:0xf
    v_add_f32 v67, v67, v67 row_ror:4 row_mask:0xf bank_mask:0xf
    v_add_f32 v68, v68, v68 row_ror:4 row_mask:0xf bank_mask:0xf
    v_add_f32 v69, v69, v69 row_ror:4 row_mask:0xf bank_mask:0xf
    v_add_f32 v70, v70, v70 row_ror:4 row_mask:0xf bank_mask:0xf
    v_add_f32 v71, v71, v71 row_ror:4 row_mask:0xf bank_mask:0xf
    v_add_f32 v64, v64, v64 row_ror:8 row_mask:0xf bank_mask:0xf
    v_add_f32 v65, v65, v65 row_ror:8 row_mask:0xf bank_mask:0xf
    v_add_f32 v66, v66, v66 row_ror:8 row_mask:0xf bank_mask:0xf
    v_add_f32 v67, v67, v67 row_ror:8 row_mask:0xf bank_mask:0xf
    v_add_f32 v68, v68, v68 row_ror:8 row_mask:0xf bank_mask:0xf
    v_add_f32 v69, v69, v69 row_ror:8 row_mask:0xf bank_mask:0xf
    v_add_f32 v70, v70, v70 row_ror:8 row_mask:0xf bank_mask:0xf
    v_add_f32 v71, v71, v71 row_ror:8 row_mask:0xf bank_mask:0xf
    v_mov_b32 v80, v64
s_nop 1
    v_permlane16_swap_b32 v64, v80
    v_add_f32 v64, v64, v80
    v_mov_b32 v81, v65
s_nop 1
    v_permlane16_swap_b32 v65, v81
    v_add_f32 v65, v65, v81
    v_mov_b32 v82, v66
s_nop 1
    v_permlane16_swap_b32 v66, v82
    v_add_f32 v66, v66, v82
    v_mov_b32 v83, v67
s_nop 1
    v_permlane16_swap_b32 v67, v83
    v_add_f32 v67, v67, v83
    v_mov_b32 v84, v68
s_nop 1
    v_permlane16_swap_b32 v68, v84
    v_add_f32 v68, v68, v84
    v_mov_b32 v85, v69
s_nop 1
    v_permlane16_swap_b32 v69, v85
    v_add_f32 v69, v69, v85
    v_mov_b32 v86, v70
s_nop 1
    v_permlane16_swap_b32 v70, v86
    v_add_f32 v70, v70, v86
    v_mov_b32 v87, v71
s_nop 1
    v_permlane16_swap_b32 v71, v87
    v_add_f32 v71, v71, v87
    v_mov_b32 v80, v64
s_nop 1
    v_permlane32_swap_b32 v64, v80
    v_add_f32 v64, v64, v80
    v_mov_b32 v81, v65
s_nop 1
    v_permlane32_swap_b32 v65, v81
    v_add_f32 v65, v65, v81
    v_mov_b32 v82, v66
s_nop 1
    v_permlane32_swap_b32 v66, v82
    v_add_f32 v66, v66, v82
    v_mov_b32 v83, v67
s_nop 1
    v_permlane32_swap_b32 v67, v83
    v_add_f32 v67, v67, v83
    v_mov_b32 v84, v68
s_nop 1
    v_permlane32_swap_b32 v68, v84
    v_add_f32 v68, v68, v84
    v_mov_b32 v85, v69
s_nop 1
    v_permlane32_swap_b32 v69, v85
    v_add_f32 v69, v69, v85
    v_mov_b32 v86, v70
s_nop 1
    v_permlane32_swap_b32 v70, v86
    v_add_f32 v70, v70, v86
    v_mov_b32 v87, v71
s_nop 1
    v_permlane32_swap_b32 v71, v87
    v_add_f32 v71, v71, v87
    s_mov_b32 s3, 0xbb000000
    v_fma_f32 v192, v64, s3, v192
    v_fma_f32 v193, v64, s3, v193
    v_fma_f32 v194, v64, s3, v194
    v_fma_f32 v195, v64, s3, v195
    v_fma_f32 v196, v64, s3, v196
    v_fma_f32 v197, v64, s3, v197
    v_fma_f32 v198, v64, s3, v198
    v_fma_f32 v199, v64, s3, v199
    v_mul_f32 v72, v192, v192
    v_fmac_f32 v72, v193, v193
    v_fmac_f32 v72, v194, v194
    v_fmac_f32 v72, v195, v195
    v_fmac_f32 v72, v196, v196
    v_fmac_f32 v72, v197, v197
    v_fmac_f32 v72, v198, v198
    v_fmac_f32 v72, v199, v199
    v_fma_f32 v200, v65, s3, v200
    v_fma_f32 v201, v65, s3, v201
    v_fma_f32 v202, v65, s3, v202
    v_fma_f32 v203, v65, s3, v203
    v_fma_f32 v204, v65, s3, v204
    v_fma_f32 v205, v65, s3, v205
    v_fma_f32 v206, v65, s3, v206
    v_fma_f32 v207, v65, s3, v207
    v_mul_f32 v73, v200, v200
    v_fmac_f32 v73, v201, v201
    v_fmac_f32 v73, v202, v202
    v_fmac_f32 v73, v203, v203
    v_fmac_f32 v73, v204, v204
    v_fmac_f32 v73, v205, v205
    v_fmac_f32 v73, v206, v206
    v_fmac_f32 v73, v207, v207
    v_fma_f32 v208, v66, s3, v208
    v_fma_f32 v209, v66, s3, v209
    v_fma_f32 v210, v66, s3, v210
    v_fma_f32 v211, v66, s3, v211
    v_fma_f32 v212, v66, s3, v212
    v_fma_f32 v213, v66, s3, v213
    v_fma_f32 v214, v66, s3, v214
    v_fma_f32 v215, v66, s3, v215
    v_mul_f32 v74, v208, v208
    v_fmac_f32 v74, v209, v209
    v_fmac_f32 v74, v210, v210
    v_fmac_f32 v74, v211, v211
    v_fmac_f32 v74, v212, v212
    v_fmac_f32 v74, v213, v213
    v_fmac_f32 v74, v214, v214
    v_fmac_f32 v74, v215, v215
    v_fma_f32 v216, v67, s3, v216
    v_fma_f32 v217, v67, s3, v217
    v_fma_f32 v218, v67, s3, v218
    v_fma_f32 v219, v67, s3, v219
    v_fma_f32 v220, v67, s3, v220
    v_fma_f32 v221, v67, s3, v221
    v_fma_f32 v222, v67, s3, v222
    v_fma_f32 v223, v67, s3, v223
    v_mul_f32 v75, v216, v216
    v_fmac_f32 v75, v217, v217
    v_fmac_f32 v75, v218, v218
    v_fmac_f32 v75, v219, v219
    v_fmac_f32 v75, v220, v220
    v_fmac_f32 v75, v221, v221
    v_fmac_f32 v75, v222, v222
    v_fmac_f32 v75, v223, v223
    v_fma_f32 v224, v68, s3, v224
    v_fma_f32 v225, v68, s3, v225
    v_fma_f32 v226, v68, s3, v226
    v_fma_f32 v227, v68, s3, v227
    v_fma_f32 v228, v68, s3, v228
    v_fma_f32 v229, v68, s3, v229
    v_fma_f32 v230, v68, s3, v230
    v_fma_f32 v231, v68, s3, v231
    v_mul_f32 v76, v224, v224
    v_fmac_f32 v76, v225, v225
    v_fmac_f32 v76, v226, v226
    v_fmac_f32 v76, v227, v227
    v_fmac_f32 v76, v228, v228
    v_fmac_f32 v76, v229, v229
    v_fmac_f32 v76, v230, v230
    v_fmac_f32 v76, v231, v231
    v_fma_f32 v232, v69, s3, v232
    v_fma_f32 v233, v69, s3, v233
    v_fma_f32 v234, v69, s3, v234
    v_fma_f32 v235, v69, s3, v235
    v_fma_f32 v236, v69, s3, v236
    v_fma_f32 v237, v69, s3, v237
    v_fma_f32 v238, v69, s3, v238
    v_fma_f32 v239, v69, s3, v239
    v_mul_f32 v77, v232, v232
    v_fmac_f32 v77, v233, v233
    v_fmac_f32 v77, v234, v234
    v_fmac_f32 v77, v235, v235
    v_fmac_f32 v77, v236, v236
    v_fmac_f32 v77, v237, v237
    v_fmac_f32 v77, v238, v238
    v_fmac_f32 v77, v239, v239
    v_fma_f32 v240, v70, s3, v240
    v_fma_f32 v241, v70, s3, v241
    v_fma_f32 v242, v70, s3, v242
    v_fma_f32 v243, v70, s3, v243
    v_fma_f32 v244, v70, s3, v244
    v_fma_f32 v245, v70, s3, v245
    v_fma_f32 v246, v70, s3, v246
    v_fma_f32 v247, v70, s3, v247
    v_mul_f32 v78, v240, v240
    v_fmac_f32 v78, v241, v241
    v_fmac_f32 v78, v242, v242
    v_fmac_f32 v78, v243, v243
    v_fmac_f32 v78, v244, v244
    v_fmac_f32 v78, v245, v245
    v_fmac_f32 v78, v246, v246
    v_fmac_f32 v78, v247, v247
    v_fma_f32 v248, v71, s3, v248
    v_fma_f32 v249, v71, s3, v249
    v_fma_f32 v250, v71, s3, v250
    v_fma_f32 v251, v71, s3, v251
    v_fma_f32 v252, v71, s3, v252
    v_fma_f32 v253, v71, s3, v253
    v_fma_f32 v254, v71, s3, v254
    v_fma_f32 v255, v71, s3, v255
    v_mul_f32 v79, v248, v248
    v_fmac_f32 v79, v249, v249
    v_fmac_f32 v79, v250, v250
    v_fmac_f32 v79, v251, v251
    v_fmac_f32 v79, v252, v252
    v_fmac_f32 v79, v253, v253
    v_fmac_f32 v79, v254, v254
    v_fmac_f32 v79, v255, v255
    s_cmp_lg_u32 s15, 0
    s_cbranch_scc1 WA_118
    s_waitcnt vmcnt(0)
    v_mov_b32 v21, 64
    v_mov_b32 v22, 1
    s_mov_b64 exec, 1
    global_atomic_add v21, v22, s[12:13] sc1
    s_mov_b64 exec, -1
WA_118:
    v_add_f32 v72, v72, v72 quad_perm:[1,0,3,2] row_mask:0xf bank_mask:0xf
    v_add_f32 v73, v73, v73 quad_perm:[1,0,3,2] row_mask:0xf bank_mask:0xf
    v_add_f32 v74, v74, v74 quad_perm:[1,0,3,2] row_mask:0xf bank_mask:0xf
    v_add_f32 v75, v75, v75 quad_perm:[1,0,3,2] row_mask:0xf bank_mask:0xf
    v_add_f32 v76, v76, v76 quad_perm:[1,0,3,2] row_mask:0xf bank_mask:0xf
    v_add_f32 v77, v77, v77 quad_perm:[1,0,3,2] row_mask:0xf bank_mask:0xf
    v_add_f32 v78, v78, v78 quad_perm:[1,0,3,2] row_mask:0xf bank_mask:0xf
    v_add_f32 v79, v79, v79 quad_perm:[1,0,3,2] row_mask:0xf bank_mask:0xf
    v_add_f32 v72, v72, v72 quad_perm:[2,3,0,1] row_mask:0xf bank_mask:0xf
    v_add_f32 v73, v73, v73 quad_perm:[2,3,0,1] row_mask:0xf bank_mask:0xf
    v_add_f32 v74, v74, v74 quad_perm:[2,3,0,1] row_mask:0xf bank_mask:0xf
    v_add_f32 v75, v75, v75 quad_perm:[2,3,0,1] row_mask:0xf bank_mask:0xf
    v_add_f32 v76, v76, v76 quad_perm:[2,3,0,1] row_mask:0xf bank_mask:0xf
    v_add_f32 v77, v77, v77 quad_perm:[2,3,0,1] row_mask:0xf bank_mask:0xf
    v_add_f32 v78, v78, v78 quad_perm:[2,3,0,1] row_mask:0xf bank_mask:0xf
    v_add_f32 v79, v79, v79 quad_perm:[2,3,0,1] row_mask:0xf bank_mask:0xf
    v_add_f32 v72, v72, v72 row_ror:4 row_mask:0xf bank_mask:0xf
    v_add_f32 v73, v73, v73 row_ror:4 row_mask:0xf bank_mask:0xf
    v_add_f32 v74, v74, v74 row_ror:4 row_mask:0xf bank_mask:0xf
    v_add_f32 v75, v75, v75 row_ror:4 row_mask:0xf bank_mask:0xf
    v_add_f32 v76, v76, v76 row_ror:4 row_mask:0xf bank_mask:0xf
    v_add_f32 v77, v77, v77 row_ror:4 row_mask:0xf bank_mask:0xf
    v_add_f32 v78, v78, v78 row_ror:4 row_mask:0xf bank_mask:0xf
    v_add_f32 v79, v79, v79 row_ror:4 row_mask:0xf bank_mask:0xf
    v_add_f32 v72, v72, v72 row_ror:8 row_mask:0xf bank_mask:0xf
    v_add_f32 v73, v73, v73 row_ror:8 row_mask:0xf bank_mask:0xf
    v_add_f32 v74, v74, v74 row_ror:8 row_mask:0xf bank_mask:0xf
    v_add_f32 v75, v75, v75 row_ror:8 row_mask:0xf bank_mask:0xf
    v_add_f32 v76, v76, v76 row_ror:8 row_mask:0xf bank_mask:0xf
    v_add_f32 v77, v77, v77 row_ror:8 row_mask:0xf bank_mask:0xf
    v_add_f32 v78, v78, v78 row_ror:8 row_mask:0xf bank_mask:0xf
    v_add_f32 v79, v79, v79 row_ror:8 row_mask:0xf bank_mask:0xf
    v_mov_b32 v80, v72
s_nop 1
    v_permlane16_swap_b32 v72, v80
    v_add_f32 v72, v72, v80
    v_mov_b32 v81, v73
s_nop 1
    v_permlane16_swap_b32 v73, v81
    v_add_f32 v73, v73, v81
    v_mov_b32 v82, v74
s_nop 1
    v_permlane16_swap_b32 v74, v82
    v_add_f32 v74, v74, v82
    v_mov_b32 v83, v75
s_nop 1
    v_permlane16_swap_b32 v75, v83
    v_add_f32 v75, v75, v83
    v_mov_b32 v84, v76
s_nop 1
    v_permlane16_swap_b32 v76, v84
    v_add_f32 v76, v76, v84
    v_mov_b32 v85, v77
s_nop 1
    v_permlane16_swap_b32 v77, v85
    v_add_f32 v77, v77, v85
    v_mov_b32 v86, v78
s_nop 1
    v_permlane16_swap_b32 v78, v86
    v_add_f32 v78, v78, v86
    v_mov_b32 v87, v79
s_nop 1
    v_permlane16_swap_b32 v79, v87
    v_add_f32 v79, v79, v87
    v_mov_b32 v80, v72
s_nop 1
    v_permlane32_swap_b32 v72, v80
    v_add_f32 v72, v72, v80
    v_mov_b32 v81, v73
s_nop 1
    v_permlane32_swap_b32 v73, v81
    v_add_f32 v73, v73, v81
    v_mov_b32 v82, v74
s_nop 1
    v_permlane32_swap_b32 v74, v82
    v_add_f32 v74, v74, v82
    v_mov_b32 v83, v75
s_nop 1
    v_permlane32_swap_b32 v75, v83
    v_add_f32 v75, v75, v83
    v_mov_b32 v84, v76
s_nop 1
    v_permlane32_swap_b32 v76, v84
    v_add_f32 v76, v76, v84
    v_mov_b32 v85, v77
s_nop 1
    v_permlane32_swap_b32 v77, v85
    v_add_f32 v77, v77, v85
    v_mov_b32 v86, v78
s_nop 1
    v_permlane32_swap_b32 v78, v86
    v_add_f32 v78, v78, v86
    v_mov_b32 v87, v79
s_nop 1
    v_permlane32_swap_b32 v79, v87
    v_add_f32 v79, v79, v87
    v_mov_b32 v80, 0x3727c5ac
    v_fma_f32 v72, v72, -s3, v80
    v_rsq_f32 v72, v72
s_nop 0
    v_mul_f32 v192, v192, v72
    v_mul_f32 v193, v193, v72
    v_mul_f32 v194, v194, v72
    v_mul_f32 v195, v195, v72
    v_mul_f32 v196, v196, v72
    v_mul_f32 v197, v197, v72
    v_mul_f32 v198, v198, v72
    v_mul_f32 v199, v199, v72
    v_fma_f32 v73, v73, -s3, v80
    v_rsq_f32 v73, v73
s_nop 0
    v_mul_f32 v200, v200, v73
    v_mul_f32 v201, v201, v73
    v_mul_f32 v202, v202, v73
    v_mul_f32 v203, v203, v73
    v_mul_f32 v204, v204, v73
    v_mul_f32 v205, v205, v73
    v_mul_f32 v206, v206, v73
    v_mul_f32 v207, v207, v73
    v_fma_f32 v74, v74, -s3, v80
    v_rsq_f32 v74, v74
s_nop 0
    v_mul_f32 v208, v208, v74
    v_mul_f32 v209, v209, v74
    v_mul_f32 v210, v210, v74
    v_mul_f32 v211, v211, v74
    v_mul_f32 v212, v212, v74
    v_mul_f32 v213, v213, v74
    v_mul_f32 v214, v214, v74
    v_mul_f32 v215, v215, v74
    v_fma_f32 v75, v75, -s3, v80
    v_rsq_f32 v75, v75
s_nop 0
    v_mul_f32 v216, v216, v75
    v_mul_f32 v217, v217, v75
    v_mul_f32 v218, v218, v75
    v_mul_f32 v219, v219, v75
    v_mul_f32 v220, v220, v75
    v_mul_f32 v221, v221, v75
    v_mul_f32 v222, v222, v75
    v_mul_f32 v223, v223, v75
    v_fma_f32 v76, v76, -s3, v80
    v_rsq_f32 v76, v76
s_nop 0
    v_mul_f32 v224, v224, v76
    v_mul_f32 v225, v225, v76
    v_mul_f32 v226, v226, v76
    v_mul_f32 v227, v227, v76
    v_mul_f32 v228, v228, v76
    v_mul_f32 v229, v229, v76
    v_mul_f32 v230, v230, v76
    v_mul_f32 v231, v231, v76
    v_fma_f32 v77, v77, -s3, v80
    v_rsq_f32 v77, v77
s_nop 0
    v_mul_f32 v232, v232, v77
    v_mul_f32 v233, v233, v77
    v_mul_f32 v234, v234, v77
    v_mul_f32 v235, v235, v77
    v_mul_f32 v236, v236, v77
    v_mul_f32 v237, v237, v77
    v_mul_f32 v238, v238, v77
    v_mul_f32 v239, v239, v77
    v_fma_f32 v78, v78, -s3, v80
    v_rsq_f32 v78, v78
s_nop 0
    v_mul_f32 v240, v240, v78
    v_mul_f32 v241, v241, v78
    v_mul_f32 v242, v242, v78
    v_mul_f32 v243, v243, v78
    v_mul_f32 v244, v244, v78
    v_mul_f32 v245, v245, v78
    v_mul_f32 v246, v246, v78
    v_mul_f32 v247, v247, v78
    v_fma_f32 v79, v79, -s3, v80
    v_rsq_f32 v79, v79
s_nop 0
    v_mul_f32 v248, v248, v79
    v_mul_f32 v249, v249, v79
    v_mul_f32 v250, v250, v79
    v_mul_f32 v251, v251, v79
    v_mul_f32 v252, v252, v79
    v_mul_f32 v253, v253, v79
    v_mul_f32 v254, v254, v79
    v_mul_f32 v255, v255, v79
    s_waitcnt vmcnt(0)
    v_and_b32 v49, 0xffff0000, v160
    v_lshlrev_b32 v48, 16, v160
    v_and_b32 v51, 0xffff0000, v161
    v_lshlrev_b32 v50, 16, v161
    v_and_b32 v53, 0xffff0000, v162
    v_lshlrev_b32 v52, 16, v162
    v_and_b32 v55, 0xffff0000, v163
    v_lshlrev_b32 v54, 16, v163
    v_mul_f32 v56, v16, v48
    v_mul_f32 v57, v16, v49
    v_mul_f32 v58, v16, v50
    v_mul_f32 v59, v16, v51
    v_mul_f32 v60, v16, v52
    v_mul_f32 v61, v16, v53
    v_mul_f32 v62, v16, v54
    v_mul_f32 v63, v16, v55
    v_and_b32 v49, 0xffff0000, v164
    v_lshlrev_b32 v48, 16, v164
    v_and_b32 v51, 0xffff0000, v165
    v_lshlrev_b32 v50, 16, v165
    v_and_b32 v53, 0xffff0000, v166
    v_lshlrev_b32 v52, 16, v166
    v_and_b32 v55, 0xffff0000, v167
    v_lshlrev_b32 v54, 16, v167
    v_fmac_f32 v56, v17, v48
    v_fmac_f32 v57, v17, v49
    v_fmac_f32 v58, v17, v50
    v_fmac_f32 v59, v17, v51
    v_fmac_f32 v60, v17, v52
    v_fmac_f32 v61, v17, v53
    v_fmac_f32 v62, v17, v54
    v_fmac_f32 v63, v17, v55
    v_and_b32 v49, 0xffff0000, v168
    v_lshlrev_b32 v48, 16, v168
    v_and_b32 v51, 0xffff0000, v169
    v_lshlrev_b32 v50, 16, v169
    v_and_b32 v53, 0xffff0000, v170
    v_lshlrev_b32 v52, 16, v170
    v_and_b32 v55, 0xffff0000, v171
    v_lshlrev_b32 v54, 16, v171
    v_fmac_f32 v56, v18, v48
    v_fmac_f32 v57, v18, v49
    v_fmac_f32 v58, v18, v50
    v_fmac_f32 v59, v18, v51
    v_fmac_f32 v60, v18, v52
    v_fmac_f32 v61, v18, v53
    v_fmac_f32 v62, v18, v54
    v_fmac_f32 v63, v18, v55
    v_and_b32 v49, 0xffff0000, v172
    v_lshlrev_b32 v48, 16, v172
    v_and_b32 v51, 0xffff0000, v173
    v_lshlrev_b32 v50, 16, v173
    v_and_b32 v53, 0xffff0000, v174
    v_lshlrev_b32 v52, 16, v174
    v_and_b32 v55, 0xffff0000, v175
    v_lshlrev_b32 v54, 16, v175
    v_fmac_f32 v56, v19, v48
    v_fmac_f32 v57, v19, v49
    v_fmac_f32 v58, v19, v50
    v_fmac_f32 v59, v19, v51
    v_fmac_f32 v60, v19, v52
    v_fmac_f32 v61, v19, v53
    v_fmac_f32 v62, v19, v54
    v_fmac_f32 v63, v19, v55
    v_add_f32 v56, v56, v56 quad_perm:[2,3,0,1] row_mask:0xf bank_mask:0xf
    v_add_f32 v57, v57, v57 quad_perm:[2,3,0,1] row_mask:0xf bank_mask:0xf
    v_add_f32 v58, v58, v58 quad_perm:[2,3,0,1] row_mask:0xf bank_mask:0xf
    v_add_f32 v59, v59, v59 quad_perm:[2,3,0,1] row_mask:0xf bank_mask:0xf
    v_add_f32 v60, v60, v60 quad_perm:[2,3,0,1] row_mask:0xf bank_mask:0xf
    v_add_f32 v61, v61, v61 quad_perm:[2,3,0,1] row_mask:0xf bank_mask:0xf
    v_add_f32 v62, v62, v62 quad_perm:[2,3,0,1] row_mask:0xf bank_mask:0xf
    v_add_f32 v63, v63, v63 quad_perm:[2,3,0,1] row_mask:0xf bank_mask:0xf
    v_add_f32 v56, v56, v56 row_ror:4 row_mask:0xf bank_mask:0xf
    v_add_f32 v57, v57, v57 row_ror:4 row_mask:0xf bank_mask:0xf
    v_add_f32 v58, v58, v58 row_ror:4 row_mask:0xf bank_mask:0xf
    v_add_f32 v59, v59, v59 row_ror:4 row_mask:0xf bank_mask:0xf
    v_add_f32 v60, v60, v60 row_ror:4 row_mask:0xf bank_mask:0xf
    v_add_f32 v61, v61, v61 row_ror:4 row_mask:0xf bank_mask:0xf
    v_add_f32 v62, v62, v62 row_ror:4 row_mask:0xf bank_mask:0xf
    v_add_f32 v63, v63, v63 row_ror:4 row_mask:0xf bank_mask:0xf
    v_add_f32 v56, v56, v56 row_ror:8 row_mask:0xf bank_mask:0xf
    v_add_f32 v57, v57, v57 row_ror:8 row_mask:0xf bank_mask:0xf
    v_add_f32 v58, v58, v58 row_ror:8 row_mask:0xf bank_mask:0xf
    v_add_f32 v59, v59, v59 row_ror:8 row_mask:0xf bank_mask:0xf
    v_add_f32 v60, v60, v60 row_ror:8 row_mask:0xf bank_mask:0xf
    v_add_f32 v61, v61, v61 row_ror:8 row_mask:0xf bank_mask:0xf
    v_add_f32 v62, v62, v62 row_ror:8 row_mask:0xf bank_mask:0xf
    v_add_f32 v63, v63, v63 row_ror:8 row_mask:0xf bank_mask:0xf
    ds_write_b128 v6, v[56:59] offset:1024
    ds_write_b128 v6, v[60:63] offset:1040
    v_and_b32 v49, 0xffff0000, v176
    v_lshlrev_b32 v48, 16, v176
    v_and_b32 v51, 0xffff0000, v177
    v_lshlrev_b32 v50, 16, v177
    v_and_b32 v53, 0xffff0000, v178
    v_lshlrev_b32 v52, 16, v178
    v_and_b32 v55, 0xffff0000, v179
    v_lshlrev_b32 v54, 16, v179
    v_mul_f32 v56, v16, v48
    v_mul_f32 v57, v16, v49
    v_mul_f32 v58, v16, v50
    v_mul_f32 v59, v16, v51
    v_mul_f32 v60, v16, v52
    v_mul_f32 v61, v16, v53
    v_mul_f32 v62, v16, v54
    v_mul_f32 v63, v16, v55
    v_and_b32 v49, 0xffff0000, v180
    v_lshlrev_b32 v48, 16, v180
    v_and_b32 v51, 0xffff0000, v181
    v_lshlrev_b32 v50, 16, v181
    v_and_b32 v53, 0xffff0000, v182
    v_lshlrev_b32 v52, 16, v182
    v_and_b32 v55, 0xffff0000, v183
    v_lshlrev_b32 v54, 16, v183
    v_fmac_f32 v56, v17, v48
    v_fmac_f32 v57, v17, v49
    v_fmac_f32 v58, v17, v50
    v_fmac_f32 v59, v17, v51
    v_fmac_f32 v60, v17, v52
    v_fmac_f32 v61, v17, v53
    v_fmac_f32 v62, v17, v54
    v_fmac_f32 v63, v17, v55
    v_and_b32 v49, 0xffff0000, v184
    v_lshlrev_b32 v48, 16, v184
    v_and_b32 v51, 0xffff0000, v185
    v_lshlrev_b32 v50, 16, v185
    v_and_b32 v53, 0xffff0000, v186
    v_lshlrev_b32 v52, 16, v186
    v_and_b32 v55, 0xffff0000, v187
    v_lshlrev_b32 v54, 16, v187
    v_fmac_f32 v56, v18, v48
    v_fmac_f32 v57, v18, v49
    v_fmac_f32 v58, v18, v50
    v_fmac_f32 v59, v18, v51
    v_fmac_f32 v60, v18, v52
    v_fmac_f32 v61, v18, v53
    v_fmac_f32 v62, v18, v54
    v_fmac_f32 v63, v18, v55
    v_and_b32 v49, 0xffff0000, v188
    v_lshlrev_b32 v48, 16, v188
    v_and_b32 v51, 0xffff0000, v189
    v_lshlrev_b32 v50, 16, v189
    v_and_b32 v53, 0xffff0000, v190
    v_lshlrev_b32 v52, 16, v190
    v_and_b32 v55, 0xffff0000, v191
    v_lshlrev_b32 v54, 16, v191
    v_fmac_f32 v56, v19, v48
    v_fmac_f32 v57, v19, v49
    v_fmac_f32 v58, v19, v50
    v_fmac_f32 v59, v19, v51
    v_fmac_f32 v60, v19, v52
    v_fmac_f32 v61, v19, v53
    v_fmac_f32 v62, v19, v54
    v_fmac_f32 v63, v19, v55
    v_add_f32 v56, v56, v56 quad_perm:[2,3,0,1] row_mask:0xf bank_mask:0xf
    v_add_f32 v57, v57, v57 quad_perm:[2,3,0,1] row_mask:0xf bank_mask:0xf
    v_add_f32 v58, v58, v58 quad_perm:[2,3,0,1] row_mask:0xf bank_mask:0xf
    v_add_f32 v59, v59, v59 quad_perm:[2,3,0,1] row_mask:0xf bank_mask:0xf
    v_add_f32 v60, v60, v60 quad_perm:[2,3,0,1] row_mask:0xf bank_mask:0xf
    v_add_f32 v61, v61, v61 quad_perm:[2,3,0,1] row_mask:0xf bank_mask:0xf
    v_add_f32 v62, v62, v62 quad_perm:[2,3,0,1] row_mask:0xf bank_mask:0xf
    v_add_f32 v63, v63, v63 quad_perm:[2,3,0,1] row_mask:0xf bank_mask:0xf
    v_add_f32 v56, v56, v56 row_ror:4 row_mask:0xf bank_mask:0xf
    v_add_f32 v57, v57, v57 row_ror:4 row_mask:0xf bank_mask:0xf
    v_add_f32 v58, v58, v58 row_ror:4 row_mask:0xf bank_mask:0xf
    v_add_f32 v59, v59, v59 row_ror:4 row_mask:0xf bank_mask:0xf
    v_add_f32 v60, v60, v60 row_ror:4 row_mask:0xf bank_mask:0xf
    v_add_f32 v61, v61, v61 row_ror:4 row_mask:0xf bank_mask:0xf
    v_add_f32 v62, v62, v62 row_ror:4 row_mask:0xf bank_mask:0xf
    v_add_f32 v63, v63, v63 row_ror:4 row_mask:0xf bank_mask:0xf
    v_add_f32 v56, v56, v56 row_ror:8 row_mask:0xf bank_mask:0xf
    v_add_f32 v57, v57, v57 row_ror:8 row_mask:0xf bank_mask:0xf
    v_add_f32 v58, v58, v58 row_ror:8 row_mask:0xf bank_mask:0xf
    v_add_f32 v59, v59, v59 row_ror:8 row_mask:0xf bank_mask:0xf
    v_add_f32 v60, v60, v60 row_ror:8 row_mask:0xf bank_mask:0xf
    v_add_f32 v61, v61, v61 row_ror:8 row_mask:0xf bank_mask:0xf
    v_add_f32 v62, v62, v62 row_ror:8 row_mask:0xf bank_mask:0xf
    v_add_f32 v63, v63, v63 row_ror:8 row_mask:0xf bank_mask:0xf
    ds_write_b128 v6, v[56:59] offset:2048
    ds_write_b128 v6, v[60:63] offset:2064
    v_mul_u32_u24 v7, 528, v0
    s_lshl_b32 s3, s15, 7
    v_add_u32 v7, s3, v7
    v_mul_u32_u24 v8, 528, v11
    v_and_b32 v15, 31, v0
    v_lshl_add_u32 v8, v15, 4, v8
    s_mul_i32 s3, s15, 8448
    v_add_u32 v8, s3, v8
    s_add_u32 s20, s20, 60817408
    s_add_u32 s21, s21, 60817408
WD_119:
    v_mov_b32 v110, 64
    global_load_dwordx2 v[108:109], v110, s[12:13] sc1
    s_sub_u32 s30, s30, 1
    s_cbranch_scc1 L_abort
    s_waitcnt vmcnt(0)
    v_cmp_gt_u32 vcc, 64, v108
    s_cbranch_vccnz WD_119
    s_mov_b32 s3, 80740352
    buffer_load_dwordx4 v[16:19], v112, s[4:7], s3 offen sc1
    buffer_load_dwordx4 v[20:23], v112, s[4:7], s3 offen offset:1024 sc1
    s_waitcnt vmcnt(0)
    v_and_b32 v25, 0xffff0000, v16
    v_lshlrev_b32 v24, 16, v16
    v_and_b32 v27, 0xffff0000, v17
    v_lshlrev_b32 v26, 16, v17
    v_and_b32 v29, 0xffff0000, v18
    v_lshlrev_b32 v28, 16, v18
    v_and_b32 v31, 0xffff0000, v19
    v_lshlrev_b32 v30, 16, v19
    v_and_b32 v33, 0xffff0000, v20
    v_lshlrev_b32 v32, 16, v20
    v_and_b32 v35, 0xffff0000, v21
    v_lshlrev_b32 v34, 16, v21
    v_and_b32 v37, 0xffff0000, v22
    v_lshlrev_b32 v36, 16, v22
    v_and_b32 v39, 0xffff0000, v23
    v_lshlrev_b32 v38, 16, v23
    v_add_f32 v32, 1.0, v32
    v_add_f32 v33, 1.0, v33
    v_add_f32 v34, 1.0, v34
    v_add_f32 v35, 1.0, v35
    v_add_f32 v36, 1.0, v36
    v_add_f32 v37, 1.0, v37
    v_add_f32 v38, 1.0, v38
    v_add_f32 v39, 1.0, v39
    v_fma_f32 v192, v192, v32, v24
    v_fma_f32 v193, v193, v33, v25
    v_fma_f32 v194, v194, v34, v26
    v_fma_f32 v195, v195, v35, v27
    v_fma_f32 v196, v196, v36, v28
    v_fma_f32 v197, v197, v37, v29
    v_fma_f32 v198, v198, v38, v30
    v_fma_f32 v199, v199, v39, v31
    v_cvt_pk_bf16_f32 v192, v192, v193
    v_cvt_pk_bf16_f32 v193, v194, v195
    v_cvt_pk_bf16_f32 v194, v196, v197
    v_cvt_pk_bf16_f32 v195, v198, v199
    ds_write_b128 v7, v[192:195] offset:0
    v_fma_f32 v200, v200, v32, v24
    v_fma_f32 v201, v201, v33, v25
    v_fma_f32 v202, v202, v34, v26
    v_fma_f32 v203, v203, v35, v27
    v_fma_f32 v204, v204, v36, v28
    v_fma_f32 v205, v205, v37, v29
    v_fma_f32 v206, v206, v38, v30
    v_fma_f32 v207, v207, v39, v31
    v_cvt_pk_bf16_f32 v200, v200, v201
    v_cvt_pk_bf16_f32 v201, v202, v203
    v_cvt_pk_bf16_f32 v202, v204, v205
    v_cvt_pk_bf16_f32 v203, v206, v207
    ds_write_b128 v7, v[200:203] offset:16
    v_fma_f32 v208, v208, v32, v24
    v_fma_f32 v209, v209, v33, v25
    v_fma_f32 v210, v210, v34, v26
    v_fma_f32 v211, v211, v35, v27
    v_fma_f32 v212, v212, v36, v28
    v_fma_f32 v213, v213, v37, v29
    v_fma_f32 v214, v214, v38, v30
    v_fma_f32 v215, v215, v39, v31
    v_cvt_pk_bf16_f32 v208, v208, v209
    v_cvt_pk_bf16_f32 v209, v210, v211
    v_cvt_pk_bf16_f32 v210, v212, v213
    v_cvt_pk_bf16_f32 v211, v214, v215
    ds_write_b128 v7, v[208:211] offset:32
    v_fma_f32 v216, v216, v32, v24
    v_fma_f32 v217, v217, v33, v25
    v_fma_f32 v218, v218, v34, v26
    v_fma_f32 v219, v219, v35, v27
    v_fma_f32 v220, v220, v36, v28
    v_fma_f32 v221, v221, v37, v29
    v_fma_f32 v222, v222, v38, v30
    v_fma_f32 v223, v223, v39, v31
    v_cvt_pk_bf16_f32 v216, v216, v217
    v_cvt_pk_bf16_f32 v217, v218, v219
    v_cvt_pk_bf16_f32 v218, v220, v221
    v_cvt_pk_bf16_f32 v219, v222, v223
    ds_write_b128 v7, v[216:219] offset:48
    v_fma_f32 v224, v224, v32, v24
    v_fma_f32 v225, v225, v33, v25
    v_fma_f32 v226, v226, v34, v26
    v_fma_f32 v227, v227, v35, v27
    v_fma_f32 v228, v228, v36, v28
    v_fma_f32 v229, v229, v37, v29
    v_fma_f32 v230, v230, v38, v30
    v_fma_f32 v231, v231, v39, v31
    v_cvt_pk_bf16_f32 v224, v224, v225
    v_cvt_pk_bf16_f32 v225, v226, v227
    v_cvt_pk_bf16_f32 v226, v228, v229
    v_cvt_pk_bf16_f32 v227, v230, v231
    ds_write_b128 v7, v[224:227] offset:64
    v_fma_f32 v232, v232, v32, v24
    v_fma_f32 v233, v233, v33, v25
    v_fma_f32 v234, v234, v34, v26
    v_fma_f32 v235, v235, v35, v27
    v_fma_f32 v236, v236, v36, v28
    v_fma_f32 v237, v237, v37, v29
    v_fma_f32 v238, v238, v38, v30
    v_fma_f32 v239, v239, v39, v31
    v_cvt_pk_bf16_f32 v232, v232, v233
    v_cvt_pk_bf16_f32 v233, v234, v235
    v_cvt_pk_bf16_f32 v234, v236, v237
    v_cvt_pk_bf16_f32 v235, v238, v239
    ds_write_b128 v7, v[232:235] offset:80
    v_fma_f32 v240, v240, v32, v24
    v_fma_f32 v241, v241, v33, v25
    v_fma_f32 v242, v242, v34, v26
    v_fma_f32 v243, v243, v35, v27
    v_fma_f32 v244, v244, v36, v28
    v_fma_f32 v245, v245, v37, v29
    v_fma_f32 v246, v246, v38, v30
    v_fma_f32 v247, v247, v39, v31
    v_cvt_pk_bf16_f32 v240, v240, v241
    v_cvt_pk_bf16_f32 v241, v242, v243
    v_cvt_pk_bf16_f32 v242, v244, v245
    v_cvt_pk_bf16_f32 v243, v246, v247
    ds_write_b128 v7, v[240:243] offset:96
    v_fma_f32 v248, v248, v32, v24
    v_fma_f32 v249, v249, v33, v25
    v_fma_f32 v250, v250, v34, v26
    v_fma_f32 v251, v251, v35, v27
    v_fma_f32 v252, v252, v36, v28
    v_fma_f32 v253, v253, v37, v29
    v_fma_f32 v254, v254, v38, v30
    v_fma_f32 v255, v255, v39, v31
    v_cvt_pk_bf16_f32 v248, v248, v249
    v_cvt_pk_bf16_f32 v249, v250, v251
    v_cvt_pk_bf16_f32 v250, v252, v253
    v_cvt_pk_bf16_f32 v251, v254, v255
    ds_write_b128 v7, v[248:251] offset:112
    s_waitcnt lgkmcnt(0)
    s_barrier
    ds_read_b128 v[128:131], v8 offset:0
    ds_read_b128 v[132:135], v8 offset:1056
    ds_read_b128 v[136:139], v8 offset:2112
    ds_read_b128 v[140:143], v8 offset:3168
    ds_read_b128 v[144:147], v8 offset:4224
    ds_read_b128 v[148:151], v8 offset:5280
    ds_read_b128 v[152:155], v8 offset:6336
    ds_read_b128 v[156:159], v8 offset:7392
    s_waitcnt lgkmcnt(7)
    buffer_store_dwordx4 v[128:131], v112, s[4:7], s20 offen offset:0 sc1
    s_waitcnt lgkmcnt(6)
    buffer_store_dwordx4 v[132:135], v112, s[4:7], s20 offen offset:1024 sc1
    s_waitcnt lgkmcnt(5)
    buffer_store_dwordx4 v[136:139], v112, s[4:7], s20 offen offset:2048 sc1
    s_waitcnt lgkmcnt(4)
    buffer_store_dwordx4 v[140:143], v112, s[4:7], s20 offen offset:3072 sc1
    s_waitcnt lgkmcnt(3)
    buffer_store_dwordx4 v[144:147], v112, s[4:7], s21 offen offset:0 sc1
    s_waitcnt lgkmcnt(2)
    buffer_store_dwordx4 v[148:151], v112, s[4:7], s21 offen offset:1024 sc1
    s_waitcnt lgkmcnt(1)
    buffer_store_dwordx4 v[152:155], v112, s[4:7], s21 offen offset:2048 sc1
    s_waitcnt lgkmcnt(0)
    buffer_store_dwordx4 v[156:159], v112, s[4:7], s21 offen offset:3072 sc1
    s_cmp_lg_u32 s15, 1
    s_cbranch_scc1 WA_120
    v_and_b32 v20, 15, v0
    v_lshlrev_b32 v21, 2, v20
    v_add_u32 v21, 132096, v21
    v_bfe_u32 v22, v0, 4, 1
    v_lshl_add_u32 v21, v22, 10, v21
    v_and_b32 v20, 31, v0
    ds_read_b32 v24, v21 offset:0
    ds_read_b32 v25, v21 offset:64
    ds_read_b32 v26, v21 offset:128
    ds_read_b32 v27, v21 offset:192
    ds_read_b32 v28, v21 offset:256
    ds_read_b32 v29, v21 offset:320
    ds_read_b32 v30, v21 offset:384
    ds_read_b32 v31, v21 offset:448
    ds_read_b32 v32, v21 offset:512
    ds_read_b32 v33, v21 offset:576
    ds_read_b32 v34, v21 offset:640
    ds_read_b32 v35, v21 offset:704
    ds_read_b32 v36, v21 offset:768
    ds_read_b32 v37, v21 offset:832
    ds_read_b32 v38, v21 offset:896
    ds_read_b32 v39, v21 offset:960
    v_lshlrev_b32 v20, 1, v20
    s_add_u32 s28, s28, 80740352
    s_waitcnt lgkmcnt(0)
    v_add_f32 v24, v24, v32
    v_add_f32 v25, v25, v33
    v_add_f32 v26, v26, v34
    v_add_f32 v27, v27, v35
    v_add_f32 v28, v28, v36
    v_add_f32 v29, v29, v37
    v_add_f32 v30, v30, v38
    v_add_f32 v31, v31, v39
    v_add_f32 v24, v24, v28
    v_add_f32 v25, v25, v29
    v_add_f32 v26, v26, v30
    v_add_f32 v27, v27, v31
    v_add_f32 v24, v24, v26
    v_add_f32 v25, v25, v27
    v_add_f32 v24, v24, v25
    v_cvt_pk_bf16_f32 v24, v24, v24
    buffer_store_short v24, v20, s[4:7], s28 offen sc1
WA_120:
    s_waitcnt vmcnt(0)
    s_barrier
    s_cmp_lg_u32 s15, 0
    s_cbranch_scc1 WA_121
    v_mov_b32 v21, 132
    v_mov_b32 v22, 1
    s_mov_b64 exec, 1
    global_atomic_add v21, v22, s[12:13] sc1
    s_mov_b64 exec, -1
WA_121:
WR_116:
    s_mov_b32 s8, s44
    s_mov_b32 s9, s45
    s_mov_b32 s10, 4194304
    s_add_u32 s3, s38, 0
    s_add_u32 m0, s36, 0
s_nop 0
    buffer_load_dwordx4 v100, s[8:11], s3 offen lds
    s_add_u32 s3, s38, 131072
    s_add_u32 m0, s36, 1024
s_nop 0
    buffer_load_dwordx4 v100, s[8:11], s3 offen lds
    s_add_u32 s3, s38, 262144
    s_add_u32 m0, s36, 2048
s_nop 0
    buffer_load_dwordx4 v100, s[8:11], s3 offen lds
    s_add_u32 s3, s38, 393216
    s_add_u32 m0, s36, 3072
s_nop 0
    buffer_load_dwordx4 v100, s[8:11], s3 offen lds
    s_add_u32 s3, s38, 524288
    s_add_u32 m0, s36, 4096
s_nop 0
    buffer_load_dwordx4 v100, s[8:11], s3 offen lds
    s_add_u32 s3, s38, 655360
    s_add_u32 m0, s36, 5120
s_nop 0
    buffer_load_dwordx4 v100, s[8:11], s3 offen lds
    s_add_u32 s3, s38, 786432
    s_add_u32 m0, s36, 6144
s_nop 0
    buffer_load_dwordx4 v100, s[8:11], s3 offen lds
    s_add_u32 s3, s38, 917504
    s_add_u32 m0, s36, 7168
s_nop 0
    buffer_load_dwordx4 v100, s[8:11], s3 offen lds
    s_add_u32 s3, s38, 1048576
    s_add_u32 m0, s36, 8192
s_nop 0
    buffer_load_dwordx4 v100, s[8:11], s3 offen lds
    s_add_u32 s3, s38, 1179648
    s_add_u32 m0, s36, 9216
s_nop 0
    buffer_load_dwordx4 v100, s[8:11], s3 offen lds
    s_add_u32 s3, s38, 1310720
    s_add_u32 m0, s36, 10240
s_nop 0
    buffer_load_dwordx4 v100, s[8:11], s3 offen lds
    s_add_u32 s3, s38, 1441792
    s_add_u32 m0, s36, 11264
s_nop 0
    buffer_load_dwordx4 v100, s[8:11], s3 offen lds
    s_add_u32 s3, s38, 1572864
    s_add_u32 m0, s36, 12288
s_nop 0
    buffer_load_dwordx4 v100, s[8:11], s3 offen lds
    s_add_u32 s3, s38, 1703936
    s_add_u32 m0, s36, 13312
s_nop 0
    buffer_load_dwordx4 v100, s[8:11], s3 offen lds
    s_add_u32 s3, s38, 1835008
    s_add_u32 m0, s36, 14336
s_nop 0
    buffer_load_dwordx4 v100, s[8:11], s3 offen lds
    s_add_u32 s3, s38, 1966080
    s_add_u32 m0, s36, 15360
s_nop 0
    buffer_load_dwordx4 v100, s[8:11], s3 offen lds
    s_add_u32 s3, s38, 2097152
    s_add_u32 m0, s36, 16384
s_nop 0
    buffer_load_dwordx4 v100, s[8:11], s3 offen lds
    s_add_u32 s3, s38, 2228224
    s_add_u32 m0, s36, 17408
s_nop 0
    buffer_load_dwordx4 v100, s[8:11], s3 offen lds
    s_add_u32 s3, s38, 2359296
    s_add_u32 m0, s36, 18432
s_nop 0
    buffer_load_dwordx4 v100, s[8:11], s3 offen lds
    s_add_u32 s3, s38, 2490368
    s_add_u32 m0, s36, 19456
s_nop 0
    buffer_load_dwordx4 v100, s[8:11], s3 offen lds
    s_add_u32 s3, s38, 2621440
    s_add_u32 m0, s36, 20480
s_nop 0
    buffer_load_dwordx4 v100, s[8:11], s3 offen lds
    s_add_u32 s3, s38, 2752512
    s_add_u32 m0, s36, 21504
s_nop 0
    buffer_load_dwordx4 v100, s[8:11], s3 offen lds
    s_add_u32 s3, s38, 2883584
    s_add_u32 m0, s36, 22528
s_nop 0
    buffer_load_dwordx4 v100, s[8:11], s3 offen lds
    s_add_u32 s3, s38, 3014656
    s_add_u32 m0, s36, 23552
s_nop 0
    buffer_load_dwordx4 v100, s[8:11], s3 offen lds
    s_add_u32 s3, s38, 3145728
    s_add_u32 m0, s36, 24576
s_nop 0
    buffer_load_dwordx4 v100, s[8:11], s3 offen lds
    s_add_u32 s3, s38, 3276800
    s_add_u32 m0, s36, 25600
s_nop 0
    buffer_load_dwordx4 v100, s[8:11], s3 offen lds
    s_add_u32 s3, s38, 3407872
    s_add_u32 m0, s36, 26624
s_nop 0
    buffer_load_dwordx4 v100, s[8:11], s3 offen lds
    s_add_u32 s3, s38, 3538944
    s_add_u32 m0, s36, 27648
s_nop 0
    buffer_load_dwordx4 v100, s[8:11], s3 offen lds
    s_add_u32 s3, s38, 3670016
    s_add_u32 m0, s36, 28672
s_nop 0
    buffer_load_dwordx4 v100, s[8:11], s3 offen lds
    s_add_u32 s3, s38, 3801088
    s_add_u32 m0, s36, 29696
s_nop 0
    buffer_load_dwordx4 v100, s[8:11], s3 offen lds
    s_add_u32 s3, s38, 3932160
    s_add_u32 m0, s36, 30720
s_nop 0
    buffer_load_dwordx4 v100, s[8:11], s3 offen lds
    s_add_u32 s3, s38, 4063232
    s_add_u32 m0, s36, 31744
s_nop 0
    buffer_load_dwordx4 v100, s[8:11], s3 offen lds
    s_waitcnt vmcnt(28)
    ds_read_b64_tr_b16 a[0:1], v103 offset:0
    ds_read_b64_tr_b16 a[2:3], v103 offset:256
    ds_read_b64_tr_b16 a[4:5], v103 offset:1024
    ds_read_b64_tr_b16 a[6:7], v103 offset:1280
    ds_read_b64_tr_b16 a[8:9], v103 offset:2048
    ds_read_b64_tr_b16 a[10:11], v103 offset:2304
    ds_read_b64_tr_b16 a[12:13], v103 offset:3072
    ds_read_b64_tr_b16 a[14:15], v103 offset:3328
    s_waitcnt lgkmcnt(0)
    s_mov_b32 s8, s46
    s_mov_b32 s9, s47
    s_mov_b32 s10, 4194304
    s_add_u32 s3, s38, 0
    s_add_u32 m0, s36, 0
s_nop 0
    buffer_load_dwordx4 v100, s[8:11], s3 offen lds
    s_add_u32 s3, s38, 131072
    s_add_u32 m0, s36, 1024
s_nop 0
    buffer_load_dwordx4 v100, s[8:11], s3 offen lds
    s_add_u32 s3, s38, 262144
    s_add_u32 m0, s36, 2048
s_nop 0
    buffer_load_dwordx4 v100, s[8:11], s3 offen lds
    s_add_u32 s3, s38, 393216
    s_add_u32 m0, s36, 3072
s_nop 0
    buffer_load_dwordx4 v100, s[8:11], s3 offen lds
    s_waitcnt vmcnt(28)
    ds_read_b64_tr_b16 a[16:17], v103 offset:4096
    ds_read_b64_tr_b16 a[18:19], v103 offset:4352
    ds_read_b64_tr_b16 a[20:21], v103 offset:5120
    ds_read_b64_tr_b16 a[22:23], v103 offset:5376
    ds_read_b64_tr_b16 a[24:25], v103 offset:6144
    ds_read_b64_tr_b16 a[26:27], v103 offset:6400
    ds_read_b64_tr_b16 a[28:29], v103 offset:7168
    ds_read_b64_tr_b16 a[30:31], v103 offset:7424
    s_waitcnt lgkmcnt(0)
    s_add_u32 s3, s38, 524288
    s_add_u32 m0, s36, 4096
s_nop 0
    buffer_load_dwordx4 v100, s[8:11], s3 offen lds
    s_add_u32 s3, s38, 655360
    s_add_u32 m0, s36, 5120
s_nop 0
    buffer_load_dwordx4 v100, s[8:11], s3 offen lds
    s_add_u32 s3, s38, 786432
    s_add_u32 m0, s36, 6144
s_nop 0
    buffer_load_dwordx4 v100, s[8:11], s3 offen lds
    s_add_u32 s3, s38, 917504
    s_add_u32 m0, s36, 7168
s_nop 0
    buffer_load_dwordx4 v100, s[8:11], s3 offen lds
    s_waitcnt vmcnt(28)
    ds_read_b64_tr_b16 a[32:33], v103 offset:8192
    ds_read_b64_tr_b16 a[34:35], v103 offset:8448
    ds_read_b64_tr_b16 a[36:37], v103 offset:9216
    ds_read_b64_tr_b16 a[38:39], v103 offset:9472
    ds_read_b64_tr_b16 a[40:41], v103 offset:10240
    ds_read_b64_tr_b16 a[42:43], v103 offset:10496
    ds_read_b64_tr_b16 a[44:45], v103 offset:11264
    ds_read_b64_tr_b16 a[46:47], v103 offset:11520
    s_waitcnt lgkmcnt(0)
    s_add_u32 s3, s38, 1048576
    s_add_u32 m0, s36, 8192
s_nop 0
    buffer_load_dwordx4 v100, s[8:11], s3 offen lds
    s_add_u32 s3, s38, 1179648
    s_add_u32 m0, s36, 9216
s_nop 0
    buffer_load_dwordx4 v100, s[8:11], s3 offen lds
    s_add_u32 s3, s38, 1310720
    s_add_u32 m0, s36, 10240
s_nop 0
    buffer_load_dwordx4 v100, s[8:11], s3 offen lds
    s_add_u32 s3, s38, 1441792
    s_add_u32 m0, s36, 11264
s_nop 0
    buffer_load_dwordx4 v100, s[8:11], s3 offen lds
    s_waitcnt vmcnt(28)
    ds_read_b64_tr_b16 a[48:49], v103 offset:12288
    ds_read_b64_tr_b16 a[50:51], v103 offset:12544
    ds_read_b64_tr_b16 a[52:53], v103 offset:13312
    ds_read_b64_tr_b16 a[54:55], v103 offset:13568
    ds_read_b64_tr_b16 a[56:57], v103 offset:14336
    ds_read_b64_tr_b16 a[58:59], v103 offset:14592
    ds_read_b64_tr_b16 a[60:61], v103 offset:15360
    ds_read_b64_tr_b16 a[62:63], v103 offset:15616
    s_waitcnt lgkmcnt(0)
    s_add_u32 s3, s38, 1572864
    s_add_u32 m0, s36, 12288
s_nop 0
    buffer_load_dwordx4 v100, s[8:11], s3 offen lds
    s_add_u32 s3, s38, 1703936
    s_add_u32 m0, s36, 13312
s_nop 0
    buffer_load_dwordx4 v100, s[8:11], s3 offen lds
    s_add_u32 s3, s38, 1835008
    s_add_u32 m0, s36, 14336
s_nop 0
    buffer_load_dwordx4 v100, s[8:11], s3 offen lds
    s_add_u32 s3, s38, 1966080
    s_add_u32 m0, s36, 15360
s_nop 0
    buffer_load_dwordx4 v100, s[8:11], s3 offen lds
    s_waitcnt vmcnt(28)
    ds_read_b64_tr_b16 a[64:65], v103 offset:16384
    ds_read_b64_tr_b16 a[66:67], v103 offset:16640
    ds_read_b64_tr_b16 a[68:69], v103 offset:17408
    ds_read_b64_tr_b16 a[70:71], v103 offset:17664
    ds_read_b64_tr_b16 a[72:73], v103 offset:18432
    ds_read_b64_tr_b16 a[74:75], v103 offset:18688
    ds_read_b64_tr_b16 a[76:77], v103 offset:19456
    ds_read_b64_tr_b16 a[78:79], v103 offset:19712
    s_waitcnt lgkmcnt(0)
    s_add_u32 s3, s38, 2097152
    s_add_u32 m0, s36, 16384
s_nop 0
    buffer_load_dwordx4 v100, s[8:11], s3 offen lds
    s_add_u32 s3, s38, 2228224
    s_add_u32 m0, s36, 17408
s_nop 0
    buffer_load_dwordx4 v100, s[8:11], s3 offen lds
    s_add_u32 s3, s38, 2359296
    s_add_u32 m0, s36, 18432
s_nop 0
    buffer_load_dwordx4 v100, s[8:11], s3 offen lds
    s_add_u32 s3, s38, 2490368
    s_add_u32 m0, s36, 19456
s_nop 0
    buffer_load_dwordx4 v100, s[8:11], s3 offen lds
    s_waitcnt vmcnt(28)
    ds_read_b64_tr_b16 a[80:81], v103 offset:20480
    ds_read_b64_tr_b16 a[82:83], v103 offset:20736
    ds_read_b64_tr_b16 a[84:85], v103 offset:21504
    ds_read_b64_tr_b16 a[86:87], v103 offset:21760
    ds_read_b64_tr_b16 a[88:89], v103 offset:22528
    ds_read_b64_tr_b16 a[90:91], v103 offset:22784
    ds_read_b64_tr_b16 a[92:93], v103 offset:23552
    ds_read_b64_tr_b16 a[94:95], v103 offset:23808
    s_waitcnt lgkmcnt(0)
    s_add_u32 s3, s38, 2621440
    s_add_u32 m0, s36, 20480
s_nop 0
    buffer_load_dwordx4 v100, s[8:11], s3 offen lds
    s_add_u32 s3, s38, 2752512
    s_add_u32 m0, s36, 21504
s_nop 0
    buffer_load_dwordx4 v100, s[8:11], s3 offen lds
    s_add_u32 s3, s38, 2883584
    s_add_u32 m0, s36, 22528
s_nop 0
    buffer_load_dwordx4 v100, s[8:11], s3 offen lds
    s_add_u32 s3, s38, 3014656
    s_add_u32 m0, s36, 23552
s_nop 0
    buffer_load_dwordx4 v100, s[8:11], s3 offen lds
    s_waitcnt vmcnt(28)
    ds_read_b64_tr_b16 a[96:97], v103 offset:24576
    ds_read_b64_tr_b16 a[98:99], v103 offset:24832
    ds_read_b64_tr_b16 a[100:101], v103 offset:25600
    ds_read_b64_tr_b16 a[102:103], v103 offset:25856
    ds_read_b64_tr_b16 a[104:105], v103 offset:26624
    ds_read_b64_tr_b16 a[106:107], v103 offset:26880
    ds_read_b64_tr_b16 a[108:109], v103 offset:27648
    ds_read_b64_tr_b16 a[110:111], v103 offset:27904
    s_waitcnt lgkmcnt(0)
    s_add_u32 s3, s38, 3145728
    s_add_u32 m0, s36, 24576
s_nop 0
    buffer_load_dwordx4 v100, s[8:11], s3 offen lds
    s_add_u32 s3, s38, 3276800
    s_add_u32 m0, s36, 25600
s_nop 0
    buffer_load_dwordx4 v100, s[8:11], s3 offen lds
    s_add_u32 s3, s38, 3407872
    s_add_u32 m0, s36, 26624
s_nop 0
    buffer_load_dwordx4 v100, s[8:11], s3 offen lds
    s_add_u32 s3, s38, 3538944
    s_add_u32 m0, s36, 27648
s_nop 0
    buffer_load_dwordx4 v100, s[8:11], s3 offen lds
    s_waitcnt vmcnt(28)
    ds_read_b64_tr_b16 a[112:113], v103 offset:28672
    ds_read_b64_tr_b16 a[114:115], v103 offset:28928
    ds_read_b64_tr_b16 a[116:117], v103 offset:29696
    ds_read_b64_tr_b16 a[118:119], v103 offset:29952
    ds_read_b64_tr_b16 a[120:121], v103 offset:30720
    ds_read_b64_tr_b16 a[122:123], v103 offset:30976
    ds_read_b64_tr_b16 a[124:125], v103 offset:31744
    ds_read_b64_tr_b16 a[126:127], v103 offset:32000
    s_waitcnt lgkmcnt(0)
    s_add_u32 s3, s38, 3670016
    s_add_u32 m0, s36, 28672
s_nop 0
    buffer_load_dwordx4 v100, s[8:11], s3 offen lds
    s_add_u32 s3, s38, 3801088
    s_add_u32 m0, s36, 29696
s_nop 0
    buffer_load_dwordx4 v100, s[8:11], s3 offen lds
    s_add_u32 s3, s38, 3932160
    s_add_u32 m0, s36, 30720
s_nop 0
    buffer_load_dwordx4 v100, s[8:11], s3 offen lds
    s_add_u32 s3, s38, 4063232
    s_add_u32 m0, s36, 31744
s_nop 0
    buffer_load_dwordx4 v100, s[8:11], s3 offen lds
    s_waitcnt vmcnt(28)
    ds_read_b64_tr_b16 a[128:129], v103 offset:0
    ds_read_b64_tr_b16 a[130:131], v103 offset:256
    ds_read_b64_tr_b16 a[132:133], v103 offset:1024
    ds_read_b64_tr_b16 a[134:135], v103 offset:1280
    ds_read_b64_tr_b16 a[136:137], v103 offset:2048
    ds_read_b64_tr_b16 a[138:139], v103 offset:2304
    ds_read_b64_tr_b16 a[140:141], v103 offset:3072
    ds_read_b64_tr_b16 a[142:143], v103 offset:3328
    s_waitcnt lgkmcnt(0)
    s_waitcnt vmcnt(24)
    ds_read_b64_tr_b16 a[144:145], v103 offset:4096
    ds_read_b64_tr_b16 a[146:147], v103 offset:4352
    ds_read_b64_tr_b16 a[148:149], v103 offset:5120
    ds_read_b64_tr_b16 a[150:151], v103 offset:5376
    ds_read_b64_tr_b16 a[152:153], v103 offset:6144
    ds_read_b64_tr_b16 a[154:155], v103 offset:6400
    ds_read_b64_tr_b16 a[156:157], v103 offset:7168
    ds_read_b64_tr_b16 a[158:159], v103 offset:7424
    s_waitcnt lgkmcnt(0)
    s_waitcnt vmcnt(20)
    ds_read_b64_tr_b16 a[160:161], v103 offset:8192
    ds_read_b64_tr_b16 a[162:163], v103 offset:8448
    ds_read_b64_tr_b16 a[164:165], v103 offset:9216
    ds_read_b64_tr_b16 a[166:167], v103 offset:9472
    ds_read_b64_tr_b16 a[168:169], v103 offset:10240
    ds_read_b64_tr_b16 a[170:171], v103 offset:10496
    ds_read_b64_tr_b16 a[172:173], v103 offset:11264
    ds_read_b64_tr_b16 a[174:175], v103 offset:11520
    s_waitcnt lgkmcnt(0)
    s_waitcnt vmcnt(16)
    ds_read_b64_tr_b16 a[176:177], v103 offset:12288
    ds_read_b64_tr_b16 a[178:179], v103 offset:12544
    ds_read_b64_tr_b16 a[180:181], v103 offset:13312
    ds_read_b64_tr_b16 a[182:183], v103 offset:13568
    ds_read_b64_tr_b16 a[184:185], v103 offset:14336
    ds_read_b64_tr_b16 a[186:187], v103 offset:14592
    ds_read_b64_tr_b16 a[188:189], v103 offset:15360
    ds_read_b64_tr_b16 a[190:191], v103 offset:15616
    s_waitcnt lgkmcnt(0)
    s_waitcnt vmcnt(12)
    ds_read_b64_tr_b16 a[192:193], v103 offset:16384
    ds_read_b64_tr_b16 a[194:195], v103 offset:16640
    ds_read_b64_tr_b16 a[196:197], v103 offset:17408
    ds_read_b64_tr_b16 a[198:199], v103 offset:17664
    ds_read_b64_tr_b16 a[200:201], v103 offset:18432
    ds_read_b64_tr_b16 a[202:203], v103 offset:18688
    ds_read_b64_tr_b16 a[204:205], v103 offset:19456
    ds_read_b64_tr_b16 a[206:207], v103 offset:19712
    s_waitcnt lgkmcnt(0)
    s_waitcnt vmcnt(8)
    ds_read_b64_tr_b16 a[208:209], v103 offset:20480
    ds_read_b64_tr_b16 a[210:211], v103 offset:20736
    ds_read_b64_tr_b16 a[212:213], v103 offset:21504
    ds_read_b64_tr_b16 a[214:215], v103 offset:21760
    ds_read_b64_tr_b16 a[216:217], v103 offset:22528
    ds_read_b64_tr_b16 a[218:219], v103 offset:22784
    ds_read_b64_tr_b16 a[220:221], v103 offset:23552
    ds_read_b64_tr_b16 a[222:223], v103 offset:23808
    s_waitcnt lgkmcnt(0)
    s_waitcnt vmcnt(4)
    ds_read_b64_tr_b16 a[224:225], v103 offset:24576
    ds_read_b64_tr_b16 a[226:227], v103 offset:24832
    ds_read_b64_tr_b16 a[228:229], v103 offset:25600
    ds_read_b64_tr_b16 a[230:231], v103 offset:25856
    ds_read_b64_tr_b16 a[232:233], v103 offset:26624
    ds_read_b64_tr_b16 a[234:235], v103 offset:26880
    ds_read_b64_tr_b16 a[236:237], v103 offset:27648
    ds_read_b64_tr_b16 a[238:239], v103 offset:27904
    s_waitcnt lgkmcnt(0)
    s_waitcnt vmcnt(0)
    ds_read_b64_tr_b16 a[240:241], v103 offset:28672
    ds_read_b64_tr_b16 a[242:243], v103 offset:28928
    ds_read_b64_tr_b16 a[244:245], v103 offset:29696
    ds_read_b64_tr_b16 a[246:247], v103 offset:29952
    ds_read_b64_tr_b16 a[248:249], v103 offset:30720
    ds_read_b64_tr_b16 a[250:251], v103 offset:30976
    ds_read_b64_tr_b16 a[252:253], v103 offset:31744
    ds_read_b64_tr_b16 a[254:255], v103 offset:32000
    s_waitcnt lgkmcnt(0)

    v_add_u32 v113, 0x10000, v112
    s_lshl_b32 s3, s15, 11
    v_add_u32 v114, s3, v113
    s_lshl_b32 s28, s15, 13
    s_add_u32 s28, s28, 98304
    v_add_u32 v115, s28, v112
    s_lshl_b32 s28, s15, 10
    v_add_u32 v116, s28, v112
    v_and_b32 v2, 31, v0
    v_lshlrev_b32 v3, 8, v11
    v_bfe_u32 v4, v0, 3, 1
    v_lshl_add_u32 v5, v4, 10, v3
    v_lshl_add_u32 v5, v12, 7, v5
    v_and_b32 v6, 7, v0
    v_lshl_add_u32 v117, v6, 4, v5
    v_and_b32 v6, 15, v0
    v_lshl_add_u32 v5, v12, 10, v3
    v_lshl_add_u32 v5, v6, 4, v5
    s_add_u32 s3, s3, 8192
    v_add_u32 v118, s3, v5
    v_lshl_add_u32 v5, v12, 9, v3
    v_lshl_add_u32 v5, v6, 4, v5
    v_add_u32 v119, 8, v5
    v_lshl_add_u32 v5, v6, 4, v3
    v_lshl_add_u32 v5, v12, 3, v5
    s_lshl_b32 s3, s15, 9
    v_add_u32 v120, s3, v5
    v_lshlrev_b32 v5, 6, v11
    v_lshl_add_u32 v5, v13, 4, v5
    v_and_b32 v6, 1, v0
    v_lshl_add_u32 v121, v6, 3, v5
    v_lshlrev_b32 v5, 10, v2
    v_lshl_add_u32 v122, v11, 4, v5
    v_lshlrev_b32 v5, 2, v11
    v_sub_u32 v123, v2, v5
    v_lshlrev_b32 v15, 2, v2
    s_lshl_b32 s3, s15, 11
    v_add_u32 v14, s3, v117
    s_barrier

WD_122:
    v_mov_b32 v110, 128
    global_load_dwordx2 v[108:109], v110, s[12:13] sc1
    s_sub_u32 s30, s30, 1
    s_cbranch_scc1 L_abort
    s_waitcnt vmcnt(0)
    v_add_u32 v108, v108, v109
    v_cmp_gt_u32 vcc, 0xc0, v108
    s_cbranch_vccnz WD_122

    s_mov_b32 s16, 0
    s_lshl_b32 s20, s17, 15
    s_lshl_b32 s3, s15, 13
    s_add_u32 s20, s20, s3
    s_add_u32 s20, s20, 60817408
    s_lshl_b32 s3, s17, 5
    s_add_u32 s3, s3, s14
    s_mul_i32 s21, s3, 16384
    s_add_u32 s21, s21, 1048576
    s_lshl_b32 s22, s3, 12
    s_lshl_b32 s3, s15, 10
    s_add_u32 s22, s22, s3
    s_add_u32 s22, s22, 52428800
    s_lshl_b32 s37, s15, 13

    s_lshl_b32 s24, s14, 2
    s_add_u32 s24, s24, s15
    s_lshl_b32 s24, s24, 8
    s_lshl_b32 s3, s17, 2
    s_add_u32 s24, s24, s3
    s_add_u32 s24, s24, 80871396
    v_mov_b32 v16, v112
    v_mov_b32 v96, -1
    v_mov_b32 v97, -1
    v_mov_b32 v98, -1
    v_mov_b32 v99, -1

    s_add_u32 m0, s37, 0
    s_add_u32 s3, s20, 0
    buffer_load_dwordx4 v112, s[4:7], s3 offen offset:0 sc1 lds
    buffer_load_dwordx4 v112, s[4:7], s3 offen offset:1024 sc1 lds
    buffer_load_dwordx4 v112, s[4:7], s3 offen offset:2048 sc1 lds
    buffer_load_dwordx4 v112, s[4:7], s3 offen offset:3072 sc1 lds
    s_add_u32 m0, s37, 4096
    s_add_u32 s3, s20, 4096
    buffer_load_dwordx4 v112, s[4:7], s3 offen offset:0 sc1 lds
    buffer_load_dwordx4 v112, s[4:7], s3 offen offset:1024 sc1 lds
    buffer_load_dwordx4 v112, s[4:7], s3 offen offset:2048 sc1 lds
    buffer_load_dwordx4 v112, s[4:7], s3 offen offset:3072 sc1 lds
    s_add_u32 s20, s20, 229376
    s_xor_b32 s37, s37, 0x8000
    s_waitcnt vmcnt(0)
W1_123:
    s_waitcnt vmcnt(5)
    s_barrier
    ds_read_b128 v[32:35], v16 offset:0
    ds_read_b128 v[36:39], v16 offset:1024
    ds_read_b128 v[40:43], v16 offset:2048
    ds_read_b128 v[44:47], v16 offset:3072
    ds_read_b128 v[48:51], v16 offset:4096
    ds_read_b128 v[52:55], v16 offset:5120
    s_add_u32 m0, s37, 0
    s_add_u32 s3, s20, 0
    buffer_load_dwordx4 v112, s[4:7], s3 offen offset:0 sc1 lds
    buffer_load_dwordx4 v112, s[4:7], s3 offen offset:1024 sc1 lds
    buffer_load_dwordx4 v112, s[4:7], s3 offen offset:2048 sc1 lds
    buffer_load_dwordx4 v112, s[4:7], s3 offen offset:3072 sc1 lds
    s_add_u32 m0, s37, 4096
    s_add_u32 s3, s20, 4096
    buffer_load_dwordx4 v112, s[4:7], s3 offen offset:0 sc1 lds
    buffer_load_dwordx4 v112, s[4:7], s3 offen offset:1024 sc1 lds
    buffer_load_dwordx4 v112, s[4:7], s3 offen offset:2048 sc1 lds
    buffer_load_dwordx4 v112, s[4:7], s3 offen offset:3072 sc1 lds
    s_add_u32 s20, s20, 229376
    s_xor_b32 s37, s37, 0x8000
    s_waitcnt lgkmcnt(5)
    v_mfma_f32_32x32x16_bf16 v[64:79], a[0:3], v[32:35], 0
    ds_read_b128 v[56:59], v16 offset:6144
    v_mfma_f32_32x32x16_bf16 v[80:95], v[32:35], a[128:131], 0
    s_waitcnt lgkmcnt(5)
    v_mfma_f32_32x32x16_bf16 v[64:79], a[4:7], v[36:39], v[64:79]
    ds_read_b128 v[60:63], v16 offset:7168
    v_mfma_f32_32x32x16_bf16 v[80:95], v[36:39], a[132:135], v[80:95]
    s_cmp_lg_u32 s16, 1
    s_cbranch_scc1 WF_124
    s_waitcnt vmcnt(8)
    v_mov_b32 v108, 1
    v_mov_b32 v109, 0
    s_mov_b64 exec, 1
    buffer_store_dword v108, v109, s[4:7], s24 offen offset:0 sc1
    s_mov_b64 exec, -1
WF_124:
    s_waitcnt lgkmcnt(5)
    v_mfma_f32_32x32x16_bf16 v[64:79], a[8:11], v[40:43], v[64:79]
    ds_read_b128 v[32:35], v16 offset:8192
    v_mfma_f32_32x32x16_bf16 v[80:95], v[40:43], a[136:139], v[80:95]
    s_waitcnt lgkmcnt(5)
    v_mfma_f32_32x32x16_bf16 v[64:79], a[12:15], v[44:47], v[64:79]
    ds_read_b128 v[36:39], v16 offset:9216
    v_mfma_f32_32x32x16_bf16 v[80:95], v[44:47], a[140:143], v[80:95]
    s_waitcnt lgkmcnt(5)
    v_mfma_f32_32x32x16_bf16 v[64:79], a[16:19], v[48:51], v[64:79]
    ds_read_b128 v[40:43], v16 offset:10240
    v_mfma_f32_32x32x16_bf16 v[80:95], v[48:51], a[144:147], v[80:95]
    s_waitcnt lgkmcnt(5)
    v_mfma_f32_32x32x16_bf16 v[64:79], a[20:23], v[52:55], v[64:79]
    ds_read_b128 v[44:47], v16 offset:11264
    v_mfma_f32_32x32x16_bf16 v[80:95], v[52:55], a[148:151], v[80:95]
    s_waitcnt lgkmcnt(5)
    v_mfma_f32_32x32x16_bf16 v[64:79], a[24:27], v[56:59], v[64:79]
    ds_read_b128 v[48:51], v16 offset:12288
    v_mfma_f32_32x32x16_bf16 v[80:95], v[56:59], a[152:155], v[80:95]
    s_waitcnt lgkmcnt(5)
    v_mfma_f32_32x32x16_bf16 v[64:79], a[28:31], v[60:63], v[64:79]
    ds_read_b128 v[52:55], v16 offset:13312
    v_mfma_f32_32x32x16_bf16 v[80:95], v[60:63], a[156:159], v[80:95]
    s_waitcnt lgkmcnt(5)
    v_mfma_f32_32x32x16_bf16 v[64:79], a[32:35], v[32:35], v[64:79]
    ds_read_b128 v[56:59], v16 offset:14336
    v_mfma_f32_32x32x16_bf16 v[80:95], v[32:35], a[160:163], v[80:95]
    s_waitcnt lgkmcnt(5)
    v_mfma_f32_32x32x16_bf16 v[64:79], a[36:39], v[36:39], v[64:79]
    ds_read_b128 v[60:63], v16 offset:15360
    v_mfma_f32_32x32x16_bf16 v[80:95], v[36:39], a[164:167], v[80:95]
    s_waitcnt lgkmcnt(5)
    v_mfma_f32_32x32x16_bf16 v[64:79], a[40:43], v[40:43], v[64:79]
    ds_read_b128 v[32:35], v16 offset:16384
    v_mfma_f32_32x32x16_bf16 v[80:95], v[40:43], a[168:171], v[80:95]
    s_waitcnt lgkmcnt(5)
    v_mfma_f32_32x32x16_bf16 v[64:79], a[44:47], v[44:47], v[64:79]
    ds_read_b128 v[36:39], v16 offset:17408
    v_mfma_f32_32x32x16_bf16 v[80:95], v[44:47], a[172:175], v[80:95]
    s_waitcnt lgkmcnt(5)
    v_mfma_f32_32x32x16_bf16 v[64:79], a[48:51], v[48:51], v[64:79]
    ds_read_b128 v[40:43], v16 offset:18432
    v_mfma_f32_32x32x16_bf16 v[80:95], v[48:51], a[176:179], v[80:95]
    s_waitcnt lgkmcnt(5)
    v_mfma_f32_32x32x16_bf16 v[64:79], a[52:55], v[52:55], v[64:79]
    ds_read_b128 v[44:47], v16 offset:19456
    v_mfma_f32_32x32x16_bf16 v[80:95], v[52:55], a[180:183], v[80:95]
    s_waitcnt lgkmcnt(5)
    v_mfma_f32_32x32x16_bf16 v[64:79], a[56:59], v[56:59], v[64:79]
    ds_read_b128 v[48:51], v16 offset:20480
    v_mfma_f32_32x32x16_bf16 v[80:95], v[56:59], a[184:187], v[80:95]
    s_waitcnt lgkmcnt(5)
    v_mfma_f32_32x32x16_bf16 v[64:79], a[60:63], v[60:63], v[64:79]
    ds_read_b128 v[52:55], v16 offset:21504
    v_mfma_f32_32x32x16_bf16 v[80:95], v[60:63], a[188:191], v[80:95]
    s_waitcnt lgkmcnt(5)
    v_mfma_f32_32x32x16_bf16 v[64:79], a[64:67], v[32:35], v[64:79]
    ds_read_b128 v[56:59], v16 offset:22528
    v_mfma_f32_32x32x16_bf16 v[80:95], v[32:35], a[192:195], v[80:95]
    s_cmp_le_u32 s16, 1
    s_cbranch_scc1 WF_125
    s_waitcnt vmcnt(8)
    v_mov_b32 v108, 1
    v_mov_b32 v109, 0
    s_mov_b64 exec, 1
    buffer_store_dword v108, v109, s[4:7], s24 offen offset:0 sc1
    s_mov_b64 exec, -1
WF_125:
    s_waitcnt lgkmcnt(5)
    v_mfma_f32_32x32x16_bf16 v[64:79], a[68:71], v[36:39], v[64:79]
    ds_read_b128 v[60:63], v16 offset:23552
    v_mfma_f32_32x32x16_bf16 v[80:95], v[36:39], a[196:199], v[80:95]
    s_waitcnt lgkmcnt(5)
    v_mfma_f32_32x32x16_bf16 v[64:79], a[72:75], v[40:43], v[64:79]
    ds_read_b128 v[32:35], v16 offset:24576
    v_mfma_f32_32x32x16_bf16 v[80:95], v[40:43], a[200:203], v[80:95]
    s_waitcnt lgkmcnt(5)
    v_mfma_f32_32x32x16_bf16 v[64:79], a[76:79], v[44:47], v[64:79]
    ds_read_b128 v[36:39], v16 offset:25600
    v_mfma_f32_32x32x16_bf16 v[80:95], v[44:47], a[204:207], v[80:95]
    s_waitcnt lgkmcnt(5)
    v_mfma_f32_32x32x16_bf16 v[64:79], a[80:83], v[48:51], v[64:79]
    ds_read_b128 v[40:43], v16 offset:26624
    v_mfma_f32_32x32x16_bf16 v[80:95], v[48:51], a[208:211], v[80:95]
    s_waitcnt lgkmcnt(5)
    v_mfma_f32_32x32x16_bf16 v[64:79], a[84:87], v[52:55], v[64:79]
    ds_read_b128 v[44:47], v16 offset:27648
    v_mfma_f32_32x32x16_bf16 v[80:95], v[52:55], a[212:215], v[80:95]
    s_waitcnt lgkmcnt(5)
    v_mfma_f32_32x32x16_bf16 v[64:79], a[88:91], v[56:59], v[64:79]
    ds_read_b128 v[48:51], v16 offset:28672
    v_mfma_f32_32x32x16_bf16 v[80:95], v[56:59], a[216:219], v[80:95]
    s_waitcnt lgkmcnt(5)
    v_mfma_f32_32x32x16_bf16 v[64:79], a[92:95], v[60:63], v[64:79]
    ds_read_b128 v[52:55], v16 offset:29696
    v_mfma_f32_32x32x16_bf16 v[80:95], v[60:63], a[220:223], v[80:95]
    s_waitcnt lgkmcnt(5)
    v_mfma_f32_32x32x16_bf16 v[64:79], a[96:99], v[32:35], v[64:79]
    ds_read_b128 v[56:59], v16 offset:30720
    v_mfma_f32_32x32x16_bf16 v[80:95], v[32:35], a[224:227], v[80:95]
    s_waitcnt lgkmcnt(5)
    v_mfma_f32_32x32x16_bf16 v[64:79], a[100:103], v[36:39], v[64:79]
    ds_read_b128 v[60:63], v16 offset:31744
    v_mfma_f32_32x32x16_bf16 v[80:95], v[36:39], a[228:231], v[80:95]
    s_waitcnt lgkmcnt(5)
    v_mfma_f32_32x32x16_bf16 v[64:79], a[104:107], v[40:43], v[64:79]
    v_mfma_f32_32x32x16_bf16 v[80:95], v[40:43], a[232:235], v[80:95]
    s_waitcnt lgkmcnt(4)
    v_mfma_f32_32x32x16_bf16 v[64:79], a[108:111], v[44:47], v[64:79]
    v_mfma_f32_32x32x16_bf16 v[80:95], v[44:47], a[236:239], v[80:95]
    s_waitcnt lgkmcnt(3)
    v_mfma_f32_32x32x16_bf16 v[64:79], a[112:115], v[48:51], v[64:79]
    v_mfma_f32_32x32x16_bf16 v[80:95], v[48:51], a[240:243], v[80:95]
    s_waitcnt lgkmcnt(2)
    v_mfma_f32_32x32x16_bf16 v[64:79], a[116:119], v[52:55], v[64:79]
    v_mfma_f32_32x32x16_bf16 v[80:95], v[52:55], a[244:247], v[80:95]
    s_waitcnt lgkmcnt(1)
    v_mfma_f32_32x32x16_bf16 v[64:79], a[120:123], v[56:59], v[64:79]
    v_mfma_f32_32x32x16_bf16 v[80:95], v[56:59], a[248:251], v[80:95]
    s_waitcnt lgkmcnt(0)
    v_mfma_f32_32x32x16_bf16 v[64:79], a[124:127], v[60:63], v[64:79]
    v_mfma_f32_32x32x16_bf16 v[80:95], v[60:63], a[252:255], v[80:95]
    buffer_store_dwordx4 v[96:99], v112, s[4:7], s22 offen sc1
s_nop 2
    v_cvt_pk_bf16_f32 v64, v64, v65
    v_cvt_pk_bf16_f32 v65, v66, v67
    v_cvt_pk_bf16_f32 v66, v68, v69
    v_cvt_pk_bf16_f32 v67, v70, v71
    v_cvt_pk_bf16_f32 v68, v72, v73
    v_cvt_pk_bf16_f32 v69, v74, v75
    v_cvt_pk_bf16_f32 v70, v76, v77
    v_cvt_pk_bf16_f32 v71, v78, v79
    buffer_store_dwordx4 v[64:67], v14, s[4:7], s21 offen sc1
    buffer_store_dwordx4 v[68:71], v14, s[4:7], s21 offen offset:512 sc1
    v_cvt_pk_bf16_f32 v80, v80, v81
    v_cvt_pk_bf16_f32 v81, v82, v83
    v_cvt_pk_bf16_f32 v82, v84, v85
    v_cvt_pk_bf16_f32 v83, v86, v87
    v_cvt_pk_bf16_f32 v84, v88, v89
    v_cvt_pk_bf16_f32 v85, v90, v91
    v_cvt_pk_bf16_f32 v86, v92, v93
    v_cvt_pk_bf16_f32 v87, v94, v95
    buffer_store_dwordx4 v[80:83], v118, s[4:7], s21 offen sc1
    buffer_store_dwordx4 v[84:87], v118, s[4:7], s21 offen offset:512 sc1
    s_add_u32 s21, s21, 3670016
    s_add_u32 s22, s22, 917504
    s_add_u32 s24, s24, 28
    v_xor_b32 v16, 0x8000, v16
    s_add_u32 s16, s16, 1
    s_cmp_lt_u32 s16, s18
    s_cbranch_scc1 W1_123
    s_waitcnt vmcnt(0)
    v_mov_b32 v108, 1
    v_mov_b32 v109, 0
    s_mov_b64 exec, 1
    buffer_store_dword v108, v109, s[4:7], s24 offen offset:0 sc1
    s_mov_b64 exec, -1
    s_barrier

    s_cmp_lg_u32 s15, 0
    s_cbranch_scc1 TA_126
    s_getreg_b32 s3, hwreg(HW_REG_XCC_ID)
    s_and_b32 s3, s3, 7
    s_mul_i32 s3, s3, 6
    s_lshl_b64 vcc, 1, s3
    v_mov_b32 v4, vcc_lo
    v_mov_b32 v5, vcc_hi
    s_add_u32 s3, s17, 1
    s_lshl_b32 s3, s3, 3
    v_mov_b32 v2, s3
    s_mov_b64 exec, 1
    global_atomic_add_x2 v2, v[4:5], s[12:13] sc1
    s_mov_b64 exec, -1
TA_126:

    s_lshl_b32 s39, s14, 17
    s_lshl_b32 s3, s15, 8
    s_add_u32 s39, s39, s3
    s_lshl_b32 s28, s14, 6
    s_add_u32 s29, s28, 32
    s_min_u32 s28, s28, 1344
    s_min_u32 s29, s29, 1344
    s_lshl_b32 s62, s28, 10
    s_lshl_b32 s63, s29, 10
    s_add_u32 s62, s62, s3
    s_add_u32 s63, s63, s3
    s_mul_i32 s3, s15, 352256
    s_lshl_b32 s60, s28, 1
    s_lshl_b32 s61, s29, 1
    s_add_u32 s60, s60, s3
    s_add_u32 s61, s61, s3

    s_mov_b32 s8, s50
    s_mov_b32 s9, s51
    s_mov_b32 s10, 1409024
    s_add_u32 s3, s60, 0
    s_add_u32 m0, s36, 0
s_nop 0
    buffer_load_dwordx4 v102, s[8:11], s3 offen lds
    s_add_u32 s3, s60, 44032
    s_add_u32 m0, s36, 1024
s_nop 0
    buffer_load_dwordx4 v102, s[8:11], s3 offen lds
    s_add_u32 s3, s60, 88064
    s_add_u32 m0, s36, 2048
s_nop 0
    buffer_load_dwordx4 v102, s[8:11], s3 offen lds
    s_add_u32 s3, s60, 132096
    s_add_u32 m0, s36, 3072
s_nop 0
    buffer_load_dwordx4 v102, s[8:11], s3 offen lds
    s_add_u32 s3, s60, 176128
    s_add_u32 m0, s36, 4096
s_nop 0
    buffer_load_dwordx4 v102, s[8:11], s3 offen lds
    s_add_u32 s3, s60, 220160
    s_add_u32 m0, s36, 5120
s_nop 0
    buffer_load_dwordx4 v102, s[8:11], s3 offen lds
    s_add_u32 s3, s60, 264192
    s_add_u32 m0, s36, 6144
s_nop 0
    buffer_load_dwordx4 v102, s[8:11], s3 offen lds
    s_add_u32 s3, s60, 308224
    s_add_u32 m0, s36, 7168
s_nop 0
    buffer_load_dwordx4 v102, s[8:11], s3 offen lds
    s_add_u32 s3, s61, 0
    s_add_u32 m0, s36, 8192
s_nop 0
    buffer_load_dwordx4 v102, s[8:11], s3 offen lds
    s_add_u32 s3, s61, 44032
    s_add_u32 m0, s36, 9216
s_nop 0
    buffer_load_dwordx4 v102, s[8:11], s3 offen lds
    s_add_u32 s3, s61, 88064
    s_add_u32 m0, s36, 10240
s_nop 0
    buffer_load_dwordx4 v102, s[8:11], s3 offen lds
    s_add_u32 s3, s61, 132096
    s_add_u32 m0, s36, 11264
s_nop 0
    buffer_load_dwordx4 v102, s[8:11], s3 offen lds
    s_add_u32 s3, s61, 176128
    s_add_u32 m0, s36, 12288
s_nop 0
    buffer_load_dwordx4 v102, s[8:11], s3 offen lds
    s_add_u32 s3, s61, 220160
    s_add_u32 m0, s36, 13312
s_nop 0
    buffer_load_dwordx4 v102, s[8:11], s3 offen lds
    s_add_u32 s3, s61, 264192
    s_add_u32 m0, s36, 14336
s_nop 0
    buffer_load_dwordx4 v102, s[8:11], s3 offen lds
    s_add_u32 s3, s61, 308224
    s_add_u32 m0, s36, 15360
s_nop 0
    buffer_load_dwordx4 v102, s[8:11], s3 offen lds
    s_mov_b32 s8, s52
    s_mov_b32 s9, s53
    s_mov_b32 s10, 1409024
    s_add_u32 s3, s62, 0
    s_add_u32 m0, s36, 16384
s_nop 0
    buffer_load_dwordx4 v101, s[8:11], s3 offen lds
    s_add_u32 s3, s62, 64
    s_add_u32 m0, s36, 17408
s_nop 0
    buffer_load_dwordx4 v101, s[8:11], s3 offen lds
    s_add_u32 s3, s62, 128
    s_add_u32 m0, s36, 18432
s_nop 0
    buffer_load_dwordx4 v101, s[8:11], s3 offen lds
    s_add_u32 s3, s62, 192
    s_add_u32 m0, s36, 19456
s_nop 0
    buffer_load_dwordx4 v101, s[8:11], s3 offen lds
    s_add_u32 s3, s62, 16384
    s_add_u32 m0, s36, 20480
s_nop 0
    buffer_load_dwordx4 v101, s[8:11], s3 offen lds
    s_add_u32 s3, s62, 16448
    s_add_u32 m0, s36, 21504
s_nop 0
    buffer_load_dwordx4 v101, s[8:11], s3 offen lds
    s_add_u32 s3, s62, 16512
    s_add_u32 m0, s36, 22528
s_nop 0
    buffer_load_dwordx4 v101, s[8:11], s3 offen lds
    s_add_u32 s3, s62, 16576
    s_add_u32 m0, s36, 23552
s_nop 0
    buffer_load_dwordx4 v101, s[8:11], s3 offen lds
    s_add_u32 s3, s63, 0
    s_add_u32 m0, s36, 24576
s_nop 0
    buffer_load_dwordx4 v101, s[8:11], s3 offen lds
    s_add_u32 s3, s63, 64
    s_add_u32 m0, s36, 25600
s_nop 0
    buffer_load_dwordx4 v101, s[8:11], s3 offen lds
    s_add_u32 s3, s63, 128
    s_add_u32 m0, s36, 26624
s_nop 0
    buffer_load_dwordx4 v101, s[8:11], s3 offen lds
    s_add_u32 s3, s63, 192
    s_add_u32 m0, s36, 27648
s_nop 0
    buffer_load_dwordx4 v101, s[8:11], s3 offen lds
    s_add_u32 s3, s63, 16384
    s_add_u32 m0, s36, 28672
s_nop 0
    buffer_load_dwordx4 v101, s[8:11], s3 offen lds
    s_add_u32 s3, s63, 16448
    s_add_u32 m0, s36, 29696
s_nop 0
    buffer_load_dwordx4 v101, s[8:11], s3 offen lds
    s_add_u32 s3, s63, 16512
    s_add_u32 m0, s36, 30720
s_nop 0
    buffer_load_dwordx4 v101, s[8:11], s3 offen lds
    s_add_u32 s3, s63, 16576
    s_add_u32 m0, s36, 31744
s_nop 0
    buffer_load_dwordx4 v101, s[8:11], s3 offen lds
    s_waitcnt vmcnt(28)
    ds_read_b64_tr_b16 v[128:129], v103 offset:0
    ds_read_b64_tr_b16 v[130:131], v103 offset:256
    ds_read_b64_tr_b16 v[132:133], v103 offset:1024
    ds_read_b64_tr_b16 v[134:135], v103 offset:1280
    ds_read_b64_tr_b16 v[136:137], v103 offset:2048
    ds_read_b64_tr_b16 v[138:139], v103 offset:2304
    ds_read_b64_tr_b16 v[140:141], v103 offset:3072
    ds_read_b64_tr_b16 v[142:143], v103 offset:3328
    s_waitcnt lgkmcnt(0)
    s_mov_b32 s8, s42
    s_mov_b32 s9, s43
    s_mov_b32 s10, 4194304
    s_add_u32 s3, s38, 0
    s_add_u32 m0, s36, 0
s_nop 0
    buffer_load_dwordx4 v100, s[8:11], s3 offen lds
    s_add_u32 s3, s38, 131072
    s_add_u32 m0, s36, 1024
s_nop 0
    buffer_load_dwordx4 v100, s[8:11], s3 offen lds
    s_add_u32 s3, s38, 262144
    s_add_u32 m0, s36, 2048
s_nop 0
    buffer_load_dwordx4 v100, s[8:11], s3 offen lds
    s_add_u32 s3, s38, 393216
    s_add_u32 m0, s36, 3072
s_nop 0
    buffer_load_dwordx4 v100, s[8:11], s3 offen lds
    s_waitcnt vmcnt(28)
    ds_read_b64_tr_b16 v[144:145], v103 offset:4096
    ds_read_b64_tr_b16 v[146:147], v103 offset:4352
    ds_read_b64_tr_b16 v[148:149], v103 offset:5120
    ds_read_b64_tr_b16 v[150:151], v103 offset:5376
    ds_read_b64_tr_b16 v[152:153], v103 offset:6144
    ds_read_b64_tr_b16 v[154:155], v103 offset:6400
    ds_read_b64_tr_b16 v[156:157], v103 offset:7168
    ds_read_b64_tr_b16 v[158:159], v103 offset:7424
    s_waitcnt lgkmcnt(0)
    s_add_u32 s3, s38, 524288
    s_add_u32 m0, s36, 4096
s_nop 0
    buffer_load_dwordx4 v100, s[8:11], s3 offen lds
    s_add_u32 s3, s38, 655360
    s_add_u32 m0, s36, 5120
s_nop 0
    buffer_load_dwordx4 v100, s[8:11], s3 offen lds
    s_add_u32 s3, s38, 786432
    s_add_u32 m0, s36, 6144
s_nop 0
    buffer_load_dwordx4 v100, s[8:11], s3 offen lds
    s_add_u32 s3, s38, 917504
    s_add_u32 m0, s36, 7168
s_nop 0
    buffer_load_dwordx4 v100, s[8:11], s3 offen lds
    s_waitcnt vmcnt(28)
    ds_read_b64_tr_b16 v[160:161], v103 offset:8192
    ds_read_b64_tr_b16 v[162:163], v103 offset:8448
    ds_read_b64_tr_b16 v[164:165], v103 offset:9216
    ds_read_b64_tr_b16 v[166:167], v103 offset:9472
    ds_read_b64_tr_b16 v[168:169], v103 offset:10240
    ds_read_b64_tr_b16 v[170:171], v103 offset:10496
    ds_read_b64_tr_b16 v[172:173], v103 offset:11264
    ds_read_b64_tr_b16 v[174:175], v103 offset:11520
    s_waitcnt lgkmcnt(0)
    s_add_u32 s3, s38, 1048576
    s_add_u32 m0, s36, 8192
s_nop 0
    buffer_load_dwordx4 v100, s[8:11], s3 offen lds
    s_add_u32 s3, s38, 1179648
    s_add_u32 m0, s36, 9216
s_nop 0
    buffer_load_dwordx4 v100, s[8:11], s3 offen lds
    s_add_u32 s3, s38, 1310720
    s_add_u32 m0, s36, 10240
s_nop 0
    buffer_load_dwordx4 v100, s[8:11], s3 offen lds
    s_add_u32 s3, s38, 1441792
    s_add_u32 m0, s36, 11264
s_nop 0
    buffer_load_dwordx4 v100, s[8:11], s3 offen lds
    s_waitcnt vmcnt(28)
    ds_read_b64_tr_b16 v[176:177], v103 offset:12288
    ds_read_b64_tr_b16 v[178:179], v103 offset:12544
    ds_read_b64_tr_b16 v[180:181], v103 offset:13312
    ds_read_b64_tr_b16 v[182:183], v103 offset:13568
    ds_read_b64_tr_b16 v[184:185], v103 offset:14336
    ds_read_b64_tr_b16 v[186:187], v103 offset:14592
    ds_read_b64_tr_b16 v[188:189], v103 offset:15360
    ds_read_b64_tr_b16 v[190:191], v103 offset:15616
    s_waitcnt lgkmcnt(0)
    s_add_u32 s3, s38, 1572864
    s_add_u32 m0, s36, 12288
s_nop 0
    buffer_load_dwordx4 v100, s[8:11], s3 offen lds
    s_add_u32 s3, s38, 1703936
    s_add_u32 m0, s36, 13312
s_nop 0
    buffer_load_dwordx4 v100, s[8:11], s3 offen lds
    s_add_u32 s3, s38, 1835008
    s_add_u32 m0, s36, 14336
s_nop 0
    buffer_load_dwordx4 v100, s[8:11], s3 offen lds
    s_add_u32 s3, s38, 1966080
    s_add_u32 m0, s36, 15360
s_nop 0
    buffer_load_dwordx4 v100, s[8:11], s3 offen lds
    s_waitcnt vmcnt(28)
    ds_read_b64_tr_b16 v[192:193], v104 offset:16384
    ds_read_b64_tr_b16 v[194:195], v104 offset:16896
    ds_read_b64_tr_b16 v[208:209], v104 offset:17408
    ds_read_b64_tr_b16 v[210:211], v104 offset:17920
    ds_read_b64_tr_b16 v[224:225], v104 offset:18432
    ds_read_b64_tr_b16 v[226:227], v104 offset:18944
    ds_read_b64_tr_b16 v[240:241], v104 offset:19456
    ds_read_b64_tr_b16 v[242:243], v104 offset:19968
    s_waitcnt lgkmcnt(0)
    s_add_u32 s3, s38, 2097152
    s_add_u32 m0, s36, 16384
s_nop 0
    buffer_load_dwordx4 v100, s[8:11], s3 offen lds
    s_add_u32 s3, s38, 2228224
    s_add_u32 m0, s36, 17408
s_nop 0
    buffer_load_dwordx4 v100, s[8:11], s3 offen lds
    s_add_u32 s3, s38, 2359296
    s_add_u32 m0, s36, 18432
s_nop 0
    buffer_load_dwordx4 v100, s[8:11], s3 offen lds
    s_add_u32 s3, s38, 2490368
    s_add_u32 m0, s36, 19456
s_nop 0
    buffer_load_dwordx4 v100, s[8:11], s3 offen lds
    s_waitcnt vmcnt(28)
    ds_read_b64_tr_b16 v[196:197], v104 offset:20480
    ds_read_b64_tr_b16 v[198:199], v104 offset:20992
    ds_read_b64_tr_b16 v[212:213], v104 offset:21504
    ds_read_b64_tr_b16 v[214:215], v104 offset:22016
    ds_read_b64_tr_b16 v[228:229], v104 offset:22528
    ds_read_b64_tr_b16 v[230:231], v104 offset:23040
    ds_read_b64_tr_b16 v[244:245], v104 offset:23552
    ds_read_b64_tr_b16 v[246:247], v104 offset:24064
    s_waitcnt lgkmcnt(0)
    s_add_u32 s3, s38, 2621440
    s_add_u32 m0, s36, 20480
s_nop 0
    buffer_load_dwordx4 v100, s[8:11], s3 offen lds
    s_add_u32 s3, s38, 2752512
    s_add_u32 m0, s36, 21504
s_nop 0
    buffer_load_dwordx4 v100, s[8:11], s3 offen lds
    s_add_u32 s3, s38, 2883584
    s_add_u32 m0, s36, 22528
s_nop 0
    buffer_load_dwordx4 v100, s[8:11], s3 offen lds
    s_add_u32 s3, s38, 3014656
    s_add_u32 m0, s36, 23552
s_nop 0
    buffer_load_dwordx4 v100, s[8:11], s3 offen lds
    s_waitcnt vmcnt(28)
    ds_read_b64_tr_b16 v[200:201], v104 offset:24576
    ds_read_b64_tr_b16 v[202:203], v104 offset:25088
    ds_read_b64_tr_b16 v[216:217], v104 offset:25600
    ds_read_b64_tr_b16 v[218:219], v104 offset:26112
    ds_read_b64_tr_b16 v[232:233], v104 offset:26624
    ds_read_b64_tr_b16 v[234:235], v104 offset:27136
    ds_read_b64_tr_b16 v[248:249], v104 offset:27648
    ds_read_b64_tr_b16 v[250:251], v104 offset:28160
    s_waitcnt lgkmcnt(0)
    s_add_u32 s3, s38, 3145728
    s_add_u32 m0, s36, 24576
s_nop 0
    buffer_load_dwordx4 v100, s[8:11], s3 offen lds
    s_add_u32 s3, s38, 3276800
    s_add_u32 m0, s36, 25600
s_nop 0
    buffer_load_dwordx4 v100, s[8:11], s3 offen lds
    s_add_u32 s3, s38, 3407872
    s_add_u32 m0, s36, 26624
s_nop 0
    buffer_load_dwordx4 v100, s[8:11], s3 offen lds
    s_add_u32 s3, s38, 3538944
    s_add_u32 m0, s36, 27648
s_nop 0
    buffer_load_dwordx4 v100, s[8:11], s3 offen lds
    s_waitcnt vmcnt(28)
    ds_read_b64_tr_b16 v[204:205], v104 offset:28672
    ds_read_b64_tr_b16 v[206:207], v104 offset:29184
    ds_read_b64_tr_b16 v[220:221], v104 offset:29696
    ds_read_b64_tr_b16 v[222:223], v104 offset:30208
    ds_read_b64_tr_b16 v[236:237], v104 offset:30720
    ds_read_b64_tr_b16 v[238:239], v104 offset:31232
    ds_read_b64_tr_b16 v[252:253], v104 offset:31744
    ds_read_b64_tr_b16 v[254:255], v104 offset:32256
    s_waitcnt lgkmcnt(0)
    s_add_u32 s3, s38, 3670016
    s_add_u32 m0, s36, 28672
s_nop 0
    buffer_load_dwordx4 v100, s[8:11], s3 offen lds
    s_add_u32 s3, s38, 3801088
    s_add_u32 m0, s36, 29696
s_nop 0
    buffer_load_dwordx4 v100, s[8:11], s3 offen lds
    s_add_u32 s3, s38, 3932160
    s_add_u32 m0, s36, 30720
s_nop 0
    buffer_load_dwordx4 v100, s[8:11], s3 offen lds
    s_add_u32 s3, s38, 4063232
    s_add_u32 m0, s36, 31744
s_nop 0
    buffer_load_dwordx4 v100, s[8:11], s3 offen lds
    s_waitcnt vmcnt(28)
    ds_read_b64_tr_b16 a[0:1], v103 offset:0
    ds_read_b64_tr_b16 a[2:3], v103 offset:256
    ds_read_b64_tr_b16 a[4:5], v103 offset:1024
    ds_read_b64_tr_b16 a[6:7], v103 offset:1280
    ds_read_b64_tr_b16 a[8:9], v103 offset:2048
    ds_read_b64_tr_b16 a[10:11], v103 offset:2304
    ds_read_b64_tr_b16 a[12:13], v103 offset:3072
    ds_read_b64_tr_b16 a[14:15], v103 offset:3328
    s_waitcnt lgkmcnt(0)
    s_mov_b32 s8, s48
    s_mov_b32 s9, s49
    s_mov_b32 s10, 4194304
    s_add_u32 s3, s39, 0
    s_add_u32 m0, s36, 0
s_nop 0
    buffer_load_dwordx4 v101, s[8:11], s3 offen lds
    s_add_u32 s3, s39, 64
    s_add_u32 m0, s36, 1024
s_nop 0
    buffer_load_dwordx4 v101, s[8:11], s3 offen lds
    s_add_u32 s3, s39, 128
    s_add_u32 m0, s36, 2048
s_nop 0
    buffer_load_dwordx4 v101, s[8:11], s3 offen lds
    s_add_u32 s3, s39, 192
    s_add_u32 m0, s36, 3072
s_nop 0
    buffer_load_dwordx4 v101, s[8:11], s3 offen lds
    s_waitcnt vmcnt(28)
    ds_read_b64_tr_b16 a[16:17], v103 offset:4096
    ds_read_b64_tr_b16 a[18:19], v103 offset:4352
    ds_read_b64_tr_b16 a[20:21], v103 offset:5120
    ds_read_b64_tr_b16 a[22:23], v103 offset:5376
    ds_read_b64_tr_b16 a[24:25], v103 offset:6144
    ds_read_b64_tr_b16 a[26:27], v103 offset:6400
    ds_read_b64_tr_b16 a[28:29], v103 offset:7168
    ds_read_b64_tr_b16 a[30:31], v103 offset:7424
    s_waitcnt lgkmcnt(0)
    s_add_u32 s3, s39, 16384
    s_add_u32 m0, s36, 4096
s_nop 0
    buffer_load_dwordx4 v101, s[8:11], s3 offen lds
    s_add_u32 s3, s39, 16448
    s_add_u32 m0, s36, 5120
s_nop 0
    buffer_load_dwordx4 v101, s[8:11], s3 offen lds
    s_add_u32 s3, s39, 16512
    s_add_u32 m0, s36, 6144
s_nop 0
    buffer_load_dwordx4 v101, s[8:11], s3 offen lds
    s_add_u32 s3, s39, 16576
    s_add_u32 m0, s36, 7168
s_nop 0
    buffer_load_dwordx4 v101, s[8:11], s3 offen lds
    s_waitcnt vmcnt(28)
    ds_read_b64_tr_b16 a[32:33], v103 offset:8192
    ds_read_b64_tr_b16 a[34:35], v103 offset:8448
    ds_read_b64_tr_b16 a[36:37], v103 offset:9216
    ds_read_b64_tr_b16 a[38:39], v103 offset:9472
    ds_read_b64_tr_b16 a[40:41], v103 offset:10240
    ds_read_b64_tr_b16 a[42:43], v103 offset:10496
    ds_read_b64_tr_b16 a[44:45], v103 offset:11264
    ds_read_b64_tr_b16 a[46:47], v103 offset:11520
    s_waitcnt lgkmcnt(0)
    s_add_u32 s3, s39, 32768
    s_add_u32 m0, s36, 8192
s_nop 0
    buffer_load_dwordx4 v101, s[8:11], s3 offen lds
    s_add_u32 s3, s39, 32832
    s_add_u32 m0, s36, 9216
s_nop 0
    buffer_load_dwordx4 v101, s[8:11], s3 offen lds
    s_add_u32 s3, s39, 32896
    s_add_u32 m0, s36, 10240
s_nop 0
    buffer_load_dwordx4 v101, s[8:11], s3 offen lds
    s_add_u32 s3, s39, 32960
    s_add_u32 m0, s36, 11264
s_nop 0
    buffer_load_dwordx4 v101, s[8:11], s3 offen lds
    s_waitcnt vmcnt(28)
    ds_read_b64_tr_b16 a[48:49], v103 offset:12288
    ds_read_b64_tr_b16 a[50:51], v103 offset:12544
    ds_read_b64_tr_b16 a[52:53], v103 offset:13312
    ds_read_b64_tr_b16 a[54:55], v103 offset:13568
    ds_read_b64_tr_b16 a[56:57], v103 offset:14336
    ds_read_b64_tr_b16 a[58:59], v103 offset:14592
    ds_read_b64_tr_b16 a[60:61], v103 offset:15360
    ds_read_b64_tr_b16 a[62:63], v103 offset:15616
    s_waitcnt lgkmcnt(0)
    s_add_u32 s3, s39, 49152
    s_add_u32 m0, s36, 12288
s_nop 0
    buffer_load_dwordx4 v101, s[8:11], s3 offen lds
    s_add_u32 s3, s39, 49216
    s_add_u32 m0, s36, 13312
s_nop 0
    buffer_load_dwordx4 v101, s[8:11], s3 offen lds
    s_add_u32 s3, s39, 49280
    s_add_u32 m0, s36, 14336
s_nop 0
    buffer_load_dwordx4 v101, s[8:11], s3 offen lds
    s_add_u32 s3, s39, 49344
    s_add_u32 m0, s36, 15360
s_nop 0
    buffer_load_dwordx4 v101, s[8:11], s3 offen lds
    s_waitcnt vmcnt(28)
    ds_read_b64_tr_b16 a[64:65], v103 offset:16384
    ds_read_b64_tr_b16 a[66:67], v103 offset:16640
    ds_read_b64_tr_b16 a[68:69], v103 offset:17408
    ds_read_b64_tr_b16 a[70:71], v103 offset:17664
    ds_read_b64_tr_b16 a[72:73], v103 offset:18432
    ds_read_b64_tr_b16 a[74:75], v103 offset:18688
    ds_read_b64_tr_b16 a[76:77], v103 offset:19456
    ds_read_b64_tr_b16 a[78:79], v103 offset:19712
    s_waitcnt lgkmcnt(0)
    s_add_u32 s3, s39, 65536
    s_add_u32 m0, s36, 16384
s_nop 0
    buffer_load_dwordx4 v101, s[8:11], s3 offen lds
    s_add_u32 s3, s39, 65600
    s_add_u32 m0, s36, 17408
s_nop 0
    buffer_load_dwordx4 v101, s[8:11], s3 offen lds
    s_add_u32 s3, s39, 65664
    s_add_u32 m0, s36, 18432
s_nop 0
    buffer_load_dwordx4 v101, s[8:11], s3 offen lds
    s_add_u32 s3, s39, 65728
    s_add_u32 m0, s36, 19456
s_nop 0
    buffer_load_dwordx4 v101, s[8:11], s3 offen lds
    s_waitcnt vmcnt(28)
    ds_read_b64_tr_b16 a[80:81], v103 offset:20480
    ds_read_b64_tr_b16 a[82:83], v103 offset:20736
    ds_read_b64_tr_b16 a[84:85], v103 offset:21504
    ds_read_b64_tr_b16 a[86:87], v103 offset:21760
    ds_read_b64_tr_b16 a[88:89], v103 offset:22528
    ds_read_b64_tr_b16 a[90:91], v103 offset:22784
    ds_read_b64_tr_b16 a[92:93], v103 offset:23552
    ds_read_b64_tr_b16 a[94:95], v103 offset:23808
    s_waitcnt lgkmcnt(0)
    s_add_u32 s3, s39, 81920
    s_add_u32 m0, s36, 20480
s_nop 0
    buffer_load_dwordx4 v101, s[8:11], s3 offen lds
    s_add_u32 s3, s39, 81984
    s_add_u32 m0, s36, 21504
s_nop 0
    buffer_load_dwordx4 v101, s[8:11], s3 offen lds
    s_add_u32 s3, s39, 82048
    s_add_u32 m0, s36, 22528
s_nop 0
    buffer_load_dwordx4 v101, s[8:11], s3 offen lds
    s_add_u32 s3, s39, 82112
    s_add_u32 m0, s36, 23552
s_nop 0
    buffer_load_dwordx4 v101, s[8:11], s3 offen lds
    s_waitcnt vmcnt(28)
    ds_read_b64_tr_b16 a[96:97], v103 offset:24576
    ds_read_b64_tr_b16 a[98:99], v103 offset:24832
    ds_read_b64_tr_b16 a[100:101], v103 offset:25600
    ds_read_b64_tr_b16 a[102:103], v103 offset:25856
    ds_read_b64_tr_b16 a[104:105], v103 offset:26624
    ds_read_b64_tr_b16 a[106:107], v103 offset:26880
    ds_read_b64_tr_b16 a[108:109], v103 offset:27648
    ds_read_b64_tr_b16 a[110:111], v103 offset:27904
    s_waitcnt lgkmcnt(0)
    s_add_u32 s3, s39, 98304
    s_add_u32 m0, s36, 24576
s_nop 0
    buffer_load_dwordx4 v101, s[8:11], s3 offen lds
    s_add_u32 s3, s39, 98368
    s_add_u32 m0, s36, 25600
s_nop 0
    buffer_load_dwordx4 v101, s[8:11], s3 offen lds
    s_add_u32 s3, s39, 98432
    s_add_u32 m0, s36, 26624
s_nop 0
    buffer_load_dwordx4 v101, s[8:11], s3 offen lds
    s_add_u32 s3, s39, 98496
    s_add_u32 m0, s36, 27648
s_nop 0
    buffer_load_dwordx4 v101, s[8:11], s3 offen lds
    s_waitcnt vmcnt(28)
    ds_read_b64_tr_b16 a[112:113], v103 offset:28672
    ds_read_b64_tr_b16 a[114:115], v103 offset:28928
    ds_read_b64_tr_b16 a[116:117], v103 offset:29696
    ds_read_b64_tr_b16 a[118:119], v103 offset:29952
    ds_read_b64_tr_b16 a[120:121], v103 offset:30720
    ds_read_b64_tr_b16 a[122:123], v103 offset:30976
    ds_read_b64_tr_b16 a[124:125], v103 offset:31744
    ds_read_b64_tr_b16 a[126:127], v103 offset:32000
    s_waitcnt lgkmcnt(0)
    s_add_u32 s3, s39, 114688
    s_add_u32 m0, s36, 28672
s_nop 0
    buffer_load_dwordx4 v101, s[8:11], s3 offen lds
    s_add_u32 s3, s39, 114752
    s_add_u32 m0, s36, 29696
s_nop 0
    buffer_load_dwordx4 v101, s[8:11], s3 offen lds
    s_add_u32 s3, s39, 114816
    s_add_u32 m0, s36, 30720
s_nop 0
    buffer_load_dwordx4 v101, s[8:11], s3 offen lds
    s_add_u32 s3, s39, 114880
    s_add_u32 m0, s36, 31744
s_nop 0
    buffer_load_dwordx4 v101, s[8:11], s3 offen lds
    s_waitcnt vmcnt(28)
    ds_read_b64_tr_b16 a[128:129], v104 offset:0
    ds_read_b64_tr_b16 a[130:131], v104 offset:512
    ds_read_b64_tr_b16 a[160:161], v104 offset:1024
    ds_read_b64_tr_b16 a[162:163], v104 offset:1536
    ds_read_b64_tr_b16 a[192:193], v104 offset:2048
    ds_read_b64_tr_b16 a[194:195], v104 offset:2560
    ds_read_b64_tr_b16 a[224:225], v104 offset:3072
    ds_read_b64_tr_b16 a[226:227], v104 offset:3584
    s_waitcnt lgkmcnt(0)
    s_waitcnt vmcnt(24)
    ds_read_b64_tr_b16 a[132:133], v104 offset:4096
    ds_read_b64_tr_b16 a[134:135], v104 offset:4608
    ds_read_b64_tr_b16 a[164:165], v104 offset:5120
    ds_read_b64_tr_b16 a[166:167], v104 offset:5632
    ds_read_b64_tr_b16 a[196:197], v104 offset:6144
    ds_read_b64_tr_b16 a[198:199], v104 offset:6656
    ds_read_b64_tr_b16 a[228:229], v104 offset:7168
    ds_read_b64_tr_b16 a[230:231], v104 offset:7680
    s_waitcnt lgkmcnt(0)
    s_waitcnt vmcnt(20)
    ds_read_b64_tr_b16 a[136:137], v104 offset:8192
    ds_read_b64_tr_b16 a[138:139], v104 offset:8704
    ds_read_b64_tr_b16 a[168:169], v104 offset:9216
    ds_read_b64_tr_b16 a[170:171], v104 offset:9728
    ds_read_b64_tr_b16 a[200:201], v104 offset:10240
    ds_read_b64_tr_b16 a[202:203], v104 offset:10752
    ds_read_b64_tr_b16 a[232:233], v104 offset:11264
    ds_read_b64_tr_b16 a[234:235], v104 offset:11776
    s_waitcnt lgkmcnt(0)
    s_waitcnt vmcnt(16)
    ds_read_b64_tr_b16 a[140:141], v104 offset:12288
    ds_read_b64_tr_b16 a[142:143], v104 offset:12800
    ds_read_b64_tr_b16 a[172:173], v104 offset:13312
    ds_read_b64_tr_b16 a[174:175], v104 offset:13824
    ds_read_b64_tr_b16 a[204:205], v104 offset:14336
    ds_read_b64_tr_b16 a[206:207], v104 offset:14848
    ds_read_b64_tr_b16 a[236:237], v104 offset:15360
    ds_read_b64_tr_b16 a[238:239], v104 offset:15872
    s_waitcnt lgkmcnt(0)
    s_waitcnt vmcnt(12)
    ds_read_b64_tr_b16 a[144:145], v104 offset:16384
    ds_read_b64_tr_b16 a[146:147], v104 offset:16896
    ds_read_b64_tr_b16 a[176:177], v104 offset:17408
    ds_read_b64_tr_b16 a[178:179], v104 offset:17920
    ds_read_b64_tr_b16 a[208:209], v104 offset:18432
    ds_read_b64_tr_b16 a[210:211], v104 offset:18944
    ds_read_b64_tr_b16 a[240:241], v104 offset:19456
    ds_read_b64_tr_b16 a[242:243], v104 offset:19968
    s_waitcnt lgkmcnt(0)
    s_waitcnt vmcnt(8)
    ds_read_b64_tr_b16 a[148:149], v104 offset:20480
    ds_read_b64_tr_b16 a[150:151], v104 offset:20992
    ds_read_b64_tr_b16 a[180:181], v104 offset:21504
    ds_read_b64_tr_b16 a[182:183], v104 offset:22016
    ds_read_b64_tr_b16 a[212:213], v104 offset:22528
    ds_read_b64_tr_b16 a[214:215], v104 offset:23040
    ds_read_b64_tr_b16 a[244:245], v104 offset:23552
    ds_read_b64_tr_b16 a[246:247], v104 offset:24064
    s_waitcnt lgkmcnt(0)
    s_waitcnt vmcnt(4)
    ds_read_b64_tr_b16 a[152:153], v104 offset:24576
    ds_read_b64_tr_b16 a[154:155], v104 offset:25088
    ds_read_b64_tr_b16 a[184:185], v104 offset:25600
    ds_read_b64_tr_b16 a[186:187], v104 offset:26112
    ds_read_b64_tr_b16 a[216:217], v104 offset:26624
    ds_read_b64_tr_b16 a[218:219], v104 offset:27136
    ds_read_b64_tr_b16 a[248:249], v104 offset:27648
    ds_read_b64_tr_b16 a[250:251], v104 offset:28160
    s_waitcnt lgkmcnt(0)
    s_waitcnt vmcnt(0)
    ds_read_b64_tr_b16 a[156:157], v104 offset:28672
    ds_read_b64_tr_b16 a[158:159], v104 offset:29184
    ds_read_b64_tr_b16 a[188:189], v104 offset:29696
    ds_read_b64_tr_b16 a[190:191], v104 offset:30208
    ds_read_b64_tr_b16 a[220:221], v104 offset:30720
    ds_read_b64_tr_b16 a[222:223], v104 offset:31232
    ds_read_b64_tr_b16 a[252:253], v104 offset:31744
    ds_read_b64_tr_b16 a[254:255], v104 offset:32256
    s_waitcnt lgkmcnt(0)
    s_cmp_lg_u32 s14, 21
    s_cbranch_scc1 WZ2_127
    v_mov_b64 v[200:201], 0
    v_mov_b64 v[202:203], 0
    v_mov_b64 v[204:205], 0
    v_mov_b64 v[206:207], 0
    v_mov_b64 v[216:217], 0
    v_mov_b64 v[218:219], 0
    v_mov_b64 v[220:221], 0
    v_mov_b64 v[222:223], 0
    v_mov_b64 v[232:233], 0
    v_mov_b64 v[234:235], 0
    v_mov_b64 v[236:237], 0
    v_mov_b64 v[238:239], 0
    v_mov_b64 v[248:249], 0
    v_mov_b64 v[250:251], 0
    v_mov_b64 v[252:253], 0
    v_mov_b64 v[254:255], 0
WZ2_127:
    v_lshlrev_b32 v96, 4, v11
    s_lshl_b32 s3, s15, 8
    s_add_u32 s3, s3, 80743424
    buffer_load_dwordx4 v[32:35], v96, s[4:7], s3 offen offset:0 sc1
    buffer_load_dwordx4 v[36:39], v96, s[4:7], s3 offen offset:32 sc1
    buffer_load_dwordx4 v[40:43], v96, s[4:7], s3 offen offset:64 sc1
    buffer_load_dwordx4 v[44:47], v96, s[4:7], s3 offen offset:96 sc1
    buffer_load_dwordx4 v[48:51], v96, s[4:7], s3 offen offset:128 sc1
    buffer_load_dwordx4 v[52:55], v96, s[4:7], s3 offen offset:160 sc1
    buffer_load_dwordx4 v[56:59], v96, s[4:7], s3 offen offset:192 sc1
    buffer_load_dwordx4 v[60:63], v96, s[4:7], s3 offen offset:224 sc1
    buffer_load_dwordx4 v[64:67], v96, s[4:7], s3 offen offset:1024 sc1
    buffer_load_dwordx4 v[68:71], v96, s[4:7], s3 offen offset:1056 sc1
    buffer_load_dwordx4 v[72:75], v96, s[4:7], s3 offen offset:1088 sc1
    buffer_load_dwordx4 v[76:79], v96, s[4:7], s3 offen offset:1120 sc1
    buffer_load_dwordx4 v[80:83], v96, s[4:7], s3 offen offset:1152 sc1
    buffer_load_dwordx4 v[84:87], v96, s[4:7], s3 offen offset:1184 sc1
    buffer_load_dwordx4 v[88:91], v96, s[4:7], s3 offen offset:1216 sc1
    buffer_load_dwordx4 v[92:95], v96, s[4:7], s3 offen offset:1248 sc1
    s_lshl_b32 s3, s14, 5
    s_add_u32 s3, s3, 80742400
    buffer_load_dwordx4 v[100:103], v96, s[4:7], s3 offen sc1
    buffer_load_dwordx4 v[104:107], v96, s[4:7], s3 offen offset:3072 sc1
    v_lshlrev_b32 v96, 3, v11
    v_and_b32 v97, 31, v0
    v_sub_u32 v96, v97, v96
    v_mov_b32 v97, 0x3f80
    v_mov_b32 v98, 0x3f800000
    v_cmp_eq_u32 vcc, 0, v96
s_nop 1
    v_cndmask_b32 v124, 0, v97, vcc
    v_cmp_eq_u32 vcc, 1, v96
s_nop 1
    v_cndmask_b32 v124, v124, v98, vcc
    v_cmp_eq_u32 vcc, 2, v96
s_nop 1
    v_cndmask_b32 v125, 0, v97, vcc
    v_cmp_eq_u32 vcc, 3, v96
s_nop 1
    v_cndmask_b32 v125, v125, v98, vcc
    v_cmp_eq_u32 vcc, 4, v96
s_nop 1
    v_cndmask_b32 v126, 0, v97, vcc
    v_cmp_eq_u32 vcc, 5, v96
s_nop 1
    v_cndmask_b32 v126, v126, v98, vcc
    v_cmp_eq_u32 vcc, 6, v96
s_nop 1
    v_cndmask_b32 v127, 0, v97, vcc
    v_cmp_eq_u32 vcc, 7, v96
s_nop 1
    v_cndmask_b32 v127, v127, v98, vcc
    s_barrier
    ds_write_b128 v112, v[124:127] offset:43008
    s_waitcnt vmcnt(0)
    v_and_b32 v1, 0xffff0000, v100
    v_lshlrev_b32 v0, 16, v100
    v_and_b32 v3, 0xffff0000, v101
    v_lshlrev_b32 v2, 16, v101
    v_and_b32 v5, 0xffff0000, v102
    v_lshlrev_b32 v4, 16, v102
    v_and_b32 v7, 0xffff0000, v103
    v_lshlrev_b32 v6, 16, v103
    v_and_b32 v9, 0xffff0000, v104
    v_lshlrev_b32 v8, 16, v104
    v_and_b32 v11, 0xffff0000, v105
    v_lshlrev_b32 v10, 16, v105
    v_and_b32 v13, 0xffff0000, v106
    v_lshlrev_b32 v12, 16, v106
    v_and_b32 v15, 0xffff0000, v107
    v_lshlrev_b32 v14, 16, v107
    ds_write_b128 v112, v[0:3] offset:61440
    ds_write_b128 v112, v[4:7] offset:62464
    ds_write_b128 v112, v[8:11] offset:63488
    ds_write_b128 v112, v[12:15] offset:64512
    s_waitcnt lgkmcnt(0)
    v_mfma_f32_32x32x16_bf16 v[0:15], v[128:131], v[32:35], 0
    v_mfma_f32_32x32x16_bf16 v[16:31], v[160:163], v[32:35], 0
    v_mfma_f32_32x32x16_bf16 v[0:15], v[132:135], v[36:39], v[0:15]
    v_mfma_f32_32x32x16_bf16 v[16:31], v[164:167], v[36:39], v[16:31]
    v_mfma_f32_32x32x16_bf16 v[0:15], v[136:139], v[40:43], v[0:15]
    v_mfma_f32_32x32x16_bf16 v[16:31], v[168:171], v[40:43], v[16:31]
    v_mfma_f32_32x32x16_bf16 v[0:15], v[140:143], v[44:47], v[0:15]
    v_mfma_f32_32x32x16_bf16 v[16:31], v[172:175], v[44:47], v[16:31]
    v_mfma_f32_32x32x16_bf16 v[0:15], v[144:147], v[48:51], v[0:15]
    v_mfma_f32_32x32x16_bf16 v[16:31], v[176:179], v[48:51], v[16:31]
    v_mfma_f32_32x32x16_bf16 v[0:15], v[148:151], v[52:55], v[0:15]
    v_mfma_f32_32x32x16_bf16 v[16:31], v[180:183], v[52:55], v[16:31]
    v_mfma_f32_32x32x16_bf16 v[0:15], v[152:155], v[56:59], v[0:15]
    v_mfma_f32_32x32x16_bf16 v[16:31], v[184:187], v[56:59], v[16:31]
    v_mfma_f32_32x32x16_bf16 v[0:15], v[156:159], v[60:63], v[0:15]
    v_mfma_f32_32x32x16_bf16 v[16:31], v[188:191], v[60:63], v[16:31]
s_nop 3
    ds_write_b128 v114, v[0:3] offset:32768
    ds_write_b128 v114, v[4:7] offset:33792
    ds_write_b128 v114, v[8:11] offset:40960
    ds_write_b128 v114, v[12:15] offset:41984
s_nop 3
    ds_write_b128 v114, v[16:19] offset:49152
    ds_write_b128 v114, v[20:23] offset:50176
    ds_write_b128 v114, v[24:27] offset:57344
    ds_write_b128 v114, v[28:31] offset:58368
    s_waitcnt lgkmcnt(0)
    s_barrier
    ds_read_b128 v[32:35], v115 offset:0
    ds_read_b128 v[36:39], v115 offset:1024
    ds_read_b128 v[40:43], v115 offset:2048
    ds_read_b128 v[44:47], v115 offset:3072
    ds_read_b128 v[48:51], v115 offset:4096
    ds_read_b128 v[52:55], v115 offset:5120
    ds_read_b128 v[56:59], v115 offset:6144
    ds_read_b128 v[60:63], v115 offset:7168
    s_waitcnt lgkmcnt(0)
    v_add_f32 v32, v32, v40
    v_add_f32 v48, v48, v56
    v_add_f32 v33, v33, v41
    v_add_f32 v49, v49, v57
    v_add_f32 v34, v34, v42
    v_add_f32 v50, v50, v58
    v_add_f32 v35, v35, v43
    v_add_f32 v51, v51, v59
    v_add_f32 v36, v36, v44
    v_add_f32 v52, v52, v60
    v_add_f32 v37, v37, v45
    v_add_f32 v53, v53, v61
    v_add_f32 v38, v38, v46
    v_add_f32 v54, v54, v62
    v_add_f32 v39, v39, v47
    v_add_f32 v55, v55, v63
    v_add_f32 v32, v32, v48
    v_add_f32 v33, v33, v49
    v_add_f32 v34, v34, v50
    v_add_f32 v35, v35, v51
    v_add_f32 v36, v36, v52
    v_add_f32 v37, v37, v53
    v_add_f32 v38, v38, v54
    v_add_f32 v39, v39, v55
    ds_write_b128 v116, v[32:35] offset:45056
    ds_write_b128 v116, v[36:39] offset:49152
    s_waitcnt lgkmcnt(0)
    s_barrier
    v_and_b32 v97, 0xffff0000, v64
    v_lshlrev_b32 v96, 16, v64
    v_and_b32 v99, 0xffff0000, v65
    v_lshlrev_b32 v98, 16, v65
    v_and_b32 v101, 0xffff0000, v66
    v_lshlrev_b32 v100, 16, v66
    v_and_b32 v103, 0xffff0000, v67
    v_lshlrev_b32 v102, 16, v67
    v_add_f32 v96, 1.0, v96
    v_add_f32 v97, 1.0, v97
    v_add_f32 v98, 1.0, v98
    v_add_f32 v99, 1.0, v99
    v_add_f32 v100, 1.0, v100
    v_add_f32 v101, 1.0, v101
    v_add_f32 v102, 1.0, v102
    v_add_f32 v103, 1.0, v103
    v_and_b32 v105, 0xffff0000, v128
    v_lshlrev_b32 v104, 16, v128
    v_and_b32 v107, 0xffff0000, v129
    v_lshlrev_b32 v106, 16, v129
    v_and_b32 v109, 0xffff0000, v130
    v_lshlrev_b32 v108, 16, v130
    v_and_b32 v111, 0xffff0000, v131
    v_lshlrev_b32 v110, 16, v131
    v_mul_f32 v104, v104, v96
    v_mul_f32 v105, v105, v97
    v_mul_f32 v106, v106, v98
    v_mul_f32 v107, v107, v99
    v_mul_f32 v108, v108, v100
    v_mul_f32 v109, v109, v101
    v_mul_f32 v110, v110, v102
    v_mul_f32 v111, v111, v103
    v_cvt_pk_bf16_f32 v128, v104, v105
    v_cvt_pk_bf16_f32 v129, v106, v107
    v_cvt_pk_bf16_f32 v130, v108, v109
    v_cvt_pk_bf16_f32 v131, v110, v111
    v_and_b32 v105, 0xffff0000, v160
    v_lshlrev_b32 v104, 16, v160
    v_and_b32 v107, 0xffff0000, v161
    v_lshlrev_b32 v106, 16, v161
    v_and_b32 v109, 0xffff0000, v162
    v_lshlrev_b32 v108, 16, v162
    v_and_b32 v111, 0xffff0000, v163
    v_lshlrev_b32 v110, 16, v163
    v_mul_f32 v104, v104, v96
    v_mul_f32 v105, v105, v97
    v_mul_f32 v106, v106, v98
    v_mul_f32 v107, v107, v99
    v_mul_f32 v108, v108, v100
    v_mul_f32 v109, v109, v101
    v_mul_f32 v110, v110, v102
    v_mul_f32 v111, v111, v103
    v_cvt_pk_bf16_f32 v160, v104, v105
    v_cvt_pk_bf16_f32 v161, v106, v107
    v_cvt_pk_bf16_f32 v162, v108, v109
    v_cvt_pk_bf16_f32 v163, v110, v111
    v_and_b32 v97, 0xffff0000, v68
    v_lshlrev_b32 v96, 16, v68
    v_and_b32 v99, 0xffff0000, v69
    v_lshlrev_b32 v98, 16, v69
    v_and_b32 v101, 0xffff0000, v70
    v_lshlrev_b32 v100, 16, v70
    v_and_b32 v103, 0xffff0000, v71
    v_lshlrev_b32 v102, 16, v71
    v_add_f32 v96, 1.0, v96
    v_add_f32 v97, 1.0, v97
    v_add_f32 v98, 1.0, v98
    v_add_f32 v99, 1.0, v99
    v_add_f32 v100, 1.0, v100
    v_add_f32 v101, 1.0, v101
    v_add_f32 v102, 1.0, v102
    v_add_f32 v103, 1.0, v103
    v_and_b32 v105, 0xffff0000, v132
    v_lshlrev_b32 v104, 16, v132
    v_and_b32 v107, 0xffff0000, v133
    v_lshlrev_b32 v106, 16, v133
    v_and_b32 v109, 0xffff0000, v134
    v_lshlrev_b32 v108, 16, v134
    v_and_b32 v111, 0xffff0000, v135
    v_lshlrev_b32 v110, 16, v135
    v_mul_f32 v104, v104, v96
    v_mul_f32 v105, v105, v97
    v_mul_f32 v106, v106, v98
    v_mul_f32 v107, v107, v99
    v_mul_f32 v108, v108, v100
    v_mul_f32 v109, v109, v101
    v_mul_f32 v110, v110, v102
    v_mul_f32 v111, v111, v103
    v_cvt_pk_bf16_f32 v132, v104, v105
    v_cvt_pk_bf16_f32 v133, v106, v107
    v_cvt_pk_bf16_f32 v134, v108, v109
    v_cvt_pk_bf16_f32 v135, v110, v111
    v_and_b32 v105, 0xffff0000, v164
    v_lshlrev_b32 v104, 16, v164
    v_and_b32 v107, 0xffff0000, v165
    v_lshlrev_b32 v106, 16, v165
    v_and_b32 v109, 0xffff0000, v166
    v_lshlrev_b32 v108, 16, v166
    v_and_b32 v111, 0xffff0000, v167
    v_lshlrev_b32 v110, 16, v167
    v_mul_f32 v104, v104, v96
    v_mul_f32 v105, v105, v97
    v_mul_f32 v106, v106, v98
    v_mul_f32 v107, v107, v99
    v_mul_f32 v108, v108, v100
    v_mul_f32 v109, v109, v101
    v_mul_f32 v110, v110, v102
    v_mul_f32 v111, v111, v103
    v_cvt_pk_bf16_f32 v164, v104, v105
    v_cvt_pk_bf16_f32 v165, v106, v107
    v_cvt_pk_bf16_f32 v166, v108, v109
    v_cvt_pk_bf16_f32 v167, v110, v111
    v_and_b32 v97, 0xffff0000, v72
    v_lshlrev_b32 v96, 16, v72
    v_and_b32 v99, 0xffff0000, v73
    v_lshlrev_b32 v98, 16, v73
    v_and_b32 v101, 0xffff0000, v74
    v_lshlrev_b32 v100, 16, v74
    v_and_b32 v103, 0xffff0000, v75
    v_lshlrev_b32 v102, 16, v75
    v_add_f32 v96, 1.0, v96
    v_add_f32 v97, 1.0, v97
    v_add_f32 v98, 1.0, v98
    v_add_f32 v99, 1.0, v99
    v_add_f32 v100, 1.0, v100
    v_add_f32 v101, 1.0, v101
    v_add_f32 v102, 1.0, v102
    v_add_f32 v103, 1.0, v103
    v_and_b32 v105, 0xffff0000, v136
    v_lshlrev_b32 v104, 16, v136
    v_and_b32 v107, 0xffff0000, v137
    v_lshlrev_b32 v106, 16, v137
    v_and_b32 v109, 0xffff0000, v138
    v_lshlrev_b32 v108, 16, v138
    v_and_b32 v111, 0xffff0000, v139
    v_lshlrev_b32 v110, 16, v139
    v_mul_f32 v104, v104, v96
    v_mul_f32 v105, v105, v97
    v_mul_f32 v106, v106, v98
    v_mul_f32 v107, v107, v99
    v_mul_f32 v108, v108, v100
    v_mul_f32 v109, v109, v101
    v_mul_f32 v110, v110, v102
    v_mul_f32 v111, v111, v103
    v_cvt_pk_bf16_f32 v136, v104, v105
    v_cvt_pk_bf16_f32 v137, v106, v107
    v_cvt_pk_bf16_f32 v138, v108, v109
    v_cvt_pk_bf16_f32 v139, v110, v111
    v_and_b32 v105, 0xffff0000, v168
    v_lshlrev_b32 v104, 16, v168
    v_and_b32 v107, 0xffff0000, v169
    v_lshlrev_b32 v106, 16, v169
    v_and_b32 v109, 0xffff0000, v170
    v_lshlrev_b32 v108, 16, v170
    v_and_b32 v111, 0xffff0000, v171
    v_lshlrev_b32 v110, 16, v171
    v_mul_f32 v104, v104, v96
    v_mul_f32 v105, v105, v97
    v_mul_f32 v106, v106, v98
    v_mul_f32 v107, v107, v99
    v_mul_f32 v108, v108, v100
    v_mul_f32 v109, v109, v101
    v_mul_f32 v110, v110, v102
    v_mul_f32 v111, v111, v103
    v_cvt_pk_bf16_f32 v168, v104, v105
    v_cvt_pk_bf16_f32 v169, v106, v107
    v_cvt_pk_bf16_f32 v170, v108, v109
    v_cvt_pk_bf16_f32 v171, v110, v111
    v_and_b32 v97, 0xffff0000, v76
    v_lshlrev_b32 v96, 16, v76
    v_and_b32 v99, 0xffff0000, v77
    v_lshlrev_b32 v98, 16, v77
    v_and_b32 v101, 0xffff0000, v78
    v_lshlrev_b32 v100, 16, v78
    v_and_b32 v103, 0xffff0000, v79
    v_lshlrev_b32 v102, 16, v79
    v_add_f32 v96, 1.0, v96
    v_add_f32 v97, 1.0, v97
    v_add_f32 v98, 1.0, v98
    v_add_f32 v99, 1.0, v99
    v_add_f32 v100, 1.0, v100
    v_add_f32 v101, 1.0, v101
    v_add_f32 v102, 1.0, v102
    v_add_f32 v103, 1.0, v103
    v_and_b32 v105, 0xffff0000, v140
    v_lshlrev_b32 v104, 16, v140
    v_and_b32 v107, 0xffff0000, v141
    v_lshlrev_b32 v106, 16, v141
    v_and_b32 v109, 0xffff0000, v142
    v_lshlrev_b32 v108, 16, v142
    v_and_b32 v111, 0xffff0000, v143
    v_lshlrev_b32 v110, 16, v143
    v_mul_f32 v104, v104, v96
    v_mul_f32 v105, v105, v97
    v_mul_f32 v106, v106, v98
    v_mul_f32 v107, v107, v99
    v_mul_f32 v108, v108, v100
    v_mul_f32 v109, v109, v101
    v_mul_f32 v110, v110, v102
    v_mul_f32 v111, v111, v103
    v_cvt_pk_bf16_f32 v140, v104, v105
    v_cvt_pk_bf16_f32 v141, v106, v107
    v_cvt_pk_bf16_f32 v142, v108, v109
    v_cvt_pk_bf16_f32 v143, v110, v111
    v_and_b32 v105, 0xffff0000, v172
    v_lshlrev_b32 v104, 16, v172
    v_and_b32 v107, 0xffff0000, v173
    v_lshlrev_b32 v106, 16, v173
    v_and_b32 v109, 0xffff0000, v174
    v_lshlrev_b32 v108, 16, v174
    v_and_b32 v111, 0xffff0000, v175
    v_lshlrev_b32 v110, 16, v175
    v_mul_f32 v104, v104, v96
    v_mul_f32 v105, v105, v97
    v_mul_f32 v106, v106, v98
    v_mul_f32 v107, v107, v99
    v_mul_f32 v108, v108, v100
    v_mul_f32 v109, v109, v101
    v_mul_f32 v110, v110, v102
    v_mul_f32 v111, v111, v103
    v_cvt_pk_bf16_f32 v172, v104, v105
    v_cvt_pk_bf16_f32 v173, v106, v107
    v_cvt_pk_bf16_f32 v174, v108, v109
    v_cvt_pk_bf16_f32 v175, v110, v111
    v_and_b32 v97, 0xffff0000, v80
    v_lshlrev_b32 v96, 16, v80
    v_and_b32 v99, 0xffff0000, v81
    v_lshlrev_b32 v98, 16, v81
    v_and_b32 v101, 0xffff0000, v82
    v_lshlrev_b32 v100, 16, v82
    v_and_b32 v103, 0xffff0000, v83
    v_lshlrev_b32 v102, 16, v83
    v_add_f32 v96, 1.0, v96
    v_add_f32 v97, 1.0, v97
    v_add_f32 v98, 1.0, v98
    v_add_f32 v99, 1.0, v99
    v_add_f32 v100, 1.0, v100
    v_add_f32 v101, 1.0, v101
    v_add_f32 v102, 1.0, v102
    v_add_f32 v103, 1.0, v103
    v_and_b32 v105, 0xffff0000, v144
    v_lshlrev_b32 v104, 16, v144
    v_and_b32 v107, 0xffff0000, v145
    v_lshlrev_b32 v106, 16, v145
    v_and_b32 v109, 0xffff0000, v146
    v_lshlrev_b32 v108, 16, v146
    v_and_b32 v111, 0xffff0000, v147
    v_lshlrev_b32 v110, 16, v147
    v_mul_f32 v104, v104, v96
    v_mul_f32 v105, v105, v97
    v_mul_f32 v106, v106, v98
    v_mul_f32 v107, v107, v99
    v_mul_f32 v108, v108, v100
    v_mul_f32 v109, v109, v101
    v_mul_f32 v110, v110, v102
    v_mul_f32 v111, v111, v103
    v_cvt_pk_bf16_f32 v144, v104, v105
    v_cvt_pk_bf16_f32 v145, v106, v107
    v_cvt_pk_bf16_f32 v146, v108, v109
    v_cvt_pk_bf16_f32 v147, v110, v111
    v_and_b32 v105, 0xffff0000, v176
    v_lshlrev_b32 v104, 16, v176
    v_and_b32 v107, 0xffff0000, v177
    v_lshlrev_b32 v106, 16, v177
    v_and_b32 v109, 0xffff0000, v178
    v_lshlrev_b32 v108, 16, v178
    v_and_b32 v111, 0xffff0000, v179
    v_lshlrev_b32 v110, 16, v179
    v_mul_f32 v104, v104, v96
    v_mul_f32 v105, v105, v97
    v_mul_f32 v106, v106, v98
    v_mul_f32 v107, v107, v99
    v_mul_f32 v108, v108, v100
    v_mul_f32 v109, v109, v101
    v_mul_f32 v110, v110, v102
    v_mul_f32 v111, v111, v103
    v_cvt_pk_bf16_f32 v176, v104, v105
    v_cvt_pk_bf16_f32 v177, v106, v107
    v_cvt_pk_bf16_f32 v178, v108, v109
    v_cvt_pk_bf16_f32 v179, v110, v111
    v_and_b32 v97, 0xffff0000, v84
    v_lshlrev_b32 v96, 16, v84
    v_and_b32 v99, 0xffff0000, v85
    v_lshlrev_b32 v98, 16, v85
    v_and_b32 v101, 0xffff0000, v86
    v_lshlrev_b32 v100, 16, v86
    v_and_b32 v103, 0xffff0000, v87
    v_lshlrev_b32 v102, 16, v87
    v_add_f32 v96, 1.0, v96
    v_add_f32 v97, 1.0, v97
    v_add_f32 v98, 1.0, v98
    v_add_f32 v99, 1.0, v99
    v_add_f32 v100, 1.0, v100
    v_add_f32 v101, 1.0, v101
    v_add_f32 v102, 1.0, v102
    v_add_f32 v103, 1.0, v103
    v_and_b32 v105, 0xffff0000, v148
    v_lshlrev_b32 v104, 16, v148
    v_and_b32 v107, 0xffff0000, v149
    v_lshlrev_b32 v106, 16, v149
    v_and_b32 v109, 0xffff0000, v150
    v_lshlrev_b32 v108, 16, v150
    v_and_b32 v111, 0xffff0000, v151
    v_lshlrev_b32 v110, 16, v151
    v_mul_f32 v104, v104, v96
    v_mul_f32 v105, v105, v97
    v_mul_f32 v106, v106, v98
    v_mul_f32 v107, v107, v99
    v_mul_f32 v108, v108, v100
    v_mul_f32 v109, v109, v101
    v_mul_f32 v110, v110, v102
    v_mul_f32 v111, v111, v103
    v_cvt_pk_bf16_f32 v148, v104, v105
    v_cvt_pk_bf16_f32 v149, v106, v107
    v_cvt_pk_bf16_f32 v150, v108, v109
    v_cvt_pk_bf16_f32 v151, v110, v111
    v_and_b32 v105, 0xffff0000, v180
    v_lshlrev_b32 v104, 16, v180
    v_and_b32 v107, 0xffff0000, v181
    v_lshlrev_b32 v106, 16, v181
    v_and_b32 v109, 0xffff0000, v182
    v_lshlrev_b32 v108, 16, v182
    v_and_b32 v111, 0xffff0000, v183
    v_lshlrev_b32 v110, 16, v183
    v_mul_f32 v104, v104, v96
    v_mul_f32 v105, v105, v97
    v_mul_f32 v106, v106, v98
    v_mul_f32 v107, v107, v99
    v_mul_f32 v108, v108, v100
    v_mul_f32 v109, v109, v101
    v_mul_f32 v110, v110, v102
    v_mul_f32 v111, v111, v103
    v_cvt_pk_bf16_f32 v180, v104, v105
    v_cvt_pk_bf16_f32 v181, v106, v107
    v_cvt_pk_bf16_f32 v182, v108, v109
    v_cvt_pk_bf16_f32 v183, v110, v111
    v_and_b32 v97, 0xffff0000, v88
    v_lshlrev_b32 v96, 16, v88
    v_and_b32 v99, 0xffff0000, v89
    v_lshlrev_b32 v98, 16, v89
    v_and_b32 v101, 0xffff0000, v90
    v_lshlrev_b32 v100, 16, v90
    v_and_b32 v103, 0xffff0000, v91
    v_lshlrev_b32 v102, 16, v91
    v_add_f32 v96, 1.0, v96
    v_add_f32 v97, 1.0, v97
    v_add_f32 v98, 1.0, v98
    v_add_f32 v99, 1.0, v99
    v_add_f32 v100, 1.0, v100
    v_add_f32 v101, 1.0, v101
    v_add_f32 v102, 1.0, v102
    v_add_f32 v103, 1.0, v103
    v_and_b32 v105, 0xffff0000, v152
    v_lshlrev_b32 v104, 16, v152
    v_and_b32 v107, 0xffff0000, v153
    v_lshlrev_b32 v106, 16, v153
    v_and_b32 v109, 0xffff0000, v154
    v_lshlrev_b32 v108, 16, v154
    v_and_b32 v111, 0xffff0000, v155
    v_lshlrev_b32 v110, 16, v155
    v_mul_f32 v104, v104, v96
    v_mul_f32 v105, v105, v97
    v_mul_f32 v106, v106, v98
    v_mul_f32 v107, v107, v99
    v_mul_f32 v108, v108, v100
    v_mul_f32 v109, v109, v101
    v_mul_f32 v110, v110, v102
    v_mul_f32 v111, v111, v103
    v_cvt_pk_bf16_f32 v152, v104, v105
    v_cvt_pk_bf16_f32 v153, v106, v107
    v_cvt_pk_bf16_f32 v154, v108, v109
    v_cvt_pk_bf16_f32 v155, v110, v111
    v_and_b32 v105, 0xffff0000, v184
    v_lshlrev_b32 v104, 16, v184
    v_and_b32 v107, 0xffff0000, v185
    v_lshlrev_b32 v106, 16, v185
    v_and_b32 v109, 0xffff0000, v186
    v_lshlrev_b32 v108, 16, v186
    v_and_b32 v111, 0xffff0000, v187
    v_lshlrev_b32 v110, 16, v187
    v_mul_f32 v104, v104, v96
    v_mul_f32 v105, v105, v97
    v_mul_f32 v106, v106, v98
    v_mul_f32 v107, v107, v99
    v_mul_f32 v108, v108, v100
    v_mul_f32 v109, v109, v101
    v_mul_f32 v110, v110, v102
    v_mul_f32 v111, v111, v103
    v_cvt_pk_bf16_f32 v184, v104, v105
    v_cvt_pk_bf16_f32 v185, v106, v107
    v_cvt_pk_bf16_f32 v186, v108, v109
    v_cvt_pk_bf16_f32 v187, v110, v111
    v_and_b32 v97, 0xffff0000, v92
    v_lshlrev_b32 v96, 16, v92
    v_and_b32 v99, 0xffff0000, v93
    v_lshlrev_b32 v98, 16, v93
    v_and_b32 v101, 0xffff0000, v94
    v_lshlrev_b32 v100, 16, v94
    v_and_b32 v103, 0xffff0000, v95
    v_lshlrev_b32 v102, 16, v95
    v_add_f32 v96, 1.0, v96
    v_add_f32 v97, 1.0, v97
    v_add_f32 v98, 1.0, v98
    v_add_f32 v99, 1.0, v99
    v_add_f32 v100, 1.0, v100
    v_add_f32 v101, 1.0, v101
    v_add_f32 v102, 1.0, v102
    v_add_f32 v103, 1.0, v103
    v_and_b32 v105, 0xffff0000, v156
    v_lshlrev_b32 v104, 16, v156
    v_and_b32 v107, 0xffff0000, v157
    v_lshlrev_b32 v106, 16, v157
    v_and_b32 v109, 0xffff0000, v158
    v_lshlrev_b32 v108, 16, v158
    v_and_b32 v111, 0xffff0000, v159
    v_lshlrev_b32 v110, 16, v159
    v_mul_f32 v104, v104, v96
    v_mul_f32 v105, v105, v97
    v_mul_f32 v106, v106, v98
    v_mul_f32 v107, v107, v99
    v_mul_f32 v108, v108, v100
    v_mul_f32 v109, v109, v101
    v_mul_f32 v110, v110, v102
    v_mul_f32 v111, v111, v103
    v_cvt_pk_bf16_f32 v156, v104, v105
    v_cvt_pk_bf16_f32 v157, v106, v107
    v_cvt_pk_bf16_f32 v158, v108, v109
    v_cvt_pk_bf16_f32 v159, v110, v111
    v_and_b32 v105, 0xffff0000, v188
    v_lshlrev_b32 v104, 16, v188
    v_and_b32 v107, 0xffff0000, v189
    v_lshlrev_b32 v106, 16, v189
    v_and_b32 v109, 0xffff0000, v190
    v_lshlrev_b32 v108, 16, v190
    v_and_b32 v111, 0xffff0000, v191
    v_lshlrev_b32 v110, 16, v191
    v_mul_f32 v104, v104, v96
    v_mul_f32 v105, v105, v97
    v_mul_f32 v106, v106, v98
    v_mul_f32 v107, v107, v99
    v_mul_f32 v108, v108, v100
    v_mul_f32 v109, v109, v101
    v_mul_f32 v110, v110, v102
    v_mul_f32 v111, v111, v103
    v_cvt_pk_bf16_f32 v188, v104, v105
    v_cvt_pk_bf16_f32 v189, v106, v107
    v_cvt_pk_bf16_f32 v190, v108, v109
    v_cvt_pk_bf16_f32 v191, v110, v111
    v_mov_b32 v96, 0x3f803f80
    v_mov_b32 v97, 0x3f803f80
    v_mov_b32 v98, 0x3f803f80
    v_mov_b32 v99, 0x3f803f80
s_nop 1
    v_mfma_f32_32x32x16_bf16 v[0:15], v[128:131], v[96:99], 0
    v_mfma_f32_32x32x16_bf16 v[16:31], v[160:163], v[96:99], 0
    v_mfma_f32_32x32x16_bf16 v[0:15], v[132:135], v[96:99], v[0:15]
    v_mfma_f32_32x32x16_bf16 v[16:31], v[164:167], v[96:99], v[16:31]
    v_mfma_f32_32x32x16_bf16 v[0:15], v[136:139], v[96:99], v[0:15]
    v_mfma_f32_32x32x16_bf16 v[16:31], v[168:171], v[96:99], v[16:31]
    v_mfma_f32_32x32x16_bf16 v[0:15], v[140:143], v[96:99], v[0:15]
    v_mfma_f32_32x32x16_bf16 v[16:31], v[172:175], v[96:99], v[16:31]
    v_mfma_f32_32x32x16_bf16 v[0:15], v[144:147], v[96:99], v[0:15]
    v_mfma_f32_32x32x16_bf16 v[16:31], v[176:179], v[96:99], v[16:31]
    v_mfma_f32_32x32x16_bf16 v[0:15], v[148:151], v[96:99], v[0:15]
    v_mfma_f32_32x32x16_bf16 v[16:31], v[180:183], v[96:99], v[16:31]
    v_mfma_f32_32x32x16_bf16 v[0:15], v[152:155], v[96:99], v[0:15]
    v_mfma_f32_32x32x16_bf16 v[16:31], v[184:187], v[96:99], v[16:31]
    v_mfma_f32_32x32x16_bf16 v[0:15], v[156:159], v[96:99], v[0:15]
    v_mfma_f32_32x32x16_bf16 v[16:31], v[188:191], v[96:99], v[16:31]
s_nop 3
    ds_write_b128 v114, v[0:3] offset:32768
    ds_write_b128 v114, v[4:7] offset:33792
    ds_write_b128 v114, v[8:11] offset:40960
    ds_write_b128 v114, v[12:15] offset:41984
s_nop 3
    ds_write_b128 v114, v[16:19] offset:49152
    ds_write_b128 v114, v[20:23] offset:50176
    ds_write_b128 v114, v[24:27] offset:57344
    ds_write_b128 v114, v[28:31] offset:58368
    s_waitcnt lgkmcnt(0)
    s_barrier
    ds_read_b128 v[32:35], v115 offset:0
    ds_read_b128 v[36:39], v115 offset:1024
    ds_read_b128 v[40:43], v115 offset:2048
    ds_read_b128 v[44:47], v115 offset:3072
    ds_read_b128 v[48:51], v115 offset:4096
    ds_read_b128 v[52:55], v115 offset:5120
    ds_read_b128 v[56:59], v115 offset:6144
    ds_read_b128 v[60:63], v115 offset:7168
    s_waitcnt lgkmcnt(0)
    v_add_f32 v32, v32, v40
    v_add_f32 v48, v48, v56
    v_add_f32 v33, v33, v41
    v_add_f32 v49, v49, v57
    v_add_f32 v34, v34, v42
    v_add_f32 v50, v50, v58
    v_add_f32 v35, v35, v43
    v_add_f32 v51, v51, v59
    v_add_f32 v36, v36, v44
    v_add_f32 v52, v52, v60
    v_add_f32 v37, v37, v45
    v_add_f32 v53, v53, v61
    v_add_f32 v38, v38, v46
    v_add_f32 v54, v54, v62
    v_add_f32 v39, v39, v47
    v_add_f32 v55, v55, v63
    v_add_f32 v32, v32, v48
    v_add_f32 v33, v33, v49
    v_add_f32 v34, v34, v50
    v_add_f32 v35, v35, v51
    v_add_f32 v36, v36, v52
    v_add_f32 v37, v37, v53
    v_add_f32 v38, v38, v54
    v_add_f32 v39, v39, v55
    ds_write_b128 v116, v[32:35] offset:53248
    ds_write_b128 v116, v[36:39] offset:57344
    s_waitcnt lgkmcnt(0)
    s_barrier

    s_mov_b32 s16, 0
    s_lshl_b32 s20, s17, 15
    s_lshl_b32 s3, s15, 13
    s_add_u32 s20, s20, s3
    s_add_u32 s20, s20, 60817408
    s_lshl_b32 s3, s17, 5
    s_add_u32 s3, s3, s14
    s_mul_i32 s21, s3, 16384
    s_add_u32 s21, s21, 1048576
    s_lshl_b32 s22, s3, 12
    s_lshl_b32 s3, s15, 10
    s_add_u32 s22, s22, s3
    s_add_u32 s22, s22, 52428800
    s_lshl_b32 s37, s15, 13

    s_lshl_b32 s3, s17, 20
    s_lshl_b32 s24, s15, 18
    s_lshl_b32 s28, s14, 10
    s_add_u32 s24, s24, s28
    s_add_u32 s24, s24, s3
    s_add_u32 s24, s24, 62914560
    s_lshl_b32 s25, s14, 15
    s_add_u32 s25, s25, s3
    s_mul_i32 s32, s15, 6144
    s_add_u32 s32, s32, s25
    s_add_u32 s32, s32, 71303168
    s_lshl_b32 s3, s15, 13
    s_add_u32 s25, s25, s3
    s_add_u32 s25, s25, 62914560
    s_lshl_b32 s26, s17, 16
    s_add_u32 s26, s26, 79691776
    s_add_u32 s33, s26, s28
    s_add_u32 s26, s26, s3
    s_lshl_b32 s27, s17, 15
    s_lshl_b32 s3, s14, 5
    s_add_u32 s27, s27, s3
    s_lshl_b32 s34, s15, 7
    s_lshl_b32 s3, s14, 2
    s_add_u32 s60, s23, s3
    s_add_u32 s34, s34, s60
    s_lshr_b32 s35, s14, 3
    s_lshl_b32 s35, s35, 7
    s_add_u32 s35, s35, s23
    s_lshl_b32 s3, s15, 5
    s_add_u32 s61, s35, s3
    s_add_u32 s62, s23, s3
    s_mul_i32 s63, s15, 24
    s_add_u32 s39, s63, 20
    s_min_u32 s39, s39, 84
    s_mov_b32 s31, 0x3e0293ee

    s_add_u32 s3, s17, 1
    s_lshl_b32 s3, s3, 3
    v_mov_b32 v0, s3
    global_load_dwordx2 v[0:1], v0, s[12:13] sc1
    s_add_u32 m0, s37, 0
    s_add_u32 s3, s20, 0
    buffer_load_dwordx4 v112, s[4:7], s3 offen offset:0 sc1 lds
    buffer_load_dwordx4 v112, s[4:7], s3 offen offset:1024 sc1 lds
    buffer_load_dwordx4 v112, s[4:7], s3 offen offset:2048 sc1 lds
    buffer_load_dwordx4 v112, s[4:7], s3 offen offset:3072 sc1 lds
    s_add_u32 m0, s37, 4096
    s_add_u32 s3, s20, 4096
    buffer_load_dwordx4 v112, s[4:7], s3 offen offset:0 sc1 lds
    buffer_load_dwordx4 v112, s[4:7], s3 offen offset:1024 sc1 lds
    buffer_load_dwordx4 v112, s[4:7], s3 offen offset:2048 sc1 lds
    buffer_load_dwordx4 v112, s[4:7], s3 offen offset:3072 sc1 lds
    s_add_u32 s20, s20, 229376
    s_waitcnt vmcnt(0)
    s_barrier

    s_getreg_b32 s3, hwreg(HW_REG_XCC_ID)
    s_and_b32 s3, s3, 7
    s_mul_i32 s3, s3, 6
    s_lshl_b64 vcc, 32, s3
    v_cmp_ne_u64 vcc, vcc, v[0:1]
    s_cbranch_vccnz WSAFE_128
WL_129:
    s_add_u32 s16, s16, 1
    ds_read_b128 v[32:35], v112 offset:0
    ds_read_b128 v[36:39], v112 offset:1024
    ds_read_b128 v[40:43], v112 offset:2048
    ds_read_b128 v[44:47], v112 offset:3072
    ds_read_b128 v[48:51], v112 offset:4096
    ds_read_b128 v[52:55], v112 offset:5120
    s_add_u32 s3, s21, 4096
    buffer_load_dwordx4 v[0:3], v117, s[4:7], s21 offen offset:0
    buffer_load_dwordx4 v[4:7], v117, s[4:7], s21 offen offset:512
    buffer_load_dwordx4 v[8:11], v117, s[4:7], s21 offen offset:2048
    buffer_load_dwordx4 v[12:15], v117, s[4:7], s21 offen offset:2560
    buffer_load_dwordx4 v[16:19], v117, s[4:7], s3 offen offset:0
    buffer_load_dwordx4 v[20:23], v117, s[4:7], s3 offen offset:512
    buffer_load_dwordx4 v[24:27], v117, s[4:7], s3 offen offset:2048
    buffer_load_dwordx4 v[28:31], v117, s[4:7], s3 offen offset:2560
    buffer_load_dwordx4 v[96:99], v118, s[4:7], s21 offen offset:0
    buffer_load_dwordx4 v[100:103], v118, s[4:7], s21 offen offset:512
    buffer_load_dwordx4 v[124:127], v122, s[64:67], s27 offen
    s_waitcnt lgkmcnt(5)
    v_mfma_f32_32x32x16_bf16 v[80:95], a[0:3], v[32:35], 0
    ds_read_b128 v[56:59], v112 offset:6144
    s_waitcnt lgkmcnt(5)
    v_mfma_f32_32x32x16_bf16 v[80:95], a[4:7], v[36:39], v[80:95]
    ds_read_b128 v[60:63], v112 offset:7168
    s_waitcnt lgkmcnt(5)
    v_mfma_f32_32x32x16_bf16 v[80:95], a[8:11], v[40:43], v[80:95]
    ds_read_b128 v[32:35], v112 offset:8192
    s_waitcnt lgkmcnt(5)
    v_mfma_f32_32x32x16_bf16 v[80:95], a[12:15], v[44:47], v[80:95]
    ds_read_b128 v[36:39], v112 offset:9216
    s_waitcnt lgkmcnt(5)
    v_mfma_f32_32x32x16_bf16 v[80:95], a[16:19], v[48:51], v[80:95]
    ds_read_b128 v[40:43], v112 offset:10240
    s_waitcnt lgkmcnt(5)
    v_mfma_f32_32x32x16_bf16 v[80:95], a[20:23], v[52:55], v[80:95]
    ds_read_b128 v[44:47], v112 offset:11264
    s_waitcnt lgkmcnt(5)
    v_mfma_f32_32x32x16_bf16 v[80:95], a[24:27], v[56:59], v[80:95]
    ds_read_b128 v[48:51], v112 offset:12288
    s_waitcnt lgkmcnt(5)
    v_mfma_f32_32x32x16_bf16 v[80:95], a[28:31], v[60:63], v[80:95]
    ds_read_b128 v[52:55], v112 offset:13312
    s_waitcnt lgkmcnt(5)
    v_mfma_f32_32x32x16_bf16 v[80:95], a[32:35], v[32:35], v[80:95]
    ds_read_b128 v[56:59], v112 offset:14336
    s_waitcnt lgkmcnt(5)
    v_mfma_f32_32x32x16_bf16 v[80:95], a[36:39], v[36:39], v[80:95]
    ds_read_b128 v[60:63], v112 offset:15360
    s_waitcnt lgkmcnt(5)
    v_mfma_f32_32x32x16_bf16 v[80:95], a[40:43], v[40:43], v[80:95]
    ds_read_b128 v[32:35], v112 offset:16384
    s_waitcnt lgkmcnt(5)
    v_mfma_f32_32x32x16_bf16 v[80:95], a[44:47], v[44:47], v[80:95]
    ds_read_b128 v[36:39], v112 offset:17408
    s_waitcnt lgkmcnt(5)
    v_mfma_f32_32x32x16_bf16 v[80:95], a[48:51], v[48:51], v[80:95]
    ds_read_b128 v[40:43], v112 offset:18432
    s_waitcnt lgkmcnt(5)
    v_mfma_f32_32x32x16_bf16 v[80:95], a[52:55], v[52:55], v[80:95]
    ds_read_b128 v[44:47], v112 offset:19456
    s_waitcnt lgkmcnt(5)
    v_mfma_f32_32x32x16_bf16 v[80:95], a[56:59], v[56:59], v[80:95]
    ds_read_b128 v[48:51], v112 offset:20480
    s_waitcnt lgkmcnt(5)
    v_mfma_f32_32x32x16_bf16 v[80:95], a[60:63], v[60:63], v[80:95]
    ds_read_b128 v[52:55], v112 offset:21504
    s_waitcnt lgkmcnt(5)
    v_mfma_f32_32x32x16_bf16 v[80:95], a[64:67], v[32:35], v[80:95]
    ds_read_b128 v[56:59], v112 offset:22528
    s_waitcnt lgkmcnt(5)
    v_mfma_f32_32x32x16_bf16 v[80:95], a[68:71], v[36:39], v[80:95]
    ds_read_b128 v[60:63], v112 offset:23552
    s_waitcnt lgkmcnt(5)
    v_mfma_f32_32x32x16_bf16 v[80:95], a[72:75], v[40:43], v[80:95]
    ds_read_b128 v[32:35], v112 offset:24576
    s_waitcnt lgkmcnt(5)
    v_mfma_f32_32x32x16_bf16 v[80:95], a[76:79], v[44:47], v[80:95]
    ds_read_b128 v[36:39], v112 offset:25600
    s_waitcnt lgkmcnt(5)
    v_mfma_f32_32x32x16_bf16 v[80:95], a[80:83], v[48:51], v[80:95]
    ds_read_b128 v[40:43], v112 offset:26624
    s_waitcnt lgkmcnt(5)
    v_mfma_f32_32x32x16_bf16 v[80:95], a[84:87], v[52:55], v[80:95]
    ds_read_b128 v[44:47], v112 offset:27648
    s_waitcnt lgkmcnt(5)
    v_mfma_f32_32x32x16_bf16 v[80:95], a[88:91], v[56:59], v[80:95]
    ds_read_b128 v[48:51], v112 offset:28672
    s_waitcnt lgkmcnt(5)
    v_mfma_f32_32x32x16_bf16 v[80:95], a[92:95], v[60:63], v[80:95]
    ds_read_b128 v[52:55], v112 offset:29696
    s_waitcnt lgkmcnt(5)
    v_mfma_f32_32x32x16_bf16 v[80:95], a[96:99], v[32:35], v[80:95]
    ds_read_b128 v[56:59], v112 offset:30720
    s_waitcnt lgkmcnt(5)
    v_mfma_f32_32x32x16_bf16 v[80:95], a[100:103], v[36:39], v[80:95]
    ds_read_b128 v[60:63], v112 offset:31744
    s_waitcnt lgkmcnt(5)
    v_mfma_f32_32x32x16_bf16 v[80:95], a[104:107], v[40:43], v[80:95]
    s_waitcnt lgkmcnt(4)
    v_mfma_f32_32x32x16_bf16 v[80:95], a[108:111], v[44:47], v[80:95]
    s_waitcnt lgkmcnt(3)
    v_mfma_f32_32x32x16_bf16 v[80:95], a[112:115], v[48:51], v[80:95]
    s_waitcnt lgkmcnt(2)
    v_mfma_f32_32x32x16_bf16 v[80:95], a[116:119], v[52:55], v[80:95]
    s_waitcnt lgkmcnt(1)
    v_mfma_f32_32x32x16_bf16 v[80:95], a[120:123], v[56:59], v[80:95]
    s_waitcnt lgkmcnt(0)
    v_mfma_f32_32x32x16_bf16 v[80:95], a[124:127], v[60:63], v[80:95]
s_nop 11
    v_cvt_pk_bf16_f32 v80, v80, v81
    v_cvt_pk_bf16_f32 v81, v82, v83
    v_cvt_pk_bf16_f32 v82, v84, v85
    v_cvt_pk_bf16_f32 v83, v86, v87
    v_cvt_pk_bf16_f32 v84, v88, v89
    v_cvt_pk_bf16_f32 v85, v90, v91
    v_cvt_pk_bf16_f32 v86, v92, v93
    v_cvt_pk_bf16_f32 v87, v94, v95
    ds_write_b128 v114, v[80:83] offset:0
    ds_write_b128 v114, v[84:87] offset:1024
    s_waitcnt lgkmcnt(0)
    s_barrier
    ds_read_b128 v[32:35], v113 offset:0
    ds_read_b128 v[36:39], v113 offset:1024
    ds_read_b128 v[40:43], v113 offset:2048
    ds_read_b128 v[44:47], v113 offset:3072
    ds_read_b128 v[48:51], v113 offset:4096
    ds_read_b128 v[52:55], v113 offset:5120
    ds_read_b128 v[56:59], v113 offset:6144
    ds_read_b128 v[60:63], v113 offset:7168
    s_waitcnt vmcnt(0)
    s_add_u32 m0, s37, 0
    s_add_u32 s3, s20, 0
    buffer_load_dwordx4 v112, s[4:7], s3 offen offset:0 sc1 lds
    buffer_load_dwordx4 v112, s[4:7], s3 offen offset:1024 sc1 lds
    buffer_load_dwordx4 v112, s[4:7], s3 offen offset:2048 sc1 lds
    buffer_load_dwordx4 v112, s[4:7], s3 offen offset:3072 sc1 lds
    s_add_u32 m0, s37, 4096
    s_add_u32 s3, s20, 4096
    buffer_load_dwordx4 v112, s[4:7], s3 offen offset:0 sc1 lds
    buffer_load_dwordx4 v112, s[4:7], s3 offen offset:1024 sc1 lds
    buffer_load_dwordx4 v112, s[4:7], s3 offen offset:2048 sc1 lds
    buffer_load_dwordx4 v112, s[4:7], s3 offen offset:3072 sc1 lds
    s_add_u32 s20, s20, 229376
    s_waitcnt lgkmcnt(7)
    v_mfma_f32_32x32x16_bf16 v[64:79], v[0:3], v[32:35], 0
    s_waitcnt lgkmcnt(6)
    v_mfma_f32_32x32x16_bf16 v[64:79], v[4:7], v[36:39], v[64:79]
    s_waitcnt lgkmcnt(5)
    v_mfma_f32_32x32x16_bf16 v[64:79], v[8:11], v[40:43], v[64:79]
    s_waitcnt lgkmcnt(4)
    v_mfma_f32_32x32x16_bf16 v[64:79], v[12:15], v[44:47], v[64:79]
    s_waitcnt lgkmcnt(3)
    v_mfma_f32_32x32x16_bf16 v[64:79], v[16:19], v[48:51], v[64:79]
    s_waitcnt lgkmcnt(2)
    v_mfma_f32_32x32x16_bf16 v[64:79], v[20:23], v[52:55], v[64:79]
    s_waitcnt lgkmcnt(1)
    v_mfma_f32_32x32x16_bf16 v[64:79], v[24:27], v[56:59], v[64:79]
    s_waitcnt lgkmcnt(0)
    v_mfma_f32_32x32x16_bf16 v[64:79], v[28:31], v[60:63], v[64:79]
    v_mov_b32 v108, 0xf149f2ca
    v_mov_b64 v[106:107], 0
    v_cmp_le_i32 vcc, 0, v123
s_nop 8
    v_cndmask_b32 v64, v108, v64, vcc
    v_cmp_le_i32 vcc, 1, v123
s_nop 1
    v_cndmask_b32 v65, v108, v65, vcc
    v_cmp_le_i32 vcc, 2, v123
s_nop 1
    v_cndmask_b32 v66, v108, v66, vcc
    v_cmp_le_i32 vcc, 3, v123
s_nop 1
    v_cndmask_b32 v67, v108, v67, vcc
    v_cmp_le_i32 vcc, 8, v123
s_nop 1
    v_cndmask_b32 v68, v108, v68, vcc
    v_cmp_le_i32 vcc, 9, v123
s_nop 1
    v_cndmask_b32 v69, v108, v69, vcc
    v_cmp_le_i32 vcc, 10, v123
s_nop 1
    v_cndmask_b32 v70, v108, v70, vcc
    v_cmp_le_i32 vcc, 11, v123
s_nop 1
    v_cndmask_b32 v71, v108, v71, vcc
    v_cmp_le_i32 vcc, 16, v123
s_nop 1
    v_cndmask_b32 v72, v108, v72, vcc
    v_cmp_le_i32 vcc, 17, v123
s_nop 1
    v_cndmask_b32 v73, v108, v73, vcc
    v_cmp_le_i32 vcc, 18, v123
s_nop 1
    v_cndmask_b32 v74, v108, v74, vcc
    v_cmp_le_i32 vcc, 19, v123
s_nop 1
    v_cndmask_b32 v75, v108, v75, vcc
    v_cmp_le_i32 vcc, 24, v123
s_nop 1
    v_cndmask_b32 v76, v108, v76, vcc
    v_cmp_le_i32 vcc, 25, v123
s_nop 1
    v_cndmask_b32 v77, v108, v77, vcc
    v_cmp_le_i32 vcc, 26, v123
s_nop 1
    v_cndmask_b32 v78, v108, v78, vcc
    v_cmp_le_i32 vcc, 27, v123
s_nop 1
    v_cndmask_b32 v79, v108, v79, vcc
    v_max3_f32 v110, v64, v65, v66
    v_max3_f32 v110, v110, v67, v68
    v_max3_f32 v110, v110, v69, v70
    v_max3_f32 v110, v110, v71, v72
    v_max3_f32 v110, v110, v73, v74
    v_max3_f32 v110, v110, v75, v76
    v_max3_f32 v110, v110, v77, v78
    v_max_f32 v110, v110, v79
    s_branch WK_131
WK_130:
    s_sleep 4
WK_131:
    buffer_load_dwordx2 v[108:109], v112, s[4:7], s22 offen sc1
    buffer_load_dwordx2 v[104:105], v119, s[4:7], s22 offen sc1
    s_sub_u32 s30, s30, 1
    s_cbranch_scc1 L_abort
    s_waitcnt vmcnt(0)
    ds_write_b64 v120, v[108:109] offset:32768
    v_max3_u32 v111, v108, v109, v104
    v_max_u32 v111, v111, v105
    v_cmp_eq_u32 vcc, -1, v111
    s_cbranch_vccnz WK_130
    s_waitcnt lgkmcnt(0)
    s_barrier
    ds_read_b64_tr_b16 v[0:1], v121 offset:32768
    ds_read_b64_tr_b16 v[2:3], v121 offset:32896
    ds_read_b64_tr_b16 v[4:5], v121 offset:33024
    ds_read_b64_tr_b16 v[6:7], v121 offset:33152
    ds_read_b64_tr_b16 v[8:9], v121 offset:33280
    ds_read_b64_tr_b16 v[10:11], v121 offset:33408
    ds_read_b64_tr_b16 v[12:13], v121 offset:33536
    ds_read_b64_tr_b16 v[14:15], v121 offset:33664
    ds_read_b64_tr_b16 v[16:17], v121 offset:33792
    ds_read_b64_tr_b16 v[18:19], v121 offset:33920
    ds_read_b64_tr_b16 v[20:21], v121 offset:34048
    ds_read_b64_tr_b16 v[22:23], v121 offset:34176
    ds_read_b64_tr_b16 v[24:25], v121 offset:34304
    ds_read_b64_tr_b16 v[26:27], v121 offset:34432
    ds_read_b64_tr_b16 v[28:29], v121 offset:34560
    ds_read_b64_tr_b16 v[30:31], v121 offset:34688
    s_waitcnt lgkmcnt(14)
    v_mfma_f32_32x32x16_bf16 v[80:95], v[0:3], v[32:35], 0
    s_waitcnt lgkmcnt(12)
    v_mfma_f32_32x32x16_bf16 v[80:95], v[4:7], v[36:39], v[80:95]
    s_waitcnt lgkmcnt(10)
    v_mfma_f32_32x32x16_bf16 v[80:95], v[8:11], v[40:43], v[80:95]
    s_waitcnt lgkmcnt(8)
    v_mfma_f32_32x32x16_bf16 v[80:95], v[12:15], v[44:47], v[80:95]
    s_waitcnt lgkmcnt(6)
    v_mfma_f32_32x32x16_bf16 v[80:95], v[16:19], v[48:51], v[80:95]
    s_waitcnt lgkmcnt(4)
    v_mfma_f32_32x32x16_bf16 v[80:95], v[20:23], v[52:55], v[80:95]
    s_waitcnt lgkmcnt(2)
    v_mfma_f32_32x32x16_bf16 v[80:95], v[24:27], v[56:59], v[80:95]
    s_waitcnt lgkmcnt(0)
    v_mfma_f32_32x32x16_bf16 v[80:95], v[28:31], v[60:63], v[80:95]
s_nop 11
    v_max3_f32 v110, v110, v80, v81
    v_max3_f32 v110, v110, v82, v83
    v_mov_b32 v108, v110
s_nop 1
    v_permlane32_swap_b32 v110, v108
    v_max_f32 v110, v110, v108
    v_mul_f32 v110, s31, v110
    v_fma_f32 v64, v64, s31, -v110
    v_fma_f32 v65, v65, s31, -v110
    v_fma_f32 v66, v66, s31, -v110
    v_fma_f32 v67, v67, s31, -v110
    v_fma_f32 v68, v68, s31, -v110
    v_fma_f32 v69, v69, s31, -v110
    v_fma_f32 v70, v70, s31, -v110
    v_fma_f32 v71, v71, s31, -v110
    v_fma_f32 v72, v72, s31, -v110
    v_fma_f32 v73, v73, s31, -v110
    v_fma_f32 v74, v74, s31, -v110
    v_fma_f32 v75, v75, s31, -v110
    v_fma_f32 v76, v76, s31, -v110
    v_fma_f32 v77, v77, s31, -v110
    v_fma_f32 v78, v78, s31, -v110
    v_fma_f32 v79, v79, s31, -v110
    v_fma_f32 v80, v80, s31, -v110
    v_fma_f32 v81, v81, s31, -v110
    v_fma_f32 v82, v82, s31, -v110
    v_fma_f32 v83, v83, s31, -v110
    v_exp_f32 v64, v64
    v_exp_f32 v65, v65
    v_exp_f32 v66, v66
    v_add_f32 v108, v64, v65
    v_exp_f32 v67, v67
    v_add_f32 v108, v108, v66
    v_exp_f32 v68, v68
    v_add_f32 v108, v108, v67
    v_exp_f32 v69, v69
    v_add_f32 v108, v108, v68
    v_exp_f32 v70, v70
    v_add_f32 v108, v108, v69
    v_exp_f32 v71, v71
    v_add_f32 v108, v108, v70
    v_exp_f32 v72, v72
    v_add_f32 v108, v108, v71
    v_exp_f32 v73, v73
    v_add_f32 v108, v108, v72
    v_exp_f32 v74, v74
    v_add_f32 v108, v108, v73
    v_exp_f32 v75, v75
    v_add_f32 v108, v108, v74
    v_exp_f32 v76, v76
    v_add_f32 v108, v108, v75
    v_exp_f32 v77, v77
    v_add_f32 v108, v108, v76
    v_exp_f32 v78, v78
    v_add_f32 v108, v108, v77
    v_exp_f32 v79, v79
    v_add_f32 v108, v108, v78
    v_exp_f32 v80, v80
    v_add_f32 v108, v108, v79
    v_exp_f32 v81, v81
    v_add_f32 v108, v108, v80
    v_exp_f32 v82, v82
    v_add_f32 v108, v108, v81
    v_exp_f32 v83, v83
    v_add_f32 v108, v108, v82
    v_add_f32 v108, v108, v83
    v_cvt_pk_bf16_f32 v64, v64, v65
    v_cvt_pk_bf16_f32 v65, v66, v67
    v_cvt_pk_bf16_f32 v66, v68, v69
    v_cvt_pk_bf16_f32 v67, v70, v71
    v_cvt_pk_bf16_f32 v68, v72, v73
    v_cvt_pk_bf16_f32 v69, v74, v75
    v_cvt_pk_bf16_f32 v70, v76, v77
    v_cvt_pk_bf16_f32 v71, v78, v79
    v_cvt_pk_bf16_f32 v72, v80, v81
    v_cvt_pk_bf16_f32 v73, v82, v83
    v_mov_b64 v[74:75], 0
    v_mfma_f32_32x32x16_bf16 v[0:15], v[96:99], v[64:67], 0
    v_mov_b32 v109, v108
s_nop 1
    v_permlane32_swap_b32 v108, v109
    v_add_f32 v108, v108, v109
    v_mfma_f32_32x32x16_bf16 v[0:15], v[100:103], v[68:71], v[0:15]
    v_rcp_f32 v108, v108
    v_mfma_f32_32x32x16_bf16 v[0:15], v[104:107], v[72:75], v[0:15]
s_nop 11
    v_mul_f32 v0, v0, v108
    v_mul_f32 v1, v1, v108
    v_mul_f32 v2, v2, v108
    v_mul_f32 v3, v3, v108
    v_mul_f32 v4, v4, v108
    v_mul_f32 v5, v5, v108
    v_mul_f32 v6, v6, v108
    v_mul_f32 v7, v7, v108
    v_mul_f32 v8, v8, v108
    v_mul_f32 v9, v9, v108
    v_mul_f32 v10, v10, v108
    v_mul_f32 v11, v11, v108
    v_mul_f32 v12, v12, v108
    v_mul_f32 v13, v13, v108
    v_mul_f32 v14, v14, v108
    v_mul_f32 v15, v15, v108
    v_cvt_pk_bf16_f32 v0, v0, v1
    v_cvt_pk_bf16_f32 v1, v2, v3
    v_cvt_pk_bf16_f32 v2, v4, v5
    v_cvt_pk_bf16_f32 v3, v6, v7
    v_cvt_pk_bf16_f32 v4, v8, v9
    v_cvt_pk_bf16_f32 v5, v10, v11
    v_cvt_pk_bf16_f32 v6, v12, v13
    v_cvt_pk_bf16_f32 v7, v14, v15
    ds_write_b128 v114, v[0:3] offset:8192
    ds_write_b128 v114, v[4:7] offset:9216
    s_waitcnt lgkmcnt(0)
    s_barrier
    ds_read_b128 v[32:35], v113 offset:8192
    ds_read_b128 v[36:39], v113 offset:9216
    ds_read_b128 v[40:43], v113 offset:10240
    ds_read_b128 v[44:47], v113 offset:11264
    ds_read_b128 v[48:51], v113 offset:12288
    ds_read_b128 v[52:55], v113 offset:13312
    ds_read_b128 v[56:59], v113 offset:14336
    ds_read_b128 v[60:63], v113 offset:15360
    ds_read_b128 v[96:99], v112 offset:43008
    s_waitcnt lgkmcnt(8)
    v_mfma_f32_32x32x16_bf16 v[0:15], a[128:131], v[32:35], 0
    s_waitcnt lgkmcnt(7)
    v_mfma_f32_32x32x16_bf16 v[0:15], a[132:135], v[36:39], v[0:15]
    s_waitcnt lgkmcnt(6)
    v_mfma_f32_32x32x16_bf16 v[0:15], a[136:139], v[40:43], v[0:15]
    s_waitcnt lgkmcnt(5)
    v_mfma_f32_32x32x16_bf16 v[0:15], a[140:143], v[44:47], v[0:15]
    s_waitcnt lgkmcnt(4)
    v_mfma_f32_32x32x16_bf16 v[0:15], a[144:147], v[48:51], v[0:15]
    s_waitcnt lgkmcnt(3)
    v_mfma_f32_32x32x16_bf16 v[0:15], a[148:151], v[52:55], v[0:15]
    s_waitcnt lgkmcnt(2)
    v_mfma_f32_32x32x16_bf16 v[0:15], a[152:155], v[56:59], v[0:15]
    s_waitcnt lgkmcnt(1)
    v_mfma_f32_32x32x16_bf16 v[0:15], a[156:159], v[60:63], v[0:15]
    v_mfma_f32_32x32x16_bf16 v[16:31], a[160:163], v[32:35], 0
    v_mfma_f32_32x32x16_bf16 v[16:31], a[164:167], v[36:39], v[16:31]
    v_cvt_pk_bf16_f32 v80, v0, v1
    v_cvt_pk_bf16_f32 v81, v2, v3
    v_cvt_pk_bf16_f32 v82, v4, v5
    v_cvt_pk_bf16_f32 v83, v6, v7
    s_add_u32 s3, s24, 0
    buffer_store_dwordx4 v[80:83], v112, s[4:7], s3 offen
    v_mfma_f32_32x32x16_bf16 v[16:31], a[168:171], v[40:43], v[16:31]
    v_cvt_pk_bf16_f32 v84, v8, v9
    v_cvt_pk_bf16_f32 v85, v10, v11
    v_cvt_pk_bf16_f32 v86, v12, v13
    v_cvt_pk_bf16_f32 v87, v14, v15
    s_add_u32 s3, s24, 32768
    buffer_store_dwordx4 v[84:87], v112, s[4:7], s3 offen
    v_mfma_f32_32x32x16_bf16 v[16:31], a[172:175], v[44:47], v[16:31]
    v_mfma_f32_32x32x16_bf16 v[16:31], a[176:179], v[48:51], v[16:31]
    v_mfma_f32_32x32x16_bf16 v[16:31], a[180:183], v[52:55], v[16:31]
    v_mfma_f32_32x32x16_bf16 v[16:31], a[184:187], v[56:59], v[16:31]
    v_mfma_f32_32x32x16_bf16 v[16:31], a[188:191], v[60:63], v[16:31]
    v_mfma_f32_32x32x16_bf16 v[0:15], a[192:195], v[32:35], 0
    v_mfma_f32_32x32x16_bf16 v[0:15], a[196:199], v[36:39], v[0:15]
    v_cvt_pk_bf16_f32 v88, v16, v17
    v_cvt_pk_bf16_f32 v89, v18, v19
    v_cvt_pk_bf16_f32 v90, v20, v21
    v_cvt_pk_bf16_f32 v91, v22, v23
    s_add_u32 s3, s24, 65536
    buffer_store_dwordx4 v[88:91], v112, s[4:7], s3 offen
    v_mfma_f32_32x32x16_bf16 v[0:15], a[200:203], v[40:43], v[0:15]
    v_cvt_pk_bf16_f32 v92, v24, v25
    v_cvt_pk_bf16_f32 v93, v26, v27
    v_cvt_pk_bf16_f32 v94, v28, v29
    v_cvt_pk_bf16_f32 v95, v30, v31
    s_add_u32 s3, s24, 98304
    buffer_store_dwordx4 v[92:95], v112, s[4:7], s3 offen
    v_mfma_f32_32x32x16_bf16 v[0:15], a[204:207], v[44:47], v[0:15]
    v_mfma_f32_32x32x16_bf16 v[0:15], a[208:211], v[48:51], v[0:15]
    v_mfma_f32_32x32x16_bf16 v[0:15], a[212:215], v[52:55], v[0:15]
    v_mfma_f32_32x32x16_bf16 v[0:15], a[216:219], v[56:59], v[0:15]
    v_mfma_f32_32x32x16_bf16 v[0:15], a[220:223], v[60:63], v[0:15]
    v_mfma_f32_32x32x16_bf16 v[16:31], a[224:227], v[32:35], 0
    v_mfma_f32_32x32x16_bf16 v[16:31], a[228:231], v[36:39], v[16:31]
    v_cvt_pk_bf16_f32 v80, v0, v1
    v_cvt_pk_bf16_f32 v81, v2, v3
    v_cvt_pk_bf16_f32 v82, v4, v5
    v_cvt_pk_bf16_f32 v83, v6, v7
    s_add_u32 s3, s24, 131072
    buffer_store_dwordx4 v[80:83], v112, s[4:7], s3 offen
    v_mfma_f32_32x32x16_bf16 v[16:31], a[232:235], v[40:43], v[16:31]
    v_cvt_pk_bf16_f32 v84, v8, v9
    v_cvt_pk_bf16_f32 v85, v10, v11
    v_cvt_pk_bf16_f32 v86, v12, v13
    v_cvt_pk_bf16_f32 v87, v14, v15
    s_add_u32 s3, s24, 163840
    buffer_store_dwordx4 v[84:87], v112, s[4:7], s3 offen
    v_mfma_f32_32x32x16_bf16 v[16:31], a[236:239], v[44:47], v[16:31]
    v_mfma_f32_32x32x16_bf16 v[16:31], a[240:243], v[48:51], v[16:31]
    v_mfma_f32_32x32x16_bf16 v[16:31], a[244:247], v[52:55], v[16:31]
    v_mfma_f32_32x32x16_bf16 v[16:31], a[248:251], v[56:59], v[16:31]
    v_mfma_f32_32x32x16_bf16 v[16:31], a[252:255], v[60:63], v[16:31]
s_nop 11
    v_cvt_pk_bf16_f32 v88, v16, v17
    v_cvt_pk_bf16_f32 v89, v18, v19
    v_cvt_pk_bf16_f32 v90, v20, v21
    v_cvt_pk_bf16_f32 v91, v22, v23
    s_add_u32 s3, s24, 196608
    buffer_store_dwordx4 v[88:91], v112, s[4:7], s3 offen
    v_cvt_pk_bf16_f32 v92, v24, v25
    v_cvt_pk_bf16_f32 v93, v26, v27
    v_cvt_pk_bf16_f32 v94, v28, v29
    v_cvt_pk_bf16_f32 v95, v30, v31
    s_add_u32 s3, s24, 229376
    buffer_store_dwordx4 v[92:95], v112, s[4:7], s3 offen
    v_bfe_u32 v110, v112, 4, 3
    v_lshlrev_b32 v110, 2, v110
    s_waitcnt vmcnt(0)
    v_mov_b32 v108, s16
    v_mov_b32 v109, 0
    s_mov_b64 exec, 1
    buffer_store_dword v108, v109, s[4:7], s34 offen offset:0
    s_mov_b64 exec, -1
    s_branch WP_133
WP_132:
    s_sleep 2
WP_133:
    buffer_load_dword v108, v110, s[4:7], s61 offen offset:0 sc1
    s_sub_u32 s30, s30, 1
    s_cbranch_scc1 L_abort
    s_waitcnt vmcnt(0)
    v_cmp_gt_u32 vcc, s16, v108
    s_cbranch_vccnz WP_132
    s_add_u32 s3, s25, 4096
    buffer_load_dwordx4 v[32:35], v112, s[4:7], s25 offen offset:0 sc1
    buffer_load_dwordx4 v[36:39], v112, s[4:7], s25 offen offset:1024 sc1
    buffer_load_dwordx4 v[40:43], v112, s[4:7], s25 offen offset:2048 sc1
    buffer_load_dwordx4 v[44:47], v112, s[4:7], s25 offen offset:3072 sc1
    buffer_load_dwordx4 v[48:51], v112, s[4:7], s3 offen offset:0 sc1
    buffer_load_dwordx4 v[52:55], v112, s[4:7], s3 offen offset:1024 sc1
    buffer_load_dwordx4 v[56:59], v112, s[4:7], s3 offen offset:2048 sc1
    buffer_load_dwordx4 v[60:63], v112, s[4:7], s3 offen offset:3072 sc1
WS_134:
    s_waitcnt lgkmcnt(0)
    s_waitcnt vmcnt(7)
    v_mfma_f32_32x32x16_bf16 v[64:79], v[96:99], v[32:35], 0
    s_waitcnt vmcnt(6)
    v_mfma_f32_32x32x16_bf16 v[64:79], v[96:99], v[36:39], v[64:79]
    s_waitcnt vmcnt(5)
    v_mfma_f32_32x32x16_bf16 v[64:79], v[96:99], v[40:43], v[64:79]
    s_waitcnt vmcnt(4)
    v_mfma_f32_32x32x16_bf16 v[64:79], v[96:99], v[44:47], v[64:79]
    s_waitcnt vmcnt(3)
    v_mfma_f32_32x32x16_bf16 v[64:79], v[96:99], v[48:51], v[64:79]
    s_waitcnt vmcnt(2)
    v_mfma_f32_32x32x16_bf16 v[64:79], v[96:99], v[52:55], v[64:79]
    s_waitcnt vmcnt(1)
    v_mfma_f32_32x32x16_bf16 v[64:79], v[96:99], v[56:59], v[64:79]
    s_waitcnt vmcnt(0)
    v_mfma_f32_32x32x16_bf16 v[64:79], v[96:99], v[60:63], v[64:79]
s_nop 11
    ds_write_b128 v114, v[64:67] offset:16384
    ds_write_b128 v114, v[68:71] offset:17408
    s_waitcnt lgkmcnt(0)
    s_barrier
    s_cmp_lg_u32 s15, 0
    s_cbranch_scc1 W3_135
    ds_read_b128 v[32:35], v113 offset:18432
    ds_read_b128 v[36:39], v113 offset:19456
    ds_read_b128 v[40:43], v113 offset:20480
    ds_read_b128 v[44:47], v113 offset:21504
    ds_read_b128 v[48:51], v113 offset:22528
    ds_read_b128 v[52:55], v113 offset:23552
    ds_read_b128 v[56:59], v112 offset:61440
    ds_read_b128 v[60:63], v112 offset:62464
    v_and_b32 v73, 0xffff0000, v124
    v_lshlrev_b32 v72, 16, v124
    v_and_b32 v75, 0xffff0000, v125
    v_lshlrev_b32 v74, 16, v125
    v_and_b32 v77, 0xffff0000, v126
    v_lshlrev_b32 v76, 16, v126
    v_and_b32 v79, 0xffff0000, v127
    v_lshlrev_b32 v78, 16, v127
    s_waitcnt lgkmcnt(0)
    v_add_f32 v64, v64, v32
    v_add_f32 v40, v40, v48
    v_add_f32 v65, v65, v33
    v_add_f32 v41, v41, v49
    v_add_f32 v66, v66, v34
    v_add_f32 v42, v42, v50
    v_add_f32 v67, v67, v35
    v_add_f32 v43, v43, v51
    v_add_f32 v68, v68, v36
    v_add_f32 v44, v44, v52
    v_add_f32 v69, v69, v37
    v_add_f32 v45, v45, v53
    v_add_f32 v70, v70, v38
    v_add_f32 v46, v46, v54
    v_add_f32 v71, v71, v39
    v_add_f32 v47, v47, v55
    v_add_f32 v64, v64, v40
    v_add_f32 v65, v65, v41
    v_add_f32 v66, v66, v42
    v_add_f32 v67, v67, v43
    v_add_f32 v68, v68, v44
    v_add_f32 v69, v69, v45
    v_add_f32 v70, v70, v46
    v_add_f32 v71, v71, v47
    v_fma_f32 v64, v64, v56, v72
    v_fma_f32 v65, v65, v57, v73
    v_fma_f32 v66, v66, v58, v74
    v_fma_f32 v67, v67, v59, v75
    v_fma_f32 v68, v68, v60, v76
    v_fma_f32 v69, v69, v61, v77
    v_fma_f32 v70, v70, v62, v78
    v_fma_f32 v71, v71, v63, v79
    v_cvt_pk_bf16_f32 v124, v64, v65
    v_cvt_pk_bf16_f32 v125, v66, v67
    v_cvt_pk_bf16_f32 v126, v68, v69
    v_cvt_pk_bf16_f32 v127, v70, v71
    buffer_store_dwordx4 v[124:127], v112, s[4:7], s33 offen
    s_waitcnt vmcnt(0)
    v_mov_b32 v108, s16
    v_mov_b32 v109, 0
    s_mov_b64 exec, 1
    buffer_store_dword v108, v109, s[4:7], s60 offen offset:1024
    s_mov_b64 exec, -1
W3_135:
    s_cmp_ge_u32 s14, 22
    s_cbranch_scc1 W5_136
    s_branch WP_138
WP_137:
    s_sleep 2
WP_138:
    buffer_load_dword v108, v110, s[4:7], s62 offen offset:1024 sc1
    s_sub_u32 s30, s30, 1
    s_cbranch_scc1 L_abort
    s_waitcnt vmcnt(0)
    v_cmp_gt_u32 vcc, s16, v108
    s_cbranch_vccnz WP_137
    s_add_u32 s3, s26, 4096
    buffer_load_dwordx4 v[32:35], v112, s[4:7], s26 offen offset:0 sc1
    buffer_load_dwordx4 v[36:39], v112, s[4:7], s26 offen offset:1024 sc1
    buffer_load_dwordx4 v[40:43], v112, s[4:7], s26 offen offset:2048 sc1
    buffer_load_dwordx4 v[44:47], v112, s[4:7], s26 offen offset:3072 sc1
    buffer_load_dwordx4 v[48:51], v112, s[4:7], s3 offen offset:0 sc1
    buffer_load_dwordx4 v[52:55], v112, s[4:7], s3 offen offset:1024 sc1
    buffer_load_dwordx4 v[56:59], v112, s[4:7], s3 offen offset:2048 sc1
    buffer_load_dwordx4 v[60:63], v112, s[4:7], s3 offen offset:3072 sc1
    ds_read_b128 v[80:83], v116 offset:45056
    ds_read_b128 v[84:87], v116 offset:49152
    ds_read_b128 v[88:91], v116 offset:53248
    ds_read_b128 v[92:95], v116 offset:57344
    v_mov_b64 v[108:109], 0
    s_mov_b32 s3, 0x3f803f80
    s_waitcnt vmcnt(7)
    v_mfma_f32_32x32x16_bf16 v[0:15], v[128:131], v[32:35], 0
    v_dot2_f32_bf16 v108, v32, s3, v108
    v_dot2_f32_bf16 v108, v33, s3, v108
    v_dot2_f32_bf16 v108, v34, s3, v108
    v_dot2_f32_bf16 v108, v35, s3, v108
    v_mfma_f32_32x32x16_bf16 v[16:31], v[160:163], v[32:35], 0
    v_dot2_f32_bf16 v109, v32, v32, v109
    v_dot2_f32_bf16 v109, v33, v33, v109
    v_dot2_f32_bf16 v109, v34, v34, v109
    v_dot2_f32_bf16 v109, v35, v35, v109
    s_waitcnt vmcnt(6)
    v_mfma_f32_32x32x16_bf16 v[0:15], v[132:135], v[36:39], v[0:15]
    v_dot2_f32_bf16 v108, v36, s3, v108
    v_dot2_f32_bf16 v108, v37, s3, v108
    v_dot2_f32_bf16 v108, v38, s3, v108
    v_dot2_f32_bf16 v108, v39, s3, v108
    v_mfma_f32_32x32x16_bf16 v[16:31], v[164:167], v[36:39], v[16:31]
    v_dot2_f32_bf16 v109, v36, v36, v109
    v_dot2_f32_bf16 v109, v37, v37, v109
    v_dot2_f32_bf16 v109, v38, v38, v109
    v_dot2_f32_bf16 v109, v39, v39, v109
    s_waitcnt vmcnt(5)
    v_mfma_f32_32x32x16_bf16 v[0:15], v[136:139], v[40:43], v[0:15]
    v_dot2_f32_bf16 v108, v40, s3, v108
    v_dot2_f32_bf16 v108, v41, s3, v108
    v_dot2_f32_bf16 v108, v42, s3, v108
    v_dot2_f32_bf16 v108, v43, s3, v108
    v_mfma_f32_32x32x16_bf16 v[16:31], v[168:171], v[40:43], v[16:31]
    v_dot2_f32_bf16 v109, v40, v40, v109
    v_dot2_f32_bf16 v109, v41, v41, v109
    v_dot2_f32_bf16 v109, v42, v42, v109
    v_dot2_f32_bf16 v109, v43, v43, v109
    s_waitcnt vmcnt(4)
    v_mfma_f32_32x32x16_bf16 v[0:15], v[140:143], v[44:47], v[0:15]
    v_dot2_f32_bf16 v108, v44, s3, v108
    v_dot2_f32_bf16 v108, v45, s3, v108
    v_dot2_f32_bf16 v108, v46, s3, v108
    v_dot2_f32_bf16 v108, v47, s3, v108
    v_mfma_f32_32x32x16_bf16 v[16:31], v[172:175], v[44:47], v[16:31]
    v_dot2_f32_bf16 v109, v44, v44, v109
    v_dot2_f32_bf16 v109, v45, v45, v109
    v_dot2_f32_bf16 v109, v46, v46, v109
    v_dot2_f32_bf16 v109, v47, v47, v109
    s_waitcnt vmcnt(3)
    v_mfma_f32_32x32x16_bf16 v[0:15], v[144:147], v[48:51], v[0:15]
    v_dot2_f32_bf16 v108, v48, s3, v108
    v_dot2_f32_bf16 v108, v49, s3, v108
    v_dot2_f32_bf16 v108, v50, s3, v108
    v_dot2_f32_bf16 v108, v51, s3, v108
    v_mfma_f32_32x32x16_bf16 v[16:31], v[176:179], v[48:51], v[16:31]
    v_dot2_f32_bf16 v109, v48, v48, v109
    v_dot2_f32_bf16 v109, v49, v49, v109
    v_dot2_f32_bf16 v109, v50, v50, v109
    v_dot2_f32_bf16 v109, v51, v51, v109
    s_waitcnt vmcnt(2)
    v_mfma_f32_32x32x16_bf16 v[0:15], v[148:151], v[52:55], v[0:15]
    v_dot2_f32_bf16 v108, v52, s3, v108
    v_dot2_f32_bf16 v108, v53, s3, v108
    v_dot2_f32_bf16 v108, v54, s3, v108
    v_dot2_f32_bf16 v108, v55, s3, v108
    v_mfma_f32_32x32x16_bf16 v[16:31], v[180:183], v[52:55], v[16:31]
    v_dot2_f32_bf16 v109, v52, v52, v109
    v_dot2_f32_bf16 v109, v53, v53, v109
    v_dot2_f32_bf16 v109, v54, v54, v109
    v_dot2_f32_bf16 v109, v55, v55, v109
    s_waitcnt vmcnt(1)
    v_mfma_f32_32x32x16_bf16 v[0:15], v[152:155], v[56:59], v[0:15]
    v_dot2_f32_bf16 v108, v56, s3, v108
    v_dot2_f32_bf16 v108, v57, s3, v108
    v_dot2_f32_bf16 v108, v58, s3, v108
    v_dot2_f32_bf16 v108, v59, s3, v108
    v_mfma_f32_32x32x16_bf16 v[16:31], v[184:187], v[56:59], v[16:31]
    v_dot2_f32_bf16 v109, v56, v56, v109
    v_dot2_f32_bf16 v109, v57, v57, v109
    v_dot2_f32_bf16 v109, v58, v58, v109
    v_dot2_f32_bf16 v109, v59, v59, v109
    s_waitcnt vmcnt(0)
    v_mfma_f32_32x32x16_bf16 v[0:15], v[156:159], v[60:63], v[0:15]
    v_dot2_f32_bf16 v108, v60, s3, v108
    v_dot2_f32_bf16 v108, v61, s3, v108
    v_dot2_f32_bf16 v108, v62, s3, v108
    v_dot2_f32_bf16 v108, v63, s3, v108
    v_mfma_f32_32x32x16_bf16 v[16:31], v[188:191], v[60:63], v[16:31]
    v_dot2_f32_bf16 v109, v60, v60, v109
    v_dot2_f32_bf16 v109, v61, v61, v109
    v_dot2_f32_bf16 v109, v62, v62, v109
    v_dot2_f32_bf16 v109, v63, v63, v109
    v_mov_b32 v104, v108
s_nop 1
    v_permlane32_swap_b32 v108, v104
    v_add_f32 v108, v108, v104
    v_mov_b32 v105, v109
s_nop 1
    v_permlane32_swap_b32 v109, v105
    v_add_f32 v109, v109, v105
    ds_write_b64 v116, v[108:109] offset:38912
    ds_write_b128 v114, v[0:3] offset:32768
    ds_write_b128 v114, v[4:7] offset:33792
    ds_write_b128 v114, v[8:11] offset:40960
    ds_write_b128 v114, v[12:15] offset:41984
    ds_write_b128 v114, v[16:19] offset:49152
    ds_write_b128 v114, v[20:23] offset:50176
    ds_write_b128 v114, v[24:27] offset:57344
    ds_write_b128 v114, v[28:31] offset:58368
    s_waitcnt lgkmcnt(0)
    s_barrier
    ds_read_b64 v[64:65], v112 offset:38912
    ds_read_b64 v[66:67], v112 offset:39936
    ds_read_b64 v[68:69], v112 offset:40960
    ds_read_b64 v[70:71], v112 offset:41984
    ds_read_b128 v[32:35], v115 offset:0
    ds_read_b128 v[36:39], v115 offset:1024
    ds_read_b128 v[40:43], v115 offset:2048
    ds_read_b128 v[44:47], v115 offset:3072
    ds_read_b128 v[48:51], v115 offset:4096
    ds_read_b128 v[52:55], v115 offset:5120
    ds_read_b128 v[56:59], v115 offset:6144
    ds_read_b128 v[60:63], v115 offset:7168
    s_mov_b32 s3, 0x3b000000
    v_mov_b32 v104, 0x3727c5ac
    s_waitcnt lgkmcnt(8)
    v_add_f32 v64, v64, v66
    v_add_f32 v68, v68, v70
    v_add_f32 v64, v64, v68
    v_add_f32 v65, v65, v67
    v_add_f32 v69, v69, v71
    v_add_f32 v65, v65, v69
    v_mul_f32 v64, s3, v64
    v_mul_f32 v66, v64, v64
    v_fma_f32 v65, v65, s3, -v66
    v_max_f32 v65, 0, v65
    v_add_f32 v65, v65, v104
    v_rsq_f32 v65, v65
    s_waitcnt lgkmcnt(0)
    v_add_f32 v32, v32, v40
    v_add_f32 v48, v48, v56
    v_add_f32 v33, v33, v41
    v_add_f32 v49, v49, v57
    v_add_f32 v34, v34, v42
    v_add_f32 v50, v50, v58
    v_add_f32 v35, v35, v43
    v_add_f32 v51, v51, v59
    v_add_f32 v36, v36, v44
    v_add_f32 v52, v52, v60
    v_add_f32 v37, v37, v45
    v_add_f32 v53, v53, v61
    v_add_f32 v38, v38, v46
    v_add_f32 v54, v54, v62
    v_add_f32 v39, v39, v47
    v_add_f32 v55, v55, v63
    v_add_f32 v32, v32, v48
    v_add_f32 v33, v33, v49
    v_add_f32 v34, v34, v50
    v_add_f32 v35, v35, v51
    v_add_f32 v36, v36, v52
    v_add_f32 v37, v37, v53
    v_add_f32 v38, v38, v54
    v_add_f32 v39, v39, v55
    v_fma_f32 v32, -v64, v88, v32
    v_fma_f32 v33, -v64, v89, v33
    v_fma_f32 v34, -v64, v90, v34
    v_fma_f32 v35, -v64, v91, v35
    v_fma_f32 v36, -v64, v92, v36
    v_fma_f32 v37, -v64, v93, v37
    v_fma_f32 v38, -v64, v94, v38
    v_fma_f32 v39, -v64, v95, v39
    v_fma_f32 v32, v32, v65, v80
    v_fma_f32 v33, v33, v65, v81
    v_fma_f32 v34, v34, v65, v82
    v_fma_f32 v35, v35, v65, v83
    v_fma_f32 v36, v36, v65, v84
    v_fma_f32 v37, v37, v65, v85
    v_fma_f32 v38, v38, v65, v86
    v_fma_f32 v39, v39, v65, v87
    v_mul_f32 v40, 0xbfb8aa3b, v32
    v_mul_f32 v41, 0xbfb8aa3b, v33
    v_mul_f32 v42, 0xbfb8aa3b, v34
    v_mul_f32 v43, 0xbfb8aa3b, v35
    v_mul_f32 v44, 0xbfb8aa3b, v36
    v_mul_f32 v45, 0xbfb8aa3b, v37
    v_mul_f32 v46, 0xbfb8aa3b, v38
    v_mul_f32 v47, 0xbfb8aa3b, v39
    v_exp_f32 v40, v40
    v_exp_f32 v41, v41
    v_exp_f32 v42, v42
    v_exp_f32 v43, v43
    v_exp_f32 v44, v44
    v_exp_f32 v45, v45
    v_exp_f32 v46, v46
    v_exp_f32 v47, v47
    v_add_f32 v40, 1.0, v40
    v_add_f32 v41, 1.0, v41
    v_add_f32 v42, 1.0, v42
    v_add_f32 v43, 1.0, v43
    v_add_f32 v44, 1.0, v44
    v_add_f32 v45, 1.0, v45
    v_add_f32 v46, 1.0, v46
    v_add_f32 v47, 1.0, v47
    v_rcp_f32 v40, v40
    v_rcp_f32 v41, v41
    v_rcp_f32 v42, v42
    v_rcp_f32 v43, v43
    v_rcp_f32 v44, v44
    v_rcp_f32 v45, v45
    v_rcp_f32 v46, v46
    v_rcp_f32 v47, v47
    v_mul_f32 v32, v32, v40
    v_mul_f32 v33, v33, v41
    v_mul_f32 v34, v34, v42
    v_mul_f32 v35, v35, v43
    v_mul_f32 v36, v36, v44
    v_mul_f32 v37, v37, v45
    v_mul_f32 v38, v38, v46
    v_mul_f32 v39, v39, v47
    v_cvt_pk_bf16_f32 v32, v32, v33
    v_cvt_pk_bf16_f32 v33, v34, v35
    v_cvt_pk_bf16_f32 v34, v36, v37
    v_cvt_pk_bf16_f32 v35, v38, v39
    ds_write_b128 v116, v[32:35] offset:34816
    s_waitcnt lgkmcnt(0)
    s_barrier
    ds_read_b128 v[64:67], v112 offset:34816
    ds_read_b128 v[68:71], v112 offset:35840
    ds_read_b128 v[72:75], v112 offset:36864
    ds_read_b128 v[76:79], v112 offset:37888
    s_waitcnt lgkmcnt(3)
    v_mfma_f32_32x32x16_bf16 v[0:15], v[192:195], v[64:67], 0
    s_waitcnt lgkmcnt(2)
    v_mfma_f32_32x32x16_bf16 v[0:15], v[196:199], v[68:71], v[0:15]
    s_waitcnt lgkmcnt(1)
    v_mfma_f32_32x32x16_bf16 v[0:15], v[200:203], v[72:75], v[0:15]
    s_waitcnt lgkmcnt(0)
    v_mfma_f32_32x32x16_bf16 v[0:15], v[204:207], v[76:79], v[0:15]
    v_mfma_f32_32x32x16_bf16 v[16:31], v[208:211], v[64:67], 0
    v_mfma_f32_32x32x16_bf16 v[16:31], v[212:215], v[68:71], v[16:31]
    v_cvt_pk_bf16_f32 v80, v0, v1
    v_cvt_pk_bf16_f32 v81, v2, v3
    v_cvt_pk_bf16_f32 v82, v4, v5
    v_cvt_pk_bf16_f32 v83, v6, v7
    s_add_u32 s3, s24, 8388608
    buffer_store_dwordx4 v[80:83], v112, s[4:7], s3 offen
    v_mfma_f32_32x32x16_bf16 v[16:31], v[216:219], v[72:75], v[16:31]
    v_cvt_pk_bf16_f32 v84, v8, v9
    v_cvt_pk_bf16_f32 v85, v10, v11
    v_cvt_pk_bf16_f32 v86, v12, v13
    v_cvt_pk_bf16_f32 v87, v14, v15
    s_add_u32 s3, s24, 8421376
    buffer_store_dwordx4 v[84:87], v112, s[4:7], s3 offen
    v_mfma_f32_32x32x16_bf16 v[16:31], v[220:223], v[76:79], v[16:31]
    v_mfma_f32_32x32x16_bf16 v[0:15], v[224:227], v[64:67], 0
    v_mfma_f32_32x32x16_bf16 v[0:15], v[228:231], v[68:71], v[0:15]
    v_cvt_pk_bf16_f32 v88, v16, v17
    v_cvt_pk_bf16_f32 v89, v18, v19
    v_cvt_pk_bf16_f32 v90, v20, v21
    v_cvt_pk_bf16_f32 v91, v22, v23
    s_add_u32 s3, s24, 8454144
    buffer_store_dwordx4 v[88:91], v112, s[4:7], s3 offen
    v_mfma_f32_32x32x16_bf16 v[0:15], v[232:235], v[72:75], v[0:15]
    v_cvt_pk_bf16_f32 v92, v24, v25
    v_cvt_pk_bf16_f32 v93, v26, v27
    v_cvt_pk_bf16_f32 v94, v28, v29
    v_cvt_pk_bf16_f32 v95, v30, v31
    s_add_u32 s3, s24, 8486912
    buffer_store_dwordx4 v[92:95], v112, s[4:7], s3 offen
    v_mfma_f32_32x32x16_bf16 v[0:15], v[236:239], v[76:79], v[0:15]
    v_mfma_f32_32x32x16_bf16 v[16:31], v[240:243], v[64:67], 0
    v_mfma_f32_32x32x16_bf16 v[16:31], v[244:247], v[68:71], v[16:31]
    v_cvt_pk_bf16_f32 v80, v0, v1
    v_cvt_pk_bf16_f32 v81, v2, v3
    v_cvt_pk_bf16_f32 v82, v4, v5
    v_cvt_pk_bf16_f32 v83, v6, v7
    s_add_u32 s3, s24, 8519680
    buffer_store_dwordx4 v[80:83], v112, s[4:7], s3 offen
    v_mfma_f32_32x32x16_bf16 v[16:31], v[248:251], v[72:75], v[16:31]
    v_cvt_pk_bf16_f32 v84, v8, v9
    v_cvt_pk_bf16_f32 v85, v10, v11
    v_cvt_pk_bf16_f32 v86, v12, v13
    v_cvt_pk_bf16_f32 v87, v14, v15
    s_add_u32 s3, s24, 8552448
    buffer_store_dwordx4 v[84:87], v112, s[4:7], s3 offen
    v_mfma_f32_32x32x16_bf16 v[16:31], v[252:255], v[76:79], v[16:31]
s_nop 11
    v_cvt_pk_bf16_f32 v88, v16, v17
    v_cvt_pk_bf16_f32 v89, v18, v19
    v_cvt_pk_bf16_f32 v90, v20, v21
    v_cvt_pk_bf16_f32 v91, v22, v23
    s_add_u32 s3, s24, 8585216
    buffer_store_dwordx4 v[88:91], v112, s[4:7], s3 offen
    v_cvt_pk_bf16_f32 v92, v24, v25
    v_cvt_pk_bf16_f32 v93, v26, v27
    v_cvt_pk_bf16_f32 v94, v28, v29
    v_cvt_pk_bf16_f32 v95, v30, v31
    s_add_u32 s3, s24, 8617984
    buffer_store_dwordx4 v[92:95], v112, s[4:7], s3 offen
    s_waitcnt vmcnt(0)
    v_mov_b32 v108, s16
    v_mov_b32 v109, 0
    s_mov_b64 exec, 1
    buffer_store_dword v108, v109, s[4:7], s34 offen offset:512
    s_mov_b64 exec, -1
W5_136:
    v_add_u32 v110, s63, v110
    v_min_u32 v110, s39, v110
    s_branch WP_140
WP_139:
    s_sleep 2
WP_140:
    buffer_load_dword v108, v110, s[4:7], s35 offen offset:512 sc1
    s_sub_u32 s30, s30, 1
    s_cbranch_scc1 L_abort
    s_waitcnt vmcnt(0)
    v_cmp_gt_u32 vcc, s16, v108
    s_cbranch_vccnz WP_139
    s_add_u32 s3, s32, 4096
    v_mov_b64 v[48:49], 0
    v_mov_b64 v[50:51], 0
    v_mov_b64 v[52:53], 0
    v_mov_b64 v[54:55], 0
    buffer_load_dwordx4 v[32:35], v112, s[4:7], s32 offen offset:0 sc1
    buffer_load_dwordx4 v[36:39], v112, s[4:7], s32 offen offset:1024 sc1
    buffer_load_dwordx4 v[40:43], v112, s[4:7], s32 offen offset:2048 sc1
    buffer_load_dwordx4 v[44:47], v112, s[4:7], s32 offen offset:3072 sc1
    s_cmp_eq_u32 s15, 3
    s_cbranch_scc1 WS_141
    buffer_load_dwordx4 v[48:51], v112, s[4:7], s3 offen offset:0 sc1
    buffer_load_dwordx4 v[52:55], v112, s[4:7], s3 offen offset:1024 sc1
WS_141:
    s_waitcnt vmcnt(3)
    v_mfma_f32_32x32x16_bf16 v[64:79], v[96:99], v[32:35], 0
    s_waitcnt vmcnt(2)
    v_mfma_f32_32x32x16_bf16 v[64:79], v[96:99], v[36:39], v[64:79]
    s_waitcnt vmcnt(1)
    v_mfma_f32_32x32x16_bf16 v[64:79], v[96:99], v[40:43], v[64:79]
    s_waitcnt vmcnt(0)
    v_mfma_f32_32x32x16_bf16 v[64:79], v[96:99], v[44:47], v[64:79]
    s_waitcnt vmcnt(0)
    v_mfma_f32_32x32x16_bf16 v[64:79], v[96:99], v[48:51], v[64:79]
    s_waitcnt vmcnt(0)
    v_mfma_f32_32x32x16_bf16 v[64:79], v[96:99], v[52:55], v[64:79]
s_nop 11
    ds_write_b128 v114, v[64:67] offset:24576
    ds_write_b128 v114, v[68:71] offset:25600
    s_waitcnt lgkmcnt(0)
    s_barrier
    s_cmp_lg_u32 s15, 0
    s_cbranch_scc1 W6_142
    ds_read_b128 v[32:35], v113 offset:26624
    ds_read_b128 v[36:39], v113 offset:27648
    ds_read_b128 v[40:43], v113 offset:28672
    ds_read_b128 v[44:47], v113 offset:29696
    ds_read_b128 v[48:51], v113 offset:30720
    ds_read_b128 v[52:55], v113 offset:31744
    ds_read_b128 v[56:59], v112 offset:63488
    ds_read_b128 v[60:63], v112 offset:64512
    v_and_b32 v73, 0xffff0000, v124
    v_lshlrev_b32 v72, 16, v124
    v_and_b32 v75, 0xffff0000, v125
    v_lshlrev_b32 v74, 16, v125
    v_and_b32 v77, 0xffff0000, v126
    v_lshlrev_b32 v76, 16, v126
    v_and_b32 v79, 0xffff0000, v127
    v_lshlrev_b32 v78, 16, v127
    s_waitcnt lgkmcnt(0)
    v_add_f32 v64, v64, v32
    v_add_f32 v40, v40, v48
    v_add_f32 v65, v65, v33
    v_add_f32 v41, v41, v49
    v_add_f32 v66, v66, v34
    v_add_f32 v42, v42, v50
    v_add_f32 v67, v67, v35
    v_add_f32 v43, v43, v51
    v_add_f32 v68, v68, v36
    v_add_f32 v44, v44, v52
    v_add_f32 v69, v69, v37
    v_add_f32 v45, v45, v53
    v_add_f32 v70, v70, v38
    v_add_f32 v46, v46, v54
    v_add_f32 v71, v71, v39
    v_add_f32 v47, v47, v55
    v_add_f32 v64, v64, v40
    v_add_f32 v65, v65, v41
    v_add_f32 v66, v66, v42
    v_add_f32 v67, v67, v43
    v_add_f32 v68, v68, v44
    v_add_f32 v69, v69, v45
    v_add_f32 v70, v70, v46
    v_add_f32 v71, v71, v47
    v_fma_f32 v64, v64, v56, v72
    v_fma_f32 v65, v65, v57, v73
    v_fma_f32 v66, v66, v58, v74
    v_fma_f32 v67, v67, v59, v75
    v_fma_f32 v68, v68, v60, v76
    v_fma_f32 v69, v69, v61, v77
    v_fma_f32 v70, v70, v62, v78
    v_fma_f32 v71, v71, v63, v79
    v_cvt_pk_bf16_f32 v124, v64, v65
    v_cvt_pk_bf16_f32 v125, v66, v67
    v_cvt_pk_bf16_f32 v126, v68, v69
    v_cvt_pk_bf16_f32 v127, v70, v71
    buffer_store_dwordx4 v[124:127], v122, s[68:71], s27 offen
W6_142:
    s_add_u32 s21, s21, 3670016
    s_add_u32 s22, s22, 917504
    s_add_u32 s27, s27, 229376
    s_cmp_lt_u32 s16, s18
    s_cbranch_scc1 WL_129
    s_branch L_wdone
WSAFE_128:
WL_143:
    s_add_u32 s16, s16, 1
    ds_read_b128 v[32:35], v112 offset:0
    ds_read_b128 v[36:39], v112 offset:1024
    ds_read_b128 v[40:43], v112 offset:2048
    ds_read_b128 v[44:47], v112 offset:3072
    ds_read_b128 v[48:51], v112 offset:4096
    ds_read_b128 v[52:55], v112 offset:5120
    s_add_u32 s3, s21, 4096
    buffer_load_dwordx4 v[0:3], v117, s[4:7], s21 offen offset:0
    buffer_load_dwordx4 v[4:7], v117, s[4:7], s21 offen offset:512
    buffer_load_dwordx4 v[8:11], v117, s[4:7], s21 offen offset:2048
    buffer_load_dwordx4 v[12:15], v117, s[4:7], s21 offen offset:2560
    buffer_load_dwordx4 v[16:19], v117, s[4:7], s3 offen offset:0
    buffer_load_dwordx4 v[20:23], v117, s[4:7], s3 offen offset:512
    buffer_load_dwordx4 v[24:27], v117, s[4:7], s3 offen offset:2048
    buffer_load_dwordx4 v[28:31], v117, s[4:7], s3 offen offset:2560
    buffer_load_dwordx4 v[96:99], v118, s[4:7], s21 offen offset:0
    buffer_load_dwordx4 v[100:103], v118, s[4:7], s21 offen offset:512
    buffer_load_dwordx4 v[124:127], v122, s[64:67], s27 offen
    s_waitcnt lgkmcnt(5)
    v_mfma_f32_32x32x16_bf16 v[80:95], a[0:3], v[32:35], 0
    ds_read_b128 v[56:59], v112 offset:6144
    s_waitcnt lgkmcnt(5)
    v_mfma_f32_32x32x16_bf16 v[80:95], a[4:7], v[36:39], v[80:95]
    ds_read_b128 v[60:63], v112 offset:7168
    s_waitcnt lgkmcnt(5)
    v_mfma_f32_32x32x16_bf16 v[80:95], a[8:11], v[40:43], v[80:95]
    ds_read_b128 v[32:35], v112 offset:8192
    s_waitcnt lgkmcnt(5)
    v_mfma_f32_32x32x16_bf16 v[80:95], a[12:15], v[44:47], v[80:95]
    ds_read_b128 v[36:39], v112 offset:9216
    s_waitcnt lgkmcnt(5)
    v_mfma_f32_32x32x16_bf16 v[80:95], a[16:19], v[48:51], v[80:95]
    ds_read_b128 v[40:43], v112 offset:10240
    s_waitcnt lgkmcnt(5)
    v_mfma_f32_32x32x16_bf16 v[80:95], a[20:23], v[52:55], v[80:95]
    ds_read_b128 v[44:47], v112 offset:11264
    s_waitcnt lgkmcnt(5)
    v_mfma_f32_32x32x16_bf16 v[80:95], a[24:27], v[56:59], v[80:95]
    ds_read_b128 v[48:51], v112 offset:12288
    s_waitcnt lgkmcnt(5)
    v_mfma_f32_32x32x16_bf16 v[80:95], a[28:31], v[60:63], v[80:95]
    ds_read_b128 v[52:55], v112 offset:13312
    s_waitcnt lgkmcnt(5)
    v_mfma_f32_32x32x16_bf16 v[80:95], a[32:35], v[32:35], v[80:95]
    ds_read_b128 v[56:59], v112 offset:14336
    s_waitcnt lgkmcnt(5)
    v_mfma_f32_32x32x16_bf16 v[80:95], a[36:39], v[36:39], v[80:95]
    ds_read_b128 v[60:63], v112 offset:15360
    s_waitcnt lgkmcnt(5)
    v_mfma_f32_32x32x16_bf16 v[80:95], a[40:43], v[40:43], v[80:95]
    ds_read_b128 v[32:35], v112 offset:16384
    s_waitcnt lgkmcnt(5)
    v_mfma_f32_32x32x16_bf16 v[80:95], a[44:47], v[44:47], v[80:95]
    ds_read_b128 v[36:39], v112 offset:17408
    s_waitcnt lgkmcnt(5)
    v_mfma_f32_32x32x16_bf16 v[80:95], a[48:51], v[48:51], v[80:95]
    ds_read_b128 v[40:43], v112 offset:18432
    s_waitcnt lgkmcnt(5)
    v_mfma_f32_32x32x16_bf16 v[80:95], a[52:55], v[52:55], v[80:95]
    ds_read_b128 v[44:47], v112 offset:19456
    s_waitcnt lgkmcnt(5)
    v_mfma_f32_32x32x16_bf16 v[80:95], a[56:59], v[56:59], v[80:95]
    ds_read_b128 v[48:51], v112 offset:20480
    s_waitcnt lgkmcnt(5)
    v_mfma_f32_32x32x16_bf16 v[80:95], a[60:63], v[60:63], v[80:95]
    ds_read_b128 v[52:55], v112 offset:21504
    s_waitcnt lgkmcnt(5)
    v_mfma_f32_32x32x16_bf16 v[80:95], a[64:67], v[32:35], v[80:95]
    ds_read_b128 v[56:59], v112 offset:22528
    s_waitcnt lgkmcnt(5)
    v_mfma_f32_32x32x16_bf16 v[80:95], a[68:71], v[36:39], v[80:95]
    ds_read_b128 v[60:63], v112 offset:23552
    s_waitcnt lgkmcnt(5)
    v_mfma_f32_32x32x16_bf16 v[80:95], a[72:75], v[40:43], v[80:95]
    ds_read_b128 v[32:35], v112 offset:24576
    s_waitcnt lgkmcnt(5)
    v_mfma_f32_32x32x16_bf16 v[80:95], a[76:79], v[44:47], v[80:95]
    ds_read_b128 v[36:39], v112 offset:25600
    s_waitcnt lgkmcnt(5)
    v_mfma_f32_32x32x16_bf16 v[80:95], a[80:83], v[48:51], v[80:95]
    ds_read_b128 v[40:43], v112 offset:26624
    s_waitcnt lgkmcnt(5)
    v_mfma_f32_32x32x16_bf16 v[80:95], a[84:87], v[52:55], v[80:95]
    ds_read_b128 v[44:47], v112 offset:27648
    s_waitcnt lgkmcnt(5)
    v_mfma_f32_32x32x16_bf16 v[80:95], a[88:91], v[56:59], v[80:95]
    ds_read_b128 v[48:51], v112 offset:28672
    s_waitcnt lgkmcnt(5)
    v_mfma_f32_32x32x16_bf16 v[80:95], a[92:95], v[60:63], v[80:95]
    ds_read_b128 v[52:55], v112 offset:29696
    s_waitcnt lgkmcnt(5)
    v_mfma_f32_32x32x16_bf16 v[80:95], a[96:99], v[32:35], v[80:95]
    ds_read_b128 v[56:59], v112 offset:30720
    s_waitcnt lgkmcnt(5)
    v_mfma_f32_32x32x16_bf16 v[80:95], a[100:103], v[36:39], v[80:95]
    ds_read_b128 v[60:63], v112 offset:31744
    s_waitcnt lgkmcnt(5)
    v_mfma_f32_32x32x16_bf16 v[80:95], a[104:107], v[40:43], v[80:95]
    s_waitcnt lgkmcnt(4)
    v_mfma_f32_32x32x16_bf16 v[80:95], a[108:111], v[44:47], v[80:95]
    s_waitcnt lgkmcnt(3)
    v_mfma_f32_32x32x16_bf16 v[80:95], a[112:115], v[48:51], v[80:95]
    s_waitcnt lgkmcnt(2)
    v_mfma_f32_32x32x16_bf16 v[80:95], a[116:119], v[52:55], v[80:95]
    s_waitcnt lgkmcnt(1)
    v_mfma_f32_32x32x16_bf16 v[80:95], a[120:123], v[56:59], v[80:95]
    s_waitcnt lgkmcnt(0)
    v_mfma_f32_32x32x16_bf16 v[80:95], a[124:127], v[60:63], v[80:95]
s_nop 11
    v_cvt_pk_bf16_f32 v80, v80, v81
    v_cvt_pk_bf16_f32 v81, v82, v83
    v_cvt_pk_bf16_f32 v82, v84, v85
    v_cvt_pk_bf16_f32 v83, v86, v87
    v_cvt_pk_bf16_f32 v84, v88, v89
    v_cvt_pk_bf16_f32 v85, v90, v91
    v_cvt_pk_bf16_f32 v86, v92, v93
    v_cvt_pk_bf16_f32 v87, v94, v95
    ds_write_b128 v114, v[80:83] offset:0
    ds_write_b128 v114, v[84:87] offset:1024
    s_waitcnt lgkmcnt(0)
    s_barrier
    ds_read_b128 v[32:35], v113 offset:0
    ds_read_b128 v[36:39], v113 offset:1024
    ds_read_b128 v[40:43], v113 offset:2048
    ds_read_b128 v[44:47], v113 offset:3072
    ds_read_b128 v[48:51], v113 offset:4096
    ds_read_b128 v[52:55], v113 offset:5120
    ds_read_b128 v[56:59], v113 offset:6144
    ds_read_b128 v[60:63], v113 offset:7168
    s_waitcnt vmcnt(0)
    s_add_u32 m0, s37, 0
    s_add_u32 s3, s20, 0
    buffer_load_dwordx4 v112, s[4:7], s3 offen offset:0 sc1 lds
    buffer_load_dwordx4 v112, s[4:7], s3 offen offset:1024 sc1 lds
    buffer_load_dwordx4 v112, s[4:7], s3 offen offset:2048 sc1 lds
    buffer_load_dwordx4 v112, s[4:7], s3 offen offset:3072 sc1 lds
    s_add_u32 m0, s37, 4096
    s_add_u32 s3, s20, 4096
    buffer_load_dwordx4 v112, s[4:7], s3 offen offset:0 sc1 lds
    buffer_load_dwordx4 v112, s[4:7], s3 offen offset:1024 sc1 lds
    buffer_load_dwordx4 v112, s[4:7], s3 offen offset:2048 sc1 lds
    buffer_load_dwordx4 v112, s[4:7], s3 offen offset:3072 sc1 lds
    s_add_u32 s20, s20, 229376
    s_waitcnt lgkmcnt(7)
    v_mfma_f32_32x32x16_bf16 v[64:79], v[0:3], v[32:35], 0
    s_waitcnt lgkmcnt(6)
    v_mfma_f32_32x32x16_bf16 v[64:79], v[4:7], v[36:39], v[64:79]
    s_waitcnt lgkmcnt(5)
    v_mfma_f32_32x32x16_bf16 v[64:79], v[8:11], v[40:43], v[64:79]
    s_waitcnt lgkmcnt(4)
    v_mfma_f32_32x32x16_bf16 v[64:79], v[12:15], v[44:47], v[64:79]
    s_waitcnt lgkmcnt(3)
    v_mfma_f32_32x32x16_bf16 v[64:79], v[16:19], v[48:51], v[64:79]
    s_waitcnt lgkmcnt(2)
    v_mfma_f32_32x32x16_bf16 v[64:79], v[20:23], v[52:55], v[64:79]
    s_waitcnt lgkmcnt(1)
    v_mfma_f32_32x32x16_bf16 v[64:79], v[24:27], v[56:59], v[64:79]
    s_waitcnt lgkmcnt(0)
    v_mfma_f32_32x32x16_bf16 v[64:79], v[28:31], v[60:63], v[64:79]
    v_mov_b32 v108, 0xf149f2ca
    v_mov_b64 v[106:107], 0
    v_cmp_le_i32 vcc, 0, v123
s_nop 8
    v_cndmask_b32 v64, v108, v64, vcc
    v_cmp_le_i32 vcc, 1, v123
s_nop 1
    v_cndmask_b32 v65, v108, v65, vcc
    v_cmp_le_i32 vcc, 2, v123
s_nop 1
    v_cndmask_b32 v66, v108, v66, vcc
    v_cmp_le_i32 vcc, 3, v123
s_nop 1
    v_cndmask_b32 v67, v108, v67, vcc
    v_cmp_le_i32 vcc, 8, v123
s_nop 1
    v_cndmask_b32 v68, v108, v68, vcc
    v_cmp_le_i32 vcc, 9, v123
s_nop 1
    v_cndmask_b32 v69, v108, v69, vcc
    v_cmp_le_i32 vcc, 10, v123
s_nop 1
    v_cndmask_b32 v70, v108, v70, vcc
    v_cmp_le_i32 vcc, 11, v123
s_nop 1
    v_cndmask_b32 v71, v108, v71, vcc
    v_cmp_le_i32 vcc, 16, v123
s_nop 1
    v_cndmask_b32 v72, v108, v72, vcc
    v_cmp_le_i32 vcc, 17, v123
s_nop 1
    v_cndmask_b32 v73, v108, v73, vcc
    v_cmp_le_i32 vcc, 18, v123
s_nop 1
    v_cndmask_b32 v74, v108, v74, vcc
    v_cmp_le_i32 vcc, 19, v123
s_nop 1
    v_cndmask_b32 v75, v108, v75, vcc
    v_cmp_le_i32 vcc, 24, v123
s_nop 1
    v_cndmask_b32 v76, v108, v76, vcc
    v_cmp_le_i32 vcc, 25, v123
s_nop 1
    v_cndmask_b32 v77, v108, v77, vcc
    v_cmp_le_i32 vcc, 26, v123
s_nop 1
    v_cndmask_b32 v78, v108, v78, vcc
    v_cmp_le_i32 vcc, 27, v123
s_nop 1
    v_cndmask_b32 v79, v108, v79, vcc
    v_max3_f32 v110, v64, v65, v66
    v_max3_f32 v110, v110, v67, v68
    v_max3_f32 v110, v110, v69, v70
    v_max3_f32 v110, v110, v71, v72
    v_max3_f32 v110, v110, v73, v74
    v_max3_f32 v110, v110, v75, v76
    v_max3_f32 v110, v110, v77, v78
    v_max_f32 v110, v110, v79
    s_branch WK_145
WK_144:
    s_sleep 4
WK_145:
    buffer_load_dwordx2 v[108:109], v112, s[4:7], s22 offen sc1
    buffer_load_dwordx2 v[104:105], v119, s[4:7], s22 offen sc1
    s_sub_u32 s30, s30, 1
    s_cbranch_scc1 L_abort
    s_waitcnt vmcnt(0)
    ds_write_b64 v120, v[108:109] offset:32768
    v_max3_u32 v111, v108, v109, v104
    v_max_u32 v111, v111, v105
    v_cmp_eq_u32 vcc, -1, v111
    s_cbranch_vccnz WK_144
    s_waitcnt lgkmcnt(0)
    s_barrier
    ds_read_b64_tr_b16 v[0:1], v121 offset:32768
    ds_read_b64_tr_b16 v[2:3], v121 offset:32896
    ds_read_b64_tr_b16 v[4:5], v121 offset:33024
    ds_read_b64_tr_b16 v[6:7], v121 offset:33152
    ds_read_b64_tr_b16 v[8:9], v121 offset:33280
    ds_read_b64_tr_b16 v[10:11], v121 offset:33408
    ds_read_b64_tr_b16 v[12:13], v121 offset:33536
    ds_read_b64_tr_b16 v[14:15], v121 offset:33664
    ds_read_b64_tr_b16 v[16:17], v121 offset:33792
    ds_read_b64_tr_b16 v[18:19], v121 offset:33920
    ds_read_b64_tr_b16 v[20:21], v121 offset:34048
    ds_read_b64_tr_b16 v[22:23], v121 offset:34176
    ds_read_b64_tr_b16 v[24:25], v121 offset:34304
    ds_read_b64_tr_b16 v[26:27], v121 offset:34432
    ds_read_b64_tr_b16 v[28:29], v121 offset:34560
    ds_read_b64_tr_b16 v[30:31], v121 offset:34688
    s_waitcnt lgkmcnt(14)
    v_mfma_f32_32x32x16_bf16 v[80:95], v[0:3], v[32:35], 0
    s_waitcnt lgkmcnt(12)
    v_mfma_f32_32x32x16_bf16 v[80:95], v[4:7], v[36:39], v[80:95]
    s_waitcnt lgkmcnt(10)
    v_mfma_f32_32x32x16_bf16 v[80:95], v[8:11], v[40:43], v[80:95]
    s_waitcnt lgkmcnt(8)
    v_mfma_f32_32x32x16_bf16 v[80:95], v[12:15], v[44:47], v[80:95]
    s_waitcnt lgkmcnt(6)
    v_mfma_f32_32x32x16_bf16 v[80:95], v[16:19], v[48:51], v[80:95]
    s_waitcnt lgkmcnt(4)
    v_mfma_f32_32x32x16_bf16 v[80:95], v[20:23], v[52:55], v[80:95]
    s_waitcnt lgkmcnt(2)
    v_mfma_f32_32x32x16_bf16 v[80:95], v[24:27], v[56:59], v[80:95]
    s_waitcnt lgkmcnt(0)
    v_mfma_f32_32x32x16_bf16 v[80:95], v[28:31], v[60:63], v[80:95]
s_nop 11
    v_max3_f32 v110, v110, v80, v81
    v_max3_f32 v110, v110, v82, v83
    v_mov_b32 v108, v110
s_nop 1
    v_permlane32_swap_b32 v110, v108
    v_max_f32 v110, v110, v108
    v_mul_f32 v110, s31, v110
    v_fma_f32 v64, v64, s31, -v110
    v_fma_f32 v65, v65, s31, -v110
    v_fma_f32 v66, v66, s31, -v110
    v_fma_f32 v67, v67, s31, -v110
    v_fma_f32 v68, v68, s31, -v110
    v_fma_f32 v69, v69, s31, -v110
    v_fma_f32 v70, v70, s31, -v110
    v_fma_f32 v71, v71, s31, -v110
    v_fma_f32 v72, v72, s31, -v110
    v_fma_f32 v73, v73, s31, -v110
    v_fma_f32 v74, v74, s31, -v110
    v_fma_f32 v75, v75, s31, -v110
    v_fma_f32 v76, v76, s31, -v110
    v_fma_f32 v77, v77, s31, -v110
    v_fma_f32 v78, v78, s31, -v110
    v_fma_f32 v79, v79, s31, -v110
    v_fma_f32 v80, v80, s31, -v110
    v_fma_f32 v81, v81, s31, -v110
    v_fma_f32 v82, v82, s31, -v110
    v_fma_f32 v83, v83, s31, -v110
    v_exp_f32 v64, v64
    v_exp_f32 v65, v65
    v_exp_f32 v66, v66
    v_add_f32 v108, v64, v65
    v_exp_f32 v67, v67
    v_add_f32 v108, v108, v66
    v_exp_f32 v68, v68
    v_add_f32 v108, v108, v67
    v_exp_f32 v69, v69
    v_add_f32 v108, v108, v68
    v_exp_f32 v70, v70
    v_add_f32 v108, v108, v69
    v_exp_f32 v71, v71
    v_add_f32 v108, v108, v70
    v_exp_f32 v72, v72
    v_add_f32 v108, v108, v71
    v_exp_f32 v73, v73
    v_add_f32 v108, v108, v72
    v_exp_f32 v74, v74
    v_add_f32 v108, v108, v73
    v_exp_f32 v75, v75
    v_add_f32 v108, v108, v74
    v_exp_f32 v76, v76
    v_add_f32 v108, v108, v75
    v_exp_f32 v77, v77
    v_add_f32 v108, v108, v76
    v_exp_f32 v78, v78
    v_add_f32 v108, v108, v77
    v_exp_f32 v79, v79
    v_add_f32 v108, v108, v78
    v_exp_f32 v80, v80
    v_add_f32 v108, v108, v79
    v_exp_f32 v81, v81
    v_add_f32 v108, v108, v80
    v_exp_f32 v82, v82
    v_add_f32 v108, v108, v81
    v_exp_f32 v83, v83
    v_add_f32 v108, v108, v82
    v_add_f32 v108, v108, v83
    v_cvt_pk_bf16_f32 v64, v64, v65
    v_cvt_pk_bf16_f32 v65, v66, v67
    v_cvt_pk_bf16_f32 v66, v68, v69
    v_cvt_pk_bf16_f32 v67, v70, v71
    v_cvt_pk_bf16_f32 v68, v72, v73
    v_cvt_pk_bf16_f32 v69, v74, v75
    v_cvt_pk_bf16_f32 v70, v76, v77
    v_cvt_pk_bf16_f32 v71, v78, v79
    v_cvt_pk_bf16_f32 v72, v80, v81
    v_cvt_pk_bf16_f32 v73, v82, v83
    v_mov_b64 v[74:75], 0
    v_mfma_f32_32x32x16_bf16 v[0:15], v[96:99], v[64:67], 0
    v_mov_b32 v109, v108
s_nop 1
    v_permlane32_swap_b32 v108, v109
    v_add_f32 v108, v108, v109
    v_mfma_f32_32x32x16_bf16 v[0:15], v[100:103], v[68:71], v[0:15]
    v_rcp_f32 v108, v108
    v_mfma_f32_32x32x16_bf16 v[0:15], v[104:107], v[72:75], v[0:15]
s_nop 11
    v_mul_f32 v0, v0, v108
    v_mul_f32 v1, v1, v108
    v_mul_f32 v2, v2, v108
    v_mul_f32 v3, v3, v108
    v_mul_f32 v4, v4, v108
    v_mul_f32 v5, v5, v108
    v_mul_f32 v6, v6, v108
    v_mul_f32 v7, v7, v108
    v_mul_f32 v8, v8, v108
    v_mul_f32 v9, v9, v108
    v_mul_f32 v10, v10, v108
    v_mul_f32 v11, v11, v108
    v_mul_f32 v12, v12, v108
    v_mul_f32 v13, v13, v108
    v_mul_f32 v14, v14, v108
    v_mul_f32 v15, v15, v108
    v_cvt_pk_bf16_f32 v0, v0, v1
    v_cvt_pk_bf16_f32 v1, v2, v3
    v_cvt_pk_bf16_f32 v2, v4, v5
    v_cvt_pk_bf16_f32 v3, v6, v7
    v_cvt_pk_bf16_f32 v4, v8, v9
    v_cvt_pk_bf16_f32 v5, v10, v11
    v_cvt_pk_bf16_f32 v6, v12, v13
    v_cvt_pk_bf16_f32 v7, v14, v15
    ds_write_b128 v114, v[0:3] offset:8192
    ds_write_b128 v114, v[4:7] offset:9216
    s_waitcnt lgkmcnt(0)
    s_barrier
    ds_read_b128 v[32:35], v113 offset:8192
    ds_read_b128 v[36:39], v113 offset:9216
    ds_read_b128 v[40:43], v113 offset:10240
    ds_read_b128 v[44:47], v113 offset:11264
    ds_read_b128 v[48:51], v113 offset:12288
    ds_read_b128 v[52:55], v113 offset:13312
    ds_read_b128 v[56:59], v113 offset:14336
    ds_read_b128 v[60:63], v113 offset:15360
    ds_read_b128 v[96:99], v112 offset:43008
    s_waitcnt lgkmcnt(8)
    v_mfma_f32_32x32x16_bf16 v[0:15], a[128:131], v[32:35], 0
    s_waitcnt lgkmcnt(7)
    v_mfma_f32_32x32x16_bf16 v[0:15], a[132:135], v[36:39], v[0:15]
    s_waitcnt lgkmcnt(6)
    v_mfma_f32_32x32x16_bf16 v[0:15], a[136:139], v[40:43], v[0:15]
    s_waitcnt lgkmcnt(5)
    v_mfma_f32_32x32x16_bf16 v[0:15], a[140:143], v[44:47], v[0:15]
    s_waitcnt lgkmcnt(4)
    v_mfma_f32_32x32x16_bf16 v[0:15], a[144:147], v[48:51], v[0:15]
    s_waitcnt lgkmcnt(3)
    v_mfma_f32_32x32x16_bf16 v[0:15], a[148:151], v[52:55], v[0:15]
    s_waitcnt lgkmcnt(2)
    v_mfma_f32_32x32x16_bf16 v[0:15], a[152:155], v[56:59], v[0:15]
    s_waitcnt lgkmcnt(1)
    v_mfma_f32_32x32x16_bf16 v[0:15], a[156:159], v[60:63], v[0:15]
    v_mfma_f32_32x32x16_bf16 v[16:31], a[160:163], v[32:35], 0
    v_mfma_f32_32x32x16_bf16 v[16:31], a[164:167], v[36:39], v[16:31]
    v_cvt_pk_bf16_f32 v80, v0, v1
    v_cvt_pk_bf16_f32 v81, v2, v3
    v_cvt_pk_bf16_f32 v82, v4, v5
    v_cvt_pk_bf16_f32 v83, v6, v7
    s_add_u32 s3, s24, 0
    buffer_store_dwordx4 v[80:83], v112, s[4:7], s3 offen sc1
    v_mfma_f32_32x32x16_bf16 v[16:31], a[168:171], v[40:43], v[16:31]
    v_cvt_pk_bf16_f32 v84, v8, v9
    v_cvt_pk_bf16_f32 v85, v10, v11
    v_cvt_pk_bf16_f32 v86, v12, v13
    v_cvt_pk_bf16_f32 v87, v14, v15
    s_add_u32 s3, s24, 32768
    buffer_store_dwordx4 v[84:87], v112, s[4:7], s3 offen sc1
    v_mfma_f32_32x32x16_bf16 v[16:31], a[172:175], v[44:47], v[16:31]
    v_mfma_f32_32x32x16_bf16 v[16:31], a[176:179], v[48:51], v[16:31]
    v_mfma_f32_32x32x16_bf16 v[16:31], a[180:183], v[52:55], v[16:31]
    v_mfma_f32_32x32x16_bf16 v[16:31], a[184:187], v[56:59], v[16:31]
    v_mfma_f32_32x32x16_bf16 v[16:31], a[188:191], v[60:63], v[16:31]
    v_mfma_f32_32x32x16_bf16 v[0:15], a[192:195], v[32:35], 0
    v_mfma_f32_32x32x16_bf16 v[0:15], a[196:199], v[36:39], v[0:15]
    v_cvt_pk_bf16_f32 v88, v16, v17
    v_cvt_pk_bf16_f32 v89, v18, v19
    v_cvt_pk_bf16_f32 v90, v20, v21
    v_cvt_pk_bf16_f32 v91, v22, v23
    s_add_u32 s3, s24, 65536
    buffer_store_dwordx4 v[88:91], v112, s[4:7], s3 offen sc1
    v_mfma_f32_32x32x16_bf16 v[0:15], a[200:203], v[40:43], v[0:15]
    v_cvt_pk_bf16_f32 v92, v24, v25
    v_cvt_pk_bf16_f32 v93, v26, v27
    v_cvt_pk_bf16_f32 v94, v28, v29
    v_cvt_pk_bf16_f32 v95, v30, v31
    s_add_u32 s3, s24, 98304
    buffer_store_dwordx4 v[92:95], v112, s[4:7], s3 offen sc1
    v_mfma_f32_32x32x16_bf16 v[0:15], a[204:207], v[44:47], v[0:15]
    v_mfma_f32_32x32x16_bf16 v[0:15], a[208:211], v[48:51], v[0:15]
    v_mfma_f32_32x32x16_bf16 v[0:15], a[212:215], v[52:55], v[0:15]
    v_mfma_f32_32x32x16_bf16 v[0:15], a[216:219], v[56:59], v[0:15]
    v_mfma_f32_32x32x16_bf16 v[0:15], a[220:223], v[60:63], v[0:15]
    v_mfma_f32_32x32x16_bf16 v[16:31], a[224:227], v[32:35], 0
    v_mfma_f32_32x32x16_bf16 v[16:31], a[228:231], v[36:39], v[16:31]
    v_cvt_pk_bf16_f32 v80, v0, v1
    v_cvt_pk_bf16_f32 v81, v2, v3
    v_cvt_pk_bf16_f32 v82, v4, v5
    v_cvt_pk_bf16_f32 v83, v6, v7
    s_add_u32 s3, s24, 131072
    buffer_store_dwordx4 v[80:83], v112, s[4:7], s3 offen sc1
    v_mfma_f32_32x32x16_bf16 v[16:31], a[232:235], v[40:43], v[16:31]
    v_cvt_pk_bf16_f32 v84, v8, v9
    v_cvt_pk_bf16_f32 v85, v10, v11
    v_cvt_pk_bf16_f32 v86, v12, v13
    v_cvt_pk_bf16_f32 v87, v14, v15
    s_add_u32 s3, s24, 163840
    buffer_store_dwordx4 v[84:87], v112, s[4:7], s3 offen sc1
    v_mfma_f32_32x32x16_bf16 v[16:31], a[236:239], v[44:47], v[16:31]
    v_mfma_f32_32x32x16_bf16 v[16:31], a[240:243], v[48:51], v[16:31]
    v_mfma_f32_32x32x16_bf16 v[16:31], a[244:247], v[52:55], v[16:31]
    v_mfma_f32_32x32x16_bf16 v[16:31], a[248:251], v[56:59], v[16:31]
    v_mfma_f32_32x32x16_bf16 v[16:31], a[252:255], v[60:63], v[16:31]
s_nop 11
    v_cvt_pk_bf16_f32 v88, v16, v17
    v_cvt_pk_bf16_f32 v89, v18, v19
    v_cvt_pk_bf16_f32 v90, v20, v21
    v_cvt_pk_bf16_f32 v91, v22, v23
    s_add_u32 s3, s24, 196608
    buffer_store_dwordx4 v[88:91], v112, s[4:7], s3 offen sc1
    v_cvt_pk_bf16_f32 v92, v24, v25
    v_cvt_pk_bf16_f32 v93, v26, v27
    v_cvt_pk_bf16_f32 v94, v28, v29
    v_cvt_pk_bf16_f32 v95, v30, v31
    s_add_u32 s3, s24, 229376
    buffer_store_dwordx4 v[92:95], v112, s[4:7], s3 offen sc1
    v_bfe_u32 v110, v112, 4, 3
    v_lshlrev_b32 v110, 2, v110
    s_waitcnt vmcnt(0)
    v_mov_b32 v108, s16
    v_mov_b32 v109, 0
    s_mov_b64 exec, 1
    buffer_store_dword v108, v109, s[4:7], s34 offen offset:0 sc1
    s_mov_b64 exec, -1
    s_branch WP_147
WP_146:
    s_sleep 2
WP_147:
    buffer_load_dword v108, v110, s[4:7], s61 offen offset:0 sc1
    s_sub_u32 s30, s30, 1
    s_cbranch_scc1 L_abort
    s_waitcnt vmcnt(0)
    v_cmp_gt_u32 vcc, s16, v108
    s_cbranch_vccnz WP_146
    s_add_u32 s3, s25, 4096
    buffer_load_dwordx4 v[32:35], v112, s[4:7], s25 offen offset:0 sc1
    buffer_load_dwordx4 v[36:39], v112, s[4:7], s25 offen offset:1024 sc1
    buffer_load_dwordx4 v[40:43], v112, s[4:7], s25 offen offset:2048 sc1
    buffer_load_dwordx4 v[44:47], v112, s[4:7], s25 offen offset:3072 sc1
    buffer_load_dwordx4 v[48:51], v112, s[4:7], s3 offen offset:0 sc1
    buffer_load_dwordx4 v[52:55], v112, s[4:7], s3 offen offset:1024 sc1
    buffer_load_dwordx4 v[56:59], v112, s[4:7], s3 offen offset:2048 sc1
    buffer_load_dwordx4 v[60:63], v112, s[4:7], s3 offen offset:3072 sc1
WS_148:
    s_waitcnt lgkmcnt(0)
    s_waitcnt vmcnt(7)
    v_mfma_f32_32x32x16_bf16 v[64:79], v[96:99], v[32:35], 0
    s_waitcnt vmcnt(6)
    v_mfma_f32_32x32x16_bf16 v[64:79], v[96:99], v[36:39], v[64:79]
    s_waitcnt vmcnt(5)
    v_mfma_f32_32x32x16_bf16 v[64:79], v[96:99], v[40:43], v[64:79]
    s_waitcnt vmcnt(4)
    v_mfma_f32_32x32x16_bf16 v[64:79], v[96:99], v[44:47], v[64:79]
    s_waitcnt vmcnt(3)
    v_mfma_f32_32x32x16_bf16 v[64:79], v[96:99], v[48:51], v[64:79]
    s_waitcnt vmcnt(2)
    v_mfma_f32_32x32x16_bf16 v[64:79], v[96:99], v[52:55], v[64:79]
    s_waitcnt vmcnt(1)
    v_mfma_f32_32x32x16_bf16 v[64:79], v[96:99], v[56:59], v[64:79]
    s_waitcnt vmcnt(0)
    v_mfma_f32_32x32x16_bf16 v[64:79], v[96:99], v[60:63], v[64:79]
s_nop 11
    ds_write_b128 v114, v[64:67] offset:16384
    ds_write_b128 v114, v[68:71] offset:17408
    s_waitcnt lgkmcnt(0)
    s_barrier
    s_cmp_lg_u32 s15, 0
    s_cbranch_scc1 W3_149
    ds_read_b128 v[32:35], v113 offset:18432
    ds_read_b128 v[36:39], v113 offset:19456
    ds_read_b128 v[40:43], v113 offset:20480
    ds_read_b128 v[44:47], v113 offset:21504
    ds_read_b128 v[48:51], v113 offset:22528
    ds_read_b128 v[52:55], v113 offset:23552
    ds_read_b128 v[56:59], v112 offset:61440
    ds_read_b128 v[60:63], v112 offset:62464
    v_and_b32 v73, 0xffff0000, v124
    v_lshlrev_b32 v72, 16, v124
    v_and_b32 v75, 0xffff0000, v125
    v_lshlrev_b32 v74, 16, v125
    v_and_b32 v77, 0xffff0000, v126
    v_lshlrev_b32 v76, 16, v126
    v_and_b32 v79, 0xffff0000, v127
    v_lshlrev_b32 v78, 16, v127
    s_waitcnt lgkmcnt(0)
    v_add_f32 v64, v64, v32
    v_add_f32 v40, v40, v48
    v_add_f32 v65, v65, v33
    v_add_f32 v41, v41, v49
    v_add_f32 v66, v66, v34
    v_add_f32 v42, v42, v50
    v_add_f32 v67, v67, v35
    v_add_f32 v43, v43, v51
    v_add_f32 v68, v68, v36
    v_add_f32 v44, v44, v52
    v_add_f32 v69, v69, v37
    v_add_f32 v45, v45, v53
    v_add_f32 v70, v70, v38
    v_add_f32 v46, v46, v54
    v_add_f32 v71, v71, v39
    v_add_f32 v47, v47, v55
    v_add_f32 v64, v64, v40
    v_add_f32 v65, v65, v41
    v_add_f32 v66, v66, v42
    v_add_f32 v67, v67, v43
    v_add_f32 v68, v68, v44
    v_add_f32 v69, v69, v45
    v_add_f32 v70, v70, v46
    v_add_f32 v71, v71, v47
    v_fma_f32 v64, v64, v56, v72
    v_fma_f32 v65, v65, v57, v73
    v_fma_f32 v66, v66, v58, v74
    v_fma_f32 v67, v67, v59, v75
    v_fma_f32 v68, v68, v60, v76
    v_fma_f32 v69, v69, v61, v77
    v_fma_f32 v70, v70, v62, v78
    v_fma_f32 v71, v71, v63, v79
    v_cvt_pk_bf16_f32 v124, v64, v65
    v_cvt_pk_bf16_f32 v125, v66, v67
    v_cvt_pk_bf16_f32 v126, v68, v69
    v_cvt_pk_bf16_f32 v127, v70, v71
    buffer_store_dwordx4 v[124:127], v112, s[4:7], s33 offen sc1
    s_waitcnt vmcnt(0)
    v_mov_b32 v108, s16
    v_mov_b32 v109, 0
    s_mov_b64 exec, 1
    buffer_store_dword v108, v109, s[4:7], s60 offen offset:1024 sc1
    s_mov_b64 exec, -1
W3_149:
    s_cmp_ge_u32 s14, 22
    s_cbranch_scc1 W5_150
    s_branch WP_152
WP_151:
    s_sleep 2
WP_152:
    buffer_load_dword v108, v110, s[4:7], s62 offen offset:1024 sc1
    s_sub_u32 s30, s30, 1
    s_cbranch_scc1 L_abort
    s_waitcnt vmcnt(0)
    v_cmp_gt_u32 vcc, s16, v108
    s_cbranch_vccnz WP_151
    s_add_u32 s3, s26, 4096
    buffer_load_dwordx4 v[32:35], v112, s[4:7], s26 offen offset:0 sc1
    buffer_load_dwordx4 v[36:39], v112, s[4:7], s26 offen offset:1024 sc1
    buffer_load_dwordx4 v[40:43], v112, s[4:7], s26 offen offset:2048 sc1
    buffer_load_dwordx4 v[44:47], v112, s[4:7], s26 offen offset:3072 sc1
    buffer_load_dwordx4 v[48:51], v112, s[4:7], s3 offen offset:0 sc1
    buffer_load_dwordx4 v[52:55], v112, s[4:7], s3 offen offset:1024 sc1
    buffer_load_dwordx4 v[56:59], v112, s[4:7], s3 offen offset:2048 sc1
    buffer_load_dwordx4 v[60:63], v112, s[4:7], s3 offen offset:3072 sc1
    ds_read_b128 v[80:83], v116 offset:45056
    ds_read_b128 v[84:87], v116 offset:49152
    ds_read_b128 v[88:91], v116 offset:53248
    ds_read_b128 v[92:95], v116 offset:57344
    v_mov_b64 v[108:109], 0
    s_mov_b32 s3, 0x3f803f80
    s_waitcnt vmcnt(7)
    v_mfma_f32_32x32x16_bf16 v[0:15], v[128:131], v[32:35], 0
    v_dot2_f32_bf16 v108, v32, s3, v108
    v_dot2_f32_bf16 v108, v33, s3, v108
    v_dot2_f32_bf16 v108, v34, s3, v108
    v_dot2_f32_bf16 v108, v35, s3, v108
    v_mfma_f32_32x32x16_bf16 v[16:31], v[160:163], v[32:35], 0
    v_dot2_f32_bf16 v109, v32, v32, v109
    v_dot2_f32_bf16 v109, v33, v33, v109
    v_dot2_f32_bf16 v109, v34, v34, v109
    v_dot2_f32_bf16 v109, v35, v35, v109
    s_waitcnt vmcnt(6)
    v_mfma_f32_32x32x16_bf16 v[0:15], v[132:135], v[36:39], v[0:15]
    v_dot2_f32_bf16 v108, v36, s3, v108
    v_dot2_f32_bf16 v108, v37, s3, v108
    v_dot2_f32_bf16 v108, v38, s3, v108
    v_dot2_f32_bf16 v108, v39, s3, v108
    v_mfma_f32_32x32x16_bf16 v[16:31], v[164:167], v[36:39], v[16:31]
    v_dot2_f32_bf16 v109, v36, v36, v109
    v_dot2_f32_bf16 v109, v37, v37, v109
    v_dot2_f32_bf16 v109, v38, v38, v109
    v_dot2_f32_bf16 v109, v39, v39, v109
    s_waitcnt vmcnt(5)
    v_mfma_f32_32x32x16_bf16 v[0:15], v[136:139], v[40:43], v[0:15]
    v_dot2_f32_bf16 v108, v40, s3, v108
    v_dot2_f32_bf16 v108, v41, s3, v108
    v_dot2_f32_bf16 v108, v42, s3, v108
    v_dot2_f32_bf16 v108, v43, s3, v108
    v_mfma_f32_32x32x16_bf16 v[16:31], v[168:171], v[40:43], v[16:31]
    v_dot2_f32_bf16 v109, v40, v40, v109
    v_dot2_f32_bf16 v109, v41, v41, v109
    v_dot2_f32_bf16 v109, v42, v42, v109
    v_dot2_f32_bf16 v109, v43, v43, v109
    s_waitcnt vmcnt(4)
    v_mfma_f32_32x32x16_bf16 v[0:15], v[140:143], v[44:47], v[0:15]
    v_dot2_f32_bf16 v108, v44, s3, v108
    v_dot2_f32_bf16 v108, v45, s3, v108
    v_dot2_f32_bf16 v108, v46, s3, v108
    v_dot2_f32_bf16 v108, v47, s3, v108
    v_mfma_f32_32x32x16_bf16 v[16:31], v[172:175], v[44:47], v[16:31]
    v_dot2_f32_bf16 v109, v44, v44, v109
    v_dot2_f32_bf16 v109, v45, v45, v109
    v_dot2_f32_bf16 v109, v46, v46, v109
    v_dot2_f32_bf16 v109, v47, v47, v109
    s_waitcnt vmcnt(3)
    v_mfma_f32_32x32x16_bf16 v[0:15], v[144:147], v[48:51], v[0:15]
    v_dot2_f32_bf16 v108, v48, s3, v108
    v_dot2_f32_bf16 v108, v49, s3, v108
    v_dot2_f32_bf16 v108, v50, s3, v108
    v_dot2_f32_bf16 v108, v51, s3, v108
    v_mfma_f32_32x32x16_bf16 v[16:31], v[176:179], v[48:51], v[16:31]
    v_dot2_f32_bf16 v109, v48, v48, v109
    v_dot2_f32_bf16 v109, v49, v49, v109
    v_dot2_f32_bf16 v109, v50, v50, v109
    v_dot2_f32_bf16 v109, v51, v51, v109
    s_waitcnt vmcnt(2)
    v_mfma_f32_32x32x16_bf16 v[0:15], v[148:151], v[52:55], v[0:15]
    v_dot2_f32_bf16 v108, v52, s3, v108
    v_dot2_f32_bf16 v108, v53, s3, v108
    v_dot2_f32_bf16 v108, v54, s3, v108
    v_dot2_f32_bf16 v108, v55, s3, v108
    v_mfma_f32_32x32x16_bf16 v[16:31], v[180:183], v[52:55], v[16:31]
    v_dot2_f32_bf16 v109, v52, v52, v109
    v_dot2_f32_bf16 v109, v53, v53, v109
    v_dot2_f32_bf16 v109, v54, v54, v109
    v_dot2_f32_bf16 v109, v55, v55, v109
    s_waitcnt vmcnt(1)
    v_mfma_f32_32x32x16_bf16 v[0:15], v[152:155], v[56:59], v[0:15]
    v_dot2_f32_bf16 v108, v56, s3, v108
    v_dot2_f32_bf16 v108, v57, s3, v108
    v_dot2_f32_bf16 v108, v58, s3, v108
    v_dot2_f32_bf16 v108, v59, s3, v108
    v_mfma_f32_32x32x16_bf16 v[16:31], v[184:187], v[56:59], v[16:31]
    v_dot2_f32_bf16 v109, v56, v56, v109
    v_dot2_f32_bf16 v109, v57, v57, v109
    v_dot2_f32_bf16 v109, v58, v58, v109
    v_dot2_f32_bf16 v109, v59, v59, v109
    s_waitcnt vmcnt(0)
    v_mfma_f32_32x32x16_bf16 v[0:15], v[156:159], v[60:63], v[0:15]
    v_dot2_f32_bf16 v108, v60, s3, v108
    v_dot2_f32_bf16 v108, v61, s3, v108
    v_dot2_f32_bf16 v108, v62, s3, v108
    v_dot2_f32_bf16 v108, v63, s3, v108
    v_mfma_f32_32x32x16_bf16 v[16:31], v[188:191], v[60:63], v[16:31]
    v_dot2_f32_bf16 v109, v60, v60, v109
    v_dot2_f32_bf16 v109, v61, v61, v109
    v_dot2_f32_bf16 v109, v62, v62, v109
    v_dot2_f32_bf16 v109, v63, v63, v109
    v_mov_b32 v104, v108
s_nop 1
    v_permlane32_swap_b32 v108, v104
    v_add_f32 v108, v108, v104
    v_mov_b32 v105, v109
s_nop 1
    v_permlane32_swap_b32 v109, v105
    v_add_f32 v109, v109, v105
    ds_write_b64 v116, v[108:109] offset:38912
    ds_write_b128 v114, v[0:3] offset:32768
    ds_write_b128 v114, v[4:7] offset:33792
    ds_write_b128 v114, v[8:11] offset:40960
    ds_write_b128 v114, v[12:15] offset:41984
    ds_write_b128 v114, v[16:19] offset:49152
    ds_write_b128 v114, v[20:23] offset:50176
    ds_write_b128 v114, v[24:27] offset:57344
    ds_write_b128 v114, v[28:31] offset:58368
    s_waitcnt lgkmcnt(0)
    s_barrier
    ds_read_b64 v[64:65], v112 offset:38912
    ds_read_b64 v[66:67], v112 offset:39936
    ds_read_b64 v[68:69], v112 offset:40960
    ds_read_b64 v[70:71], v112 offset:41984
    ds_read_b128 v[32:35], v115 offset:0
    ds_read_b128 v[36:39], v115 offset:1024
    ds_read_b128 v[40:43], v115 offset:2048
    ds_read_b128 v[44:47], v115 offset:3072
    ds_read_b128 v[48:51], v115 offset:4096
    ds_read_b128 v[52:55], v115 offset:5120
    ds_read_b128 v[56:59], v115 offset:6144
    ds_read_b128 v[60:63], v115 offset:7168
    s_mov_b32 s3, 0x3b000000
    v_mov_b32 v104, 0x3727c5ac
    s_waitcnt lgkmcnt(8)
    v_add_f32 v64, v64, v66
    v_add_f32 v68, v68, v70
    v_add_f32 v64, v64, v68
    v_add_f32 v65, v65, v67
    v_add_f32 v69, v69, v71
    v_add_f32 v65, v65, v69
    v_mul_f32 v64, s3, v64
    v_mul_f32 v66, v64, v64
    v_fma_f32 v65, v65, s3, -v66
    v_max_f32 v65, 0, v65
    v_add_f32 v65, v65, v104
    v_rsq_f32 v65, v65
    s_waitcnt lgkmcnt(0)
    v_add_f32 v32, v32, v40
    v_add_f32 v48, v48, v56
    v_add_f32 v33, v33, v41
    v_add_f32 v49, v49, v57
    v_add_f32 v34, v34, v42
    v_add_f32 v50, v50, v58
    v_add_f32 v35, v35, v43
    v_add_f32 v51, v51, v59
    v_add_f32 v36, v36, v44
    v_add_f32 v52, v52, v60
    v_add_f32 v37, v37, v45
    v_add_f32 v53, v53, v61
    v_add_f32 v38, v38, v46
    v_add_f32 v54, v54, v62
    v_add_f32 v39, v39, v47
    v_add_f32 v55, v55, v63
    v_add_f32 v32, v32, v48
    v_add_f32 v33, v33, v49
    v_add_f32 v34, v34, v50
    v_add_f32 v35, v35, v51
    v_add_f32 v36, v36, v52
    v_add_f32 v37, v37, v53
    v_add_f32 v38, v38, v54
    v_add_f32 v39, v39, v55
    v_fma_f32 v32, -v64, v88, v32
    v_fma_f32 v33, -v64, v89, v33
    v_fma_f32 v34, -v64, v90, v34
    v_fma_f32 v35, -v64, v91, v35
    v_fma_f32 v36, -v64, v92, v36
    v_fma_f32 v37, -v64, v93, v37
    v_fma_f32 v38, -v64, v94, v38
    v_fma_f32 v39, -v64, v95, v39
    v_fma_f32 v32, v32, v65, v80
    v_fma_f32 v33, v33, v65, v81
    v_fma_f32 v34, v34, v65, v82
    v_fma_f32 v35, v35, v65, v83
    v_fma_f32 v36, v36, v65, v84
    v_fma_f32 v37, v37, v65, v85
    v_fma_f32 v38, v38, v65, v86
    v_fma_f32 v39, v39, v65, v87
    v_mul_f32 v40, 0xbfb8aa3b, v32
    v_mul_f32 v41, 0xbfb8aa3b, v33
    v_mul_f32 v42, 0xbfb8aa3b, v34
    v_mul_f32 v43, 0xbfb8aa3b, v35
    v_mul_f32 v44, 0xbfb8aa3b, v36
    v_mul_f32 v45, 0xbfb8aa3b, v37
    v_mul_f32 v46, 0xbfb8aa3b, v38
    v_mul_f32 v47, 0xbfb8aa3b, v39
    v_exp_f32 v40, v40
    v_exp_f32 v41, v41
    v_exp_f32 v42, v42
    v_exp_f32 v43, v43
    v_exp_f32 v44, v44
    v_exp_f32 v45, v45
    v_exp_f32 v46, v46
    v_exp_f32 v47, v47
    v_add_f32 v40, 1.0, v40
    v_add_f32 v41, 1.0, v41
    v_add_f32 v42, 1.0, v42
    v_add_f32 v43, 1.0, v43
    v_add_f32 v44, 1.0, v44
    v_add_f32 v45, 1.0, v45
    v_add_f32 v46, 1.0, v46
    v_add_f32 v47, 1.0, v47
    v_rcp_f32 v40, v40
    v_rcp_f32 v41, v41
    v_rcp_f32 v42, v42
    v_rcp_f32 v43, v43
    v_rcp_f32 v44, v44
    v_rcp_f32 v45, v45
    v_rcp_f32 v46, v46
    v_rcp_f32 v47, v47
    v_mul_f32 v32, v32, v40
    v_mul_f32 v33, v33, v41
    v_mul_f32 v34, v34, v42
    v_mul_f32 v35, v35, v43
    v_mul_f32 v36, v36, v44
    v_mul_f32 v37, v37, v45
    v_mul_f32 v38, v38, v46
    v_mul_f32 v39, v39, v47
    v_cvt_pk_bf16_f32 v32, v32, v33
    v_cvt_pk_bf16_f32 v33, v34, v35
    v_cvt_pk_bf16_f32 v34, v36, v37
    v_cvt_pk_bf16_f32 v35, v38, v39
    ds_write_b128 v116, v[32:35] offset:34816
    s_waitcnt lgkmcnt(0)
    s_barrier
    ds_read_b128 v[64:67], v112 offset:34816
    ds_read_b128 v[68:71], v112 offset:35840
    ds_read_b128 v[72:75], v112 offset:36864
    ds_read_b128 v[76:79], v112 offset:37888
    s_waitcnt lgkmcnt(3)
    v_mfma_f32_32x32x16_bf16 v[0:15], v[192:195], v[64:67], 0
    s_waitcnt lgkmcnt(2)
    v_mfma_f32_32x32x16_bf16 v[0:15], v[196:199], v[68:71], v[0:15]
    s_waitcnt lgkmcnt(1)
    v_mfma_f32_32x32x16_bf16 v[0:15], v[200:203], v[72:75], v[0:15]
    s_waitcnt lgkmcnt(0)
    v_mfma_f32_32x32x16_bf16 v[0:15], v[204:207], v[76:79], v[0:15]
    v_mfma_f32_32x32x16_bf16 v[16:31], v[208:211], v[64:67], 0
    v_mfma_f32_32x32x16_bf16 v[16:31], v[212:215], v[68:71], v[16:31]
    v_cvt_pk_bf16_f32 v80, v0, v1
    v_cvt_pk_bf16_f32 v81, v2, v3
    v_cvt_pk_bf16_f32 v82, v4, v5
    v_cvt_pk_bf16_f32 v83, v6, v7
    s_add_u32 s3, s24, 8388608
    buffer_store_dwordx4 v[80:83], v112, s[4:7], s3 offen sc1
    v_mfma_f32_32x32x16_bf16 v[16:31], v[216:219], v[72:75], v[16:31]
    v_cvt_pk_bf16_f32 v84, v8, v9
    v_cvt_pk_bf16_f32 v85, v10, v11
    v_cvt_pk_bf16_f32 v86, v12, v13
    v_cvt_pk_bf16_f32 v87, v14, v15
    s_add_u32 s3, s24, 8421376
    buffer_store_dwordx4 v[84:87], v112, s[4:7], s3 offen sc1
    v_mfma_f32_32x32x16_bf16 v[16:31], v[220:223], v[76:79], v[16:31]
    v_mfma_f32_32x32x16_bf16 v[0:15], v[224:227], v[64:67], 0
    v_mfma_f32_32x32x16_bf16 v[0:15], v[228:231], v[68:71], v[0:15]
    v_cvt_pk_bf16_f32 v88, v16, v17
    v_cvt_pk_bf16_f32 v89, v18, v19
    v_cvt_pk_bf16_f32 v90, v20, v21
    v_cvt_pk_bf16_f32 v91, v22, v23
    s_add_u32 s3, s24, 8454144
    buffer_store_dwordx4 v[88:91], v112, s[4:7], s3 offen sc1
    v_mfma_f32_32x32x16_bf16 v[0:15], v[232:235], v[72:75], v[0:15]
    v_cvt_pk_bf16_f32 v92, v24, v25
    v_cvt_pk_bf16_f32 v93, v26, v27
    v_cvt_pk_bf16_f32 v94, v28, v29
    v_cvt_pk_bf16_f32 v95, v30, v31
    s_add_u32 s3, s24, 8486912
    buffer_store_dwordx4 v[92:95], v112, s[4:7], s3 offen sc1
    v_mfma_f32_32x32x16_bf16 v[0:15], v[236:239], v[76:79], v[0:15]
    v_mfma_f32_32x32x16_bf16 v[16:31], v[240:243], v[64:67], 0
    v_mfma_f32_32x32x16_bf16 v[16:31], v[244:247], v[68:71], v[16:31]
    v_cvt_pk_bf16_f32 v80, v0, v1
    v_cvt_pk_bf16_f32 v81, v2, v3
    v_cvt_pk_bf16_f32 v82, v4, v5
    v_cvt_pk_bf16_f32 v83, v6, v7
    s_add_u32 s3, s24, 8519680
    buffer_store_dwordx4 v[80:83], v112, s[4:7], s3 offen sc1
    v_mfma_f32_32x32x16_bf16 v[16:31], v[248:251], v[72:75], v[16:31]
    v_cvt_pk_bf16_f32 v84, v8, v9
    v_cvt_pk_bf16_f32 v85, v10, v11
    v_cvt_pk_bf16_f32 v86, v12, v13
    v_cvt_pk_bf16_f32 v87, v14, v15
    s_add_u32 s3, s24, 8552448
    buffer_store_dwordx4 v[84:87], v112, s[4:7], s3 offen sc1
    v_mfma_f32_32x32x16_bf16 v[16:31], v[252:255], v[76:79], v[16:31]
s_nop 11
    v_cvt_pk_bf16_f32 v88, v16, v17
    v_cvt_pk_bf16_f32 v89, v18, v19
    v_cvt_pk_bf16_f32 v90, v20, v21
    v_cvt_pk_bf16_f32 v91, v22, v23
    s_add_u32 s3, s24, 8585216
    buffer_store_dwordx4 v[88:91], v112, s[4:7], s3 offen sc1
    v_cvt_pk_bf16_f32 v92, v24, v25
    v_cvt_pk_bf16_f32 v93, v26, v27
    v_cvt_pk_bf16_f32 v94, v28, v29
    v_cvt_pk_bf16_f32 v95, v30, v31
    s_add_u32 s3, s24, 8617984
    buffer_store_dwordx4 v[92:95], v112, s[4:7], s3 offen sc1
    s_waitcnt vmcnt(0)
    v_mov_b32 v108, s16
    v_mov_b32 v109, 0
    s_mov_b64 exec, 1
    buffer_store_dword v108, v109, s[4:7], s34 offen offset:512 sc1
    s_mov_b64 exec, -1
W5_150:
    v_add_u32 v110, s63, v110
    v_min_u32 v110, s39, v110
    s_branch WP_154
WP_153:
    s_sleep 2
WP_154:
    buffer_load_dword v108, v110, s[4:7], s35 offen offset:512 sc1
    s_sub_u32 s30, s30, 1
    s_cbranch_scc1 L_abort
    s_waitcnt vmcnt(0)
    v_cmp_gt_u32 vcc, s16, v108
    s_cbranch_vccnz WP_153
    s_add_u32 s3, s32, 4096
    v_mov_b64 v[48:49], 0
    v_mov_b64 v[50:51], 0
    v_mov_b64 v[52:53], 0
    v_mov_b64 v[54:55], 0
    buffer_load_dwordx4 v[32:35], v112, s[4:7], s32 offen offset:0 sc1
    buffer_load_dwordx4 v[36:39], v112, s[4:7], s32 offen offset:1024 sc1
    buffer_load_dwordx4 v[40:43], v112, s[4:7], s32 offen offset:2048 sc1
    buffer_load_dwordx4 v[44:47], v112, s[4:7], s32 offen offset:3072 sc1
    s_cmp_eq_u32 s15, 3
    s_cbranch_scc1 WS_155
    buffer_load_dwordx4 v[48:51], v112, s[4:7], s3 offen offset:0 sc1
    buffer_load_dwordx4 v[52:55], v112, s[4:7], s3 offen offset:1024 sc1
WS_155:
    s_waitcnt vmcnt(3)
    v_mfma_f32_32x32x16_bf16 v[64:79], v[96:99], v[32:35], 0
    s_waitcnt vmcnt(2)
    v_mfma_f32_32x32x16_bf16 v[64:79], v[96:99], v[36:39], v[64:79]
    s_waitcnt vmcnt(1)
    v_mfma_f32_32x32x16_bf16 v[64:79], v[96:99], v[40:43], v[64:79]
    s_waitcnt vmcnt(0)
    v_mfma_f32_32x32x16_bf16 v[64:79], v[96:99], v[44:47], v[64:79]
    s_waitcnt vmcnt(0)
    v_mfma_f32_32x32x16_bf16 v[64:79], v[96:99], v[48:51], v[64:79]
    s_waitcnt vmcnt(0)
    v_mfma_f32_32x32x16_bf16 v[64:79], v[96:99], v[52:55], v[64:79]
s_nop 11
    ds_write_b128 v114, v[64:67] offset:24576
    ds_write_b128 v114, v[68:71] offset:25600
    s_waitcnt lgkmcnt(0)
    s_barrier
    s_cmp_lg_u32 s15, 0
    s_cbranch_scc1 W6_156
    ds_read_b128 v[32:35], v113 offset:26624
    ds_read_b128 v[36:39], v113 offset:27648
    ds_read_b128 v[40:43], v113 offset:28672
    ds_read_b128 v[44:47], v113 offset:29696
    ds_read_b128 v[48:51], v113 offset:30720
    ds_read_b128 v[52:55], v113 offset:31744
    ds_read_b128 v[56:59], v112 offset:63488
    ds_read_b128 v[60:63], v112 offset:64512
    v_and_b32 v73, 0xffff0000, v124
    v_lshlrev_b32 v72, 16, v124
    v_and_b32 v75, 0xffff0000, v125
    v_lshlrev_b32 v74, 16, v125
    v_and_b32 v77, 0xffff0000, v126
    v_lshlrev_b32 v76, 16, v126
    v_and_b32 v79, 0xffff0000, v127
    v_lshlrev_b32 v78, 16, v127
    s_waitcnt lgkmcnt(0)
    v_add_f32 v64, v64, v32
    v_add_f32 v40, v40, v48
    v_add_f32 v65, v65, v33
    v_add_f32 v41, v41, v49
    v_add_f32 v66, v66, v34
    v_add_f32 v42, v42, v50
    v_add_f32 v67, v67, v35
    v_add_f32 v43, v43, v51
    v_add_f32 v68, v68, v36
    v_add_f32 v44, v44, v52
    v_add_f32 v69, v69, v37
    v_add_f32 v45, v45, v53
    v_add_f32 v70, v70, v38
    v_add_f32 v46, v46, v54
    v_add_f32 v71, v71, v39
    v_add_f32 v47, v47, v55
    v_add_f32 v64, v64, v40
    v_add_f32 v65, v65, v41
    v_add_f32 v66, v66, v42
    v_add_f32 v67, v67, v43
    v_add_f32 v68, v68, v44
    v_add_f32 v69, v69, v45
    v_add_f32 v70, v70, v46
    v_add_f32 v71, v71, v47
    v_fma_f32 v64, v64, v56, v72
    v_fma_f32 v65, v65, v57, v73
    v_fma_f32 v66, v66, v58, v74
    v_fma_f32 v67, v67, v59, v75
    v_fma_f32 v68, v68, v60, v76
    v_fma_f32 v69, v69, v61, v77
    v_fma_f32 v70, v70, v62, v78
    v_fma_f32 v71, v71, v63, v79
    v_cvt_pk_bf16_f32 v124, v64, v65
    v_cvt_pk_bf16_f32 v125, v66, v67
    v_cvt_pk_bf16_f32 v126, v68, v69
    v_cvt_pk_bf16_f32 v127, v70, v71
    buffer_store_dwordx4 v[124:127], v122, s[68:71], s27 offen
W6_156:
    s_add_u32 s21, s21, 3670016
    s_add_u32 s22, s22, 917504
    s_add_u32 s27, s27, 229376
    s_cmp_lt_u32 s16, s18
    s_cbranch_scc1 WL_143
    s_branch L_wdone

L_abort:
    s_mov_b64 exec, 1
    v_mov_b32 v1, 1
    v_mov_b32 v2, 144
    global_atomic_add v2, v1, s[12:13] sc1
    s_branch L_fin
L_rdone:

L_wdone:
L_fin:
    s_waitcnt vmcnt(0)
L_end:
    s_endpgm

.section .rodata,"a"
.p2align 6
.amdhsa_kernel adaLN_cond__memory_aug_recurrent_mem_tr__dense_activation_silu__prompt_kernel
  .amdhsa_next_free_vgpr 512
  .amdhsa_next_free_sgpr 102
  .amdhsa_accum_offset 256
  .amdhsa_group_segment_fixed_size 0
  .amdhsa_kernarg_size 120
  .amdhsa_user_sgpr_count 2
  .amdhsa_user_sgpr_kernarg_segment_ptr 1
  .amdhsa_system_sgpr_workgroup_id_x 1
.end_amdhsa_kernel
```
